```python
import torch

def _softmax(x, axis=-1):
    return torch.softmax(x, dim=axis)
def _gelu(x):
    return torch.nn.functional.gelu(x, approximate="tanh")
def _silu(x):
    return torch.nn.functional.silu(x)
def _sigmoid(x):
    return torch.sigmoid(x)
def _layernorm(x, axis=-1, eps=1e-5):
    m = x.mean(dim=axis, keepdim=True)
    v = x.var(dim=axis, keepdim=True, unbiased=False)
    return (x - m) / torch.sqrt(v + eps)
def _scatter_add(tgt, idx, src, axis=0):
    return tgt.clone().index_add_(axis, idx, src)
def _segment_sum(src, seg, n):
    out = torch.zeros((n,) + src.shape[1:], dtype=src.dtype)
    return out.index_add_(0, seg, src)
def _pad(x, pw):
    flat = tuple(v for pair in reversed(pw) for v in pair)
    return torch.nn.functional.pad(x, flat)

kernel_name = 'interleave_layers__spectral_fnet__dense_activation_relu__prompt'

def setup_inputs():

    _w = (lambda a: (lambda t: t.to(torch.bfloat16) if t.is_floating_point() else t)(torch.as_tensor(a)))
    def _A_setup():
        B, S, D = 1, 2048, 640
        ns = torch.arange(S)[:, None] * torch.arange(S)[None, :]
        nd = torch.arange(D)[:, None] * torch.arange(D)[None, :]
        Ws_re = torch.cos(-2.0 * torch.pi * ns / S).to(float)
        Ws_im = torch.sin(-2.0 * torch.pi * ns / S).to(float)
        Wd_re = torch.cos(-2.0 * torch.pi * nd / D).to(float)
        Wd_im = torch.sin(-2.0 * torch.pi * nd / D).to(float)
        return {
            "x": _w((lambda *s: torch.randn(*s, dtype=torch.bfloat16) * 0.05)(B, S, D)),
            "dft_seq_re": _w(Ws_re),
            "dft_seq_im": _w(Ws_im),
            "dft_hid_re": _w(Wd_re),
            "dft_hid_im": _w(Wd_im),
        }
    _A_in = _A_setup()

    def _B_setup():
        B, S, D, Dff = 1, 2048, 640, 1728
        return {
            "x": _w((lambda *s: torch.randn(*s, dtype=torch.bfloat16) * 0.05)(B, S, D)),
            "w1": _w((lambda *s: torch.randn(*s, dtype=torch.bfloat16) * 1.6)(D, Dff)),
            "w2": _w((lambda *s: torch.randn(*s, dtype=torch.bfloat16) * 1.6)(Dff, D)),
        }
    _B_in = _B_setup()

    return {
        "A_x": _A_in["x"],
        "A_dft_seq_re": _A_in["dft_seq_re"],
        "A_dft_seq_im": _A_in["dft_seq_im"],
        "A_dft_hid_re": _A_in["dft_hid_re"],
        "A_dft_hid_im": _A_in["dft_hid_im"],
        "B_x": _B_in["x"],
        "B_w1": _B_in["w1"],
        "B_w2": _B_in["w2"],
    }

def reference(A_x, A_dft_seq_re, A_dft_seq_im, A_dft_hid_re, A_dft_hid_im, B_x, B_w1, B_w2):
    def _A_ref(x, dft_seq_re, dft_seq_im, dft_hid_re, dft_hid_im):
        a = torch.einsum("bsd,ed->bse", x, dft_hid_re)
        b = torch.einsum("bsd,ed->bse", x, dft_hid_im)
        y = torch.einsum("ts,bse->bte", dft_seq_re, a) - torch.einsum("ts,bse->bte", dft_seq_im, b)
        return y

    def _B_ref(x, w1, w2):
        h = torch.einsum("bsd,df->bsf", x, w1)
        zero = torch.zeros_like(h)
        h = torch.maximum(h, zero)
        return torch.einsum("bsf,fd->bsd", h, w2)

    x = A_x
    x = x + _A_ref(_layernorm(x, axis=-1), A_dft_seq_re, A_dft_seq_im, A_dft_hid_re, A_dft_hid_im)
    x = x + _B_ref(_layernorm(x, axis=-1), B_w1, B_w2)
    x = x + _A_ref(_layernorm(x, axis=-1), A_dft_seq_re, A_dft_seq_im, A_dft_hid_re, A_dft_hid_im)
    x = x + _B_ref(_layernorm(x, axis=-1), B_w1, B_w2)
    return x
```

```asm
; @launch kernel=interleave_layers__spectral_fnet__dense_activation_relu__prompt_kernel grid=(256,1,1) block=(256,1,1) lds=163840
.amdgcn_target "amdgcn-amd-amdhsa--gfx950"
.text
.globl interleave_layers__spectral_fnet__dense_activation_relu__prompt_kernel
.p2align 8
.type interleave_layers__spectral_fnet__dense_activation_relu__prompt_kernel,@function
interleave_layers__spectral_fnet__dense_activation_relu__prompt_kernel:
    s_cmp_ge_u32 s2, 256
    s_cbranch_scc1 end_m_1
    s_lshr_b32 s11, s2, 3
    s_mov_b32 s14, 2621440
    s_cmp_ge_u32 s2, 160
    s_cselect_b32 s48, 48, 0
    s_cselect_b32 s14, 2211840, s14
    s_cmp_ge_u32 s2, 214
    s_cselect_b32 s48, 56, s48
    s_load_dwordx2 s[12:13], s[0:1], s48
    s_load_dwordx2 s[16:17], s[0:1], 80
    s_load_dwordx2 s[24:25], s[0:1], 64
    s_load_dwordx2 s[20:21], s[0:1], 72
    s_mov_b32 s15, 0x20000
    s_and_b32 s28, s2, 7
    s_lshr_b32 s29, s2, 3
    s_lshr_b32 s33, s29, 1
    s_getpc_b64 s[60:61]
Lpc_m:
    s_sub_u32 s60, s60, Lpc_m-interleave_layers__spectral_fnet__dense_activation_relu__prompt_kernel
    s_subb_u32 s61, s61, 0
    s_mov_b32 s62, Lcodeend_m-interleave_layers__spectral_fnet__dense_activation_relu__prompt_kernel
    s_mov_b32 s63, 0x20000
    s_lshl_b32 s49, s11, 11
    v_lshlrev_b32 v1, 3, v0
    buffer_load_dwordx2 v[254:255], v1, s[60:63], s49 offen
    v_lshrrev_b32 v2, 6, v0
    v_and_b32 v0, 63, v0
    v_readfirstlane_b32 s3, v2
    v_lshlrev_b32 v1, 4, v0
    v_and_b32 v2, 15, v0
    v_lshrrev_b32 v3, 4, v0
    s_cmp_lt_u32 s2, 160
    s_cbranch_scc1 p1h_m_8
    s_sub_u32 s56, s2, 160
    v_and_b32 v6, 3, v0
    v_bfe_u32 v7, v0, 2, 2
    s_cmp_ge_u32 s56, 54
    s_cbranch_scc1 h2_m_12
    s_and_b32 s48, s56, 7
    s_lshl_b32 s48, s48, 1
    s_bfe_u32 s49, s56, 65539
    s_or_b32 s48, s48, s49
    s_and_b32 s49, s56, 48
    s_or_b32 s48, s48, s49
    s_cmp_ge_u32 s56, 48
    s_cselect_b32 s56, s56, s48
    v_lshrrev_b32 v8, 2, v0
    v_mul_u32_u24 v8, 3456, v8
    v_lshl_add_u32 v8, v6, 4, v8
    s_mul_i32 s48, s3, 552960
    s_lshl_b32 s49, s56, 6
    s_add_u32 s48, s48, s49
    s_mul_i32 m0, s3, 10240
    s_waitcnt lgkmcnt(0)
    buffer_load_dwordx4 v8, s[12:15], s48 offen lds
    s_add_u32 m0, m0, 1024
    s_add_u32 s48, s48, 55296
    buffer_load_dwordx4 v8, s[12:15], s48 offen lds
    s_add_u32 m0, m0, 1024
    s_add_u32 s48, s48, 55296
    buffer_load_dwordx4 v8, s[12:15], s48 offen lds
    s_add_u32 m0, m0, 1024
    s_add_u32 s48, s48, 55296
    buffer_load_dwordx4 v8, s[12:15], s48 offen lds
    s_add_u32 m0, m0, 1024
    s_add_u32 s48, s48, 55296
    buffer_load_dwordx4 v8, s[12:15], s48 offen lds
    s_add_u32 m0, m0, 1024
    s_add_u32 s48, s48, 55296
    buffer_load_dwordx4 v8, s[12:15], s48 offen lds
    s_add_u32 m0, m0, 1024
    s_add_u32 s48, s48, 55296
    buffer_load_dwordx4 v8, s[12:15], s48 offen lds
    s_add_u32 m0, m0, 1024
    s_add_u32 s48, s48, 55296
    buffer_load_dwordx4 v8, s[12:15], s48 offen lds
    s_add_u32 m0, m0, 1024
    s_add_u32 s48, s48, 55296
    buffer_load_dwordx4 v8, s[12:15], s48 offen lds
    s_add_u32 m0, m0, 1024
    s_add_u32 s48, s48, 55296
    buffer_load_dwordx4 v8, s[12:15], s48 offen lds
    s_branch w1b_m_9
h2_m_12:
    s_sub_u32 s56, s56, 54
    s_mul_i32 s48, s56, 81920
    s_mul_i32 m0, s3, 20480
    s_add_u32 s48, s48, m0
    s_waitcnt lgkmcnt(0)
    s_cmp_ge_u32 s56, 27
    s_cbranch_scc1 cpf_m_11
    s_branch w2b_m_10
p1h_m_8:
    s_sub_u32 s58, 16, s28
    s_cmp_eq_u32 s28, 0
    s_cselect_b32 s58, 8, s58
    s_bitcmp1_b32 s29, 0
    s_cselect_b32 s32, s58, s28
    s_mov_b32 s6, s33
    s_lshl_b32 s56, s3, 5
    s_add_u32 s56, s56, s32
    v_lshrrev_b32 v4, 3, v0
    v_and_b32 v5, 7, v0
    v_bfe_u32 v7, v4, 1, 1
    v_and_or_b32 v6, v4, 4, v7
    v_xor_b32 v6, v6, v5
    v_lshlrev_b32 v6, 4, v6
    s_mul_i32 s58, s56, 1280
    s_lshl_b32 s59, s3, 14
    s_add_u32 s59, s59, 0
    s_mov_b32 s48, 163840
    v_mul_lo_u32 v10, v4, s48
    v_add_u32 v10, v10, v6
    s_waitcnt lgkmcnt(0)
    s_add_u32 s48, s6, 5
    s_cmp_ge_u32 s48, 10
    s_cselect_b32 s51, 10, 0
    s_sub_u32 s48, s48, s51
    s_lshl_b32 s48, s48, 7
    s_add_u32 s48, s48, s58
    s_add_u32 m0, s59, 0
    s_add_u32 s49, s48, 0
    buffer_load_dwordx4 v10, s[12:15], s49 offen lds
    s_add_u32 m0, s59, 1024
    s_add_u32 s49, s48, 1310720
    buffer_load_dwordx4 v10, s[12:15], s49 offen lds
    s_add_u32 m0, s59, 2048
    s_add_u32 s49, s48, 20480
    buffer_load_dwordx4 v10, s[12:15], s49 offen lds
    s_add_u32 m0, s59, 3072
    s_add_u32 s49, s48, 1331200
    buffer_load_dwordx4 v10, s[12:15], s49 offen lds
    s_and_b32 s30, s29, 3
    s_lshr_b32 s31, s29, 2
    s_cmp_eq_u32 s28, 0
    s_cselect_b32 s61, 8, 16
    s_lshl_b32 s60, s30, 1
    s_mul_i32 s60, s60, s61
    s_add_u32 s36, s60, s28
    s_add_u32 s38, s36, s61
    s_sub_u32 s39, 128, s38
    s_sub_u32 s37, 128, s36
    s_cmp_eq_u32 s36, 0
    s_cselect_b32 s37, 64, s37
    s_lshl_b32 s40, s2, 7
    s_add_u32 s40, s40, 29196288
    s_cmp_lg_u32 s3, 0
    s_cselect_b32 s40, 1073741824, s40
    s_add_u32 s43, s40, 32768
    s_mul_i32 s34, s31, 7
    s_min_u32 s34, s34, 48
    s_lshl_b32 s61, s3, 1
    s_add_u32 s60, s34, s61
    s_lshl_b32 s41, s60, 10
    s_add_u32 s42, s41, 1024
    s_mul_i32 s44, s60, 40960
    s_add_u32 s44, s44, 24641536
    s_add_u32 s45, s44, 40960
    s_cmp_eq_u32 s3, 3
    s_cselect_b32 s45, 1073741824, s45
    s_cselect_b32 s61, s31, 0
    s_cmp_ge_u32 s61, 6
    s_cselect_b32 s44, 1073741824, s44
    s_cmp_eq_u32 s44, 1073741824
    s_cselect_b32 s41, 1073741824, s41
    s_cmp_eq_u32 s45, 1073741824
    s_cselect_b32 s42, 1073741824, s42
    s_cmp_ge_u32 s31, 6
    s_cselect_b32 s60, 6, 7
    s_add_u32 s7, s3, s60
    s_sub_u32 s9, s34, s3
    s_mul_i32 s8, s31, 276480
    s_add_u32 s8, s8, 26853376
    s_mov_b32 s10, 0xffff0000
    s_mov_b32 s18, 29261824
    s_mov_b32 s19, 0x20000
    s_mov_b32 s26, 2621440
    s_mov_b32 s27, 0x20000
    s_mov_b32 s22, 256
    s_mov_b32 s23, 0x20000
    v_add_u32 v14, 81920, v1
    v_lshlrev_b32 v15, 31, v2
    v_mov_b32 v20, 0x3f803f80
    v_mov_b32 v21, 0x3f803f80
    v_mov_b32 v22, 0x3f803f80
    v_mov_b32 v23, 0x3f803f80
    v_and_b32 v11, 7, v2
    v_bfe_u32 v13, v11, 1, 1
    v_and_or_b32 v12, v11, 4, v13
    v_lshlrev_b32 v13, 1, v3
    v_xor_b32 v12, v12, v13
    v_lshlrev_b32 v12, 4, v12
    v_lshl_add_u32 v12, v11, 7, v12
    v_lshrrev_b32 v11, 3, v2
    v_lshl_add_u32 v12, v11, 10, v12
    v_add_u32 v16, s59, v12
    v_xor_b32 v17, 16, v16
    s_lshl_b32 s60, s33, 5
    s_and_b32 s61, s3, 1
    s_lshl_b32 s61, s61, 4
    s_add_u32 s60, s60, s61
    v_add_u32 v32, s60, v2
    v_mov_b32 v40, 320
    v_cmp_eq_u32 vcc, 0, v32
    s_nop 1
    v_cndmask_b32 v32, v32, v40, vcc
    v_cvt_f32_u32 v32, v32
    v_mul_f32 v32, 0x3acccccd, v32
    v_lshlrev_b32 v33, 4, v3
    s_lshl_b32 s60, s3, 10
    s_add_u32 s60, s60, 81920
    v_add_u32 v35, s60, v1
    s_cmp_ge_u32 s3, 2
    s_cselect_b32 s62, 0x3e800000, 0
    s_add_u32 s60, s6, 0
    s_cmp_ge_u32 s60, 10
    s_cselect_b32 s61, 10, 0
    s_sub_u32 s60, s60, s61
    s_lshl_b32 s60, s60, 6
    v_add_u32 v37, s60, v33
    v_cvt_f32_u32 v37, v37
    v_fma_f32 v37, v37, v32, s62
    v_fract_f32 v37, v37
    v_fmamk_f32 v49, v32, 0x3f800000, v37
    v_cos_f32 v48, v37
    v_cos_f32 v49, v49
    v_fmamk_f32 v50, v32, 0x40000000, v37
    v_fmamk_f32 v51, v32, 0x40400000, v37
    v_cos_f32 v50, v50
    v_cos_f32 v51, v51
    v_cvt_pk_bf16_f32 v40, v48, v49
    v_fmamk_f32 v48, v32, 0x40800000, v37
    v_fmamk_f32 v49, v32, 0x40a00000, v37
    v_cos_f32 v48, v48
    v_cos_f32 v49, v49
    v_cvt_pk_bf16_f32 v41, v50, v51
    v_fmamk_f32 v50, v32, 0x40c00000, v37
    v_fmamk_f32 v51, v32, 0x40e00000, v37
    v_cos_f32 v50, v50
    v_cos_f32 v51, v51
    v_cvt_pk_bf16_f32 v42, v48, v49
    v_cvt_pk_bf16_f32 v43, v50, v51
    ds_write_b128 v35, v[40:43] offset:0
    v_fmamk_f32 v48, v32, 0x41000000, v37
    v_fmamk_f32 v49, v32, 0x41100000, v37
    v_cos_f32 v48, v48
    v_cos_f32 v49, v49
    v_fmamk_f32 v50, v32, 0x41200000, v37
    v_fmamk_f32 v51, v32, 0x41300000, v37
    v_cos_f32 v50, v50
    v_cos_f32 v51, v51
    v_cvt_pk_bf16_f32 v44, v48, v49
    v_fmamk_f32 v48, v32, 0x41400000, v37
    v_fmamk_f32 v49, v32, 0x41500000, v37
    v_cos_f32 v48, v48
    v_cos_f32 v49, v49
    v_cvt_pk_bf16_f32 v45, v50, v51
    v_fmamk_f32 v50, v32, 0x41600000, v37
    v_fmamk_f32 v51, v32, 0x41700000, v37
    v_cos_f32 v50, v50
    v_cos_f32 v51, v51
    v_cvt_pk_bf16_f32 v46, v48, v49
    v_cvt_pk_bf16_f32 v47, v50, v51
    ds_write_b128 v35, v[44:47] offset:4096
    s_add_u32 s60, s6, 1
    s_cmp_ge_u32 s60, 10
    s_cselect_b32 s61, 10, 0
    s_sub_u32 s60, s60, s61
    s_lshl_b32 s60, s60, 6
    v_add_u32 v37, s60, v33
    v_cvt_f32_u32 v37, v37
    v_fma_f32 v37, v37, v32, s62
    v_fract_f32 v37, v37
    v_fmamk_f32 v49, v32, 0x3f800000, v37
    v_cos_f32 v48, v37
    v_cos_f32 v49, v49
    v_fmamk_f32 v50, v32, 0x40000000, v37
    v_fmamk_f32 v51, v32, 0x40400000, v37
    v_cos_f32 v50, v50
    v_cos_f32 v51, v51
    v_cvt_pk_bf16_f32 v40, v48, v49
    v_fmamk_f32 v48, v32, 0x40800000, v37
    v_fmamk_f32 v49, v32, 0x40a00000, v37
    v_cos_f32 v48, v48
    v_cos_f32 v49, v49
    v_cvt_pk_bf16_f32 v41, v50, v51
    v_fmamk_f32 v50, v32, 0x40c00000, v37
    v_fmamk_f32 v51, v32, 0x40e00000, v37
    v_cos_f32 v50, v50
    v_cos_f32 v51, v51
    v_cvt_pk_bf16_f32 v42, v48, v49
    v_cvt_pk_bf16_f32 v43, v50, v51
    ds_write_b128 v35, v[40:43] offset:8192
    v_fmamk_f32 v48, v32, 0x41000000, v37
    v_fmamk_f32 v49, v32, 0x41100000, v37
    v_cos_f32 v48, v48
    v_cos_f32 v49, v49
    v_fmamk_f32 v50, v32, 0x41200000, v37
    v_fmamk_f32 v51, v32, 0x41300000, v37
    v_cos_f32 v50, v50
    v_cos_f32 v51, v51
    v_cvt_pk_bf16_f32 v44, v48, v49
    v_fmamk_f32 v48, v32, 0x41400000, v37
    v_fmamk_f32 v49, v32, 0x41500000, v37
    v_cos_f32 v48, v48
    v_cos_f32 v49, v49
    v_cvt_pk_bf16_f32 v45, v50, v51
    v_fmamk_f32 v50, v32, 0x41600000, v37
    v_fmamk_f32 v51, v32, 0x41700000, v37
    v_cos_f32 v50, v50
    v_cos_f32 v51, v51
    v_cvt_pk_bf16_f32 v46, v48, v49
    v_cvt_pk_bf16_f32 v47, v50, v51
    ds_write_b128 v35, v[44:47] offset:12288
    s_add_u32 s60, s6, 2
    s_cmp_ge_u32 s60, 10
    s_cselect_b32 s61, 10, 0
    s_sub_u32 s60, s60, s61
    s_lshl_b32 s60, s60, 6
    v_add_u32 v37, s60, v33
    v_cvt_f32_u32 v37, v37
    v_fma_f32 v37, v37, v32, s62
    v_fract_f32 v37, v37
    v_fmamk_f32 v49, v32, 0x3f800000, v37
    v_cos_f32 v48, v37
    v_cos_f32 v49, v49
    v_fmamk_f32 v50, v32, 0x40000000, v37
    v_fmamk_f32 v51, v32, 0x40400000, v37
    v_cos_f32 v50, v50
    v_cos_f32 v51, v51
    v_cvt_pk_bf16_f32 v40, v48, v49
    v_fmamk_f32 v48, v32, 0x40800000, v37
    v_fmamk_f32 v49, v32, 0x40a00000, v37
    v_cos_f32 v48, v48
    v_cos_f32 v49, v49
    v_cvt_pk_bf16_f32 v41, v50, v51
    v_fmamk_f32 v50, v32, 0x40c00000, v37
    v_fmamk_f32 v51, v32, 0x40e00000, v37
    v_cos_f32 v50, v50
    v_cos_f32 v51, v51
    v_cvt_pk_bf16_f32 v42, v48, v49
    v_cvt_pk_bf16_f32 v43, v50, v51
    ds_write_b128 v35, v[40:43] offset:16384
    v_fmamk_f32 v48, v32, 0x41000000, v37
    v_fmamk_f32 v49, v32, 0x41100000, v37
    v_cos_f32 v48, v48
    v_cos_f32 v49, v49
    v_fmamk_f32 v50, v32, 0x41200000, v37
    v_fmamk_f32 v51, v32, 0x41300000, v37
    v_cos_f32 v50, v50
    v_cos_f32 v51, v51
    v_cvt_pk_bf16_f32 v44, v48, v49
    v_fmamk_f32 v48, v32, 0x41400000, v37
    v_fmamk_f32 v49, v32, 0x41500000, v37
    v_cos_f32 v48, v48
    v_cos_f32 v49, v49
    v_cvt_pk_bf16_f32 v45, v50, v51
    v_fmamk_f32 v50, v32, 0x41600000, v37
    v_fmamk_f32 v51, v32, 0x41700000, v37
    v_cos_f32 v50, v50
    v_cos_f32 v51, v51
    v_cvt_pk_bf16_f32 v46, v48, v49
    v_cvt_pk_bf16_f32 v47, v50, v51
    ds_write_b128 v35, v[44:47] offset:20480
    s_add_u32 s60, s6, 3
    s_cmp_ge_u32 s60, 10
    s_cselect_b32 s61, 10, 0
    s_sub_u32 s60, s60, s61
    s_lshl_b32 s60, s60, 6
    v_add_u32 v37, s60, v33
    v_cvt_f32_u32 v37, v37
    v_fma_f32 v37, v37, v32, s62
    v_fract_f32 v37, v37
    v_fmamk_f32 v49, v32, 0x3f800000, v37
    v_cos_f32 v48, v37
    v_cos_f32 v49, v49
    v_fmamk_f32 v50, v32, 0x40000000, v37
    v_fmamk_f32 v51, v32, 0x40400000, v37
    v_cos_f32 v50, v50
    v_cos_f32 v51, v51
    v_cvt_pk_bf16_f32 v40, v48, v49
    v_fmamk_f32 v48, v32, 0x40800000, v37
    v_fmamk_f32 v49, v32, 0x40a00000, v37
    v_cos_f32 v48, v48
    v_cos_f32 v49, v49
    v_cvt_pk_bf16_f32 v41, v50, v51
    v_fmamk_f32 v50, v32, 0x40c00000, v37
    v_fmamk_f32 v51, v32, 0x40e00000, v37
    v_cos_f32 v50, v50
    v_cos_f32 v51, v51
    v_cvt_pk_bf16_f32 v42, v48, v49
    v_cvt_pk_bf16_f32 v43, v50, v51
    ds_write_b128 v35, v[40:43] offset:24576
    v_fmamk_f32 v48, v32, 0x41000000, v37
    v_fmamk_f32 v49, v32, 0x41100000, v37
    v_cos_f32 v48, v48
    v_cos_f32 v49, v49
    v_fmamk_f32 v50, v32, 0x41200000, v37
    v_fmamk_f32 v51, v32, 0x41300000, v37
    v_cos_f32 v50, v50
    v_cos_f32 v51, v51
    v_cvt_pk_bf16_f32 v44, v48, v49
    v_fmamk_f32 v48, v32, 0x41400000, v37
    v_fmamk_f32 v49, v32, 0x41500000, v37
    v_cos_f32 v48, v48
    v_cos_f32 v49, v49
    v_cvt_pk_bf16_f32 v45, v50, v51
    v_fmamk_f32 v50, v32, 0x41600000, v37
    v_fmamk_f32 v51, v32, 0x41700000, v37
    v_cos_f32 v50, v50
    v_cos_f32 v51, v51
    v_cvt_pk_bf16_f32 v46, v48, v49
    v_cvt_pk_bf16_f32 v47, v50, v51
    ds_write_b128 v35, v[44:47] offset:28672
    s_add_u32 s60, s6, 4
    s_cmp_ge_u32 s60, 10
    s_cselect_b32 s61, 10, 0
    s_sub_u32 s60, s60, s61
    s_lshl_b32 s60, s60, 6
    v_add_u32 v37, s60, v33
    v_cvt_f32_u32 v37, v37
    v_fma_f32 v37, v37, v32, s62
    v_fract_f32 v37, v37
    v_fmamk_f32 v49, v32, 0x3f800000, v37
    v_cos_f32 v48, v37
    v_cos_f32 v49, v49
    v_fmamk_f32 v50, v32, 0x40000000, v37
    v_fmamk_f32 v51, v32, 0x40400000, v37
    v_cos_f32 v50, v50
    v_cos_f32 v51, v51
    v_cvt_pk_bf16_f32 v40, v48, v49
    v_fmamk_f32 v48, v32, 0x40800000, v37
    v_fmamk_f32 v49, v32, 0x40a00000, v37
    v_cos_f32 v48, v48
    v_cos_f32 v49, v49
    v_cvt_pk_bf16_f32 v41, v50, v51
    v_fmamk_f32 v50, v32, 0x40c00000, v37
    v_fmamk_f32 v51, v32, 0x40e00000, v37
    v_cos_f32 v50, v50
    v_cos_f32 v51, v51
    v_cvt_pk_bf16_f32 v42, v48, v49
    v_cvt_pk_bf16_f32 v43, v50, v51
    ds_write_b128 v35, v[40:43] offset:32768
    v_fmamk_f32 v48, v32, 0x41000000, v37
    v_fmamk_f32 v49, v32, 0x41100000, v37
    v_cos_f32 v48, v48
    v_cos_f32 v49, v49
    v_fmamk_f32 v50, v32, 0x41200000, v37
    v_fmamk_f32 v51, v32, 0x41300000, v37
    v_cos_f32 v50, v50
    v_cos_f32 v51, v51
    v_cvt_pk_bf16_f32 v44, v48, v49
    v_fmamk_f32 v48, v32, 0x41400000, v37
    v_fmamk_f32 v49, v32, 0x41500000, v37
    v_cos_f32 v48, v48
    v_cos_f32 v49, v49
    v_cvt_pk_bf16_f32 v45, v50, v51
    v_fmamk_f32 v50, v32, 0x41600000, v37
    v_fmamk_f32 v51, v32, 0x41700000, v37
    v_cos_f32 v50, v50
    v_cos_f32 v51, v51
    v_cvt_pk_bf16_f32 v46, v48, v49
    v_cvt_pk_bf16_f32 v47, v50, v51
    ds_write_b128 v35, v[44:47] offset:36864
    s_add_u32 s48, s6, 6
    s_cmp_ge_u32 s48, 10
    s_cselect_b32 s51, 10, 0
    s_sub_u32 s48, s48, s51
    s_lshl_b32 s48, s48, 7
    s_add_u32 s48, s48, s58
    s_add_u32 m0, s59, 4096
    s_add_u32 s49, s48, 0
    buffer_load_dwordx4 v10, s[12:15], s49 offen lds
    s_add_u32 m0, s59, 5120
    s_add_u32 s49, s48, 1310720
    buffer_load_dwordx4 v10, s[12:15], s49 offen lds
    s_add_u32 m0, s59, 6144
    s_add_u32 s49, s48, 20480
    buffer_load_dwordx4 v10, s[12:15], s49 offen lds
    s_add_u32 m0, s59, 7168
    s_add_u32 s49, s48, 1331200
    buffer_load_dwordx4 v10, s[12:15], s49 offen lds
    s_add_u32 s48, s6, 7
    s_cmp_ge_u32 s48, 10
    s_cselect_b32 s51, 10, 0
    s_sub_u32 s48, s48, s51
    s_lshl_b32 s48, s48, 7
    s_add_u32 s48, s48, s58
    s_add_u32 m0, s59, 8192
    s_add_u32 s49, s48, 0
    buffer_load_dwordx4 v10, s[12:15], s49 offen lds
    s_add_u32 m0, s59, 9216
    s_add_u32 s49, s48, 1310720
    buffer_load_dwordx4 v10, s[12:15], s49 offen lds
    s_add_u32 m0, s59, 10240
    s_add_u32 s49, s48, 20480
    buffer_load_dwordx4 v10, s[12:15], s49 offen lds
    s_add_u32 m0, s59, 11264
    s_add_u32 s49, s48, 1331200
    buffer_load_dwordx4 v10, s[12:15], s49 offen lds
    v_cvt_f32_u32 v24, v2
    v_mul_f32 v24, 0x3d800000, v24
    v_lshlrev_b32 v25, 2, v3
    v_cvt_f32_u32 v25, v25
    v_mul_f32 v25, v25, v24
    v_cos_f32 v184, v25
    v_sin_f32 v188, v25
    v_add_f32 v25, v25, v24
    v_cos_f32 v185, v25
    v_sin_f32 v189, v25
    v_add_f32 v25, v25, v24
    v_cos_f32 v186, v25
    v_sin_f32 v190, v25
    v_add_f32 v25, v25, v24
    v_cos_f32 v187, v25
    v_sin_f32 v191, v25
    s_lshl_b32 s63, s3, 2
    v_lshrrev_b32 v24, 1, v2
    v_lshlrev_b32 v24, 4, v24
    v_add_u32 v24, s63, v24
    v_cvt_f32_u32 v24, v24
    v_lshlrev_b32 v26, 5, v3
    v_add_u32 v26, s32, v26
    v_cvt_f32_u32 v26, v26
    v_mul_f32 v26, 0x3a000000, v26
    v_add_f32 v27, 0x3c000000, v26
    v_and_b32 v25, 1, v2
    v_cvt_f32_u32 v25, v25
    v_mul_f32 v25, 0x3e800000, v25
    v_fma_f32 v28, v24, v26, v25
    v_fma_f32 v29, v24, v27, v25
    v_cos_f32 v30, v28
    v_sin_f32 v31, v28
    s_nop 0
    v_cvt_pk_bf16_f32 v192, v30, v31
    v_cos_f32 v30, v29
    v_sin_f32 v31, v29
    s_nop 0
    v_cvt_pk_bf16_f32 v193, v30, v31
    v_add_f32 v28, v28, v26
    v_cos_f32 v30, v28
    v_sin_f32 v31, v28
    s_nop 0
    v_cvt_pk_bf16_f32 v194, v30, v31
    v_add_f32 v29, v29, v27
    v_cos_f32 v30, v29
    v_sin_f32 v31, v29
    s_nop 0
    v_cvt_pk_bf16_f32 v195, v30, v31
    v_add_f32 v28, v28, v26
    v_cos_f32 v30, v28
    v_sin_f32 v31, v28
    s_nop 0
    v_cvt_pk_bf16_f32 v196, v30, v31
    v_add_f32 v29, v29, v27
    v_cos_f32 v30, v29
    v_sin_f32 v31, v29
    s_nop 0
    v_cvt_pk_bf16_f32 v197, v30, v31
    v_add_f32 v28, v28, v26
    v_cos_f32 v30, v28
    v_sin_f32 v31, v28
    s_nop 0
    v_cvt_pk_bf16_f32 v198, v30, v31
    v_add_f32 v29, v29, v27
    v_cos_f32 v30, v29
    v_sin_f32 v31, v29
    s_nop 0
    v_cvt_pk_bf16_f32 v199, v30, v31
    s_waitcnt lgkmcnt(0)
    s_barrier
    s_waitcnt vmcnt(8)
    ds_read_b128 v[112:115], v16 offset:0
    ds_read_b128 v[116:119], v16 offset:2048
    ds_read_b128 v[80:83], v14 offset:0
    ds_read_b128 v[84:87], v14 offset:1024
    ds_read_b128 v[88:91], v14 offset:2048
    ds_read_b128 v[92:95], v14 offset:3072
    ds_read_b128 v[120:123], v17 offset:0
    ds_read_b128 v[124:127], v17 offset:2048
    ds_read_b128 v[96:99], v14 offset:4096
    ds_read_b128 v[100:103], v14 offset:5120
    ds_read_b128 v[104:107], v14 offset:6144
    ds_read_b128 v[108:111], v14 offset:7168
    s_waitcnt lgkmcnt(6)
    v_mfma_f32_16x16x32_bf16 v[64:67], v[112:115], v[112:115], 0
    s_waitcnt vmcnt(4)
    s_add_u32 s48, s6, 8
    v_mfma_f32_16x16x32_bf16 v[72:75], v[112:115], v[20:23], 0
    s_cmp_ge_u32 s48, 10
    s_cselect_b32 s51, 10, 0
    v_mfma_f32_16x16x32_bf16 v[32:35], v[112:115], v[80:83], 0
    ds_read_b128 v[128:131], v16 offset:4096
    s_sub_u32 s48, s48, s51
    v_mfma_f32_16x16x32_bf16 v[36:39], v[112:115], v[84:87], 0
    s_lshl_b32 s48, s48, 7
    s_add_u32 s48, s48, s58
    v_mfma_f32_16x16x32_bf16 v[40:43], v[112:115], v[88:91], 0
    ds_read_b128 v[132:135], v16 offset:6144
    ds_read_b128 v[212:215], v14 offset:8192
    v_mfma_f32_16x16x32_bf16 v[44:47], v[112:115], v[92:95], 0
    ds_read_b128 v[216:219], v14 offset:9216
    v_mfma_f32_16x16x32_bf16 v[68:71], v[116:119], v[116:119], 0
    ds_read_b128 v[220:223], v14 offset:10240
    v_mfma_f32_16x16x32_bf16 v[76:79], v[116:119], v[20:23], 0
    s_add_u32 m0, s59, 12288
    s_add_u32 s49, s48, 0
    buffer_load_dwordx4 v10, s[12:15], s49 offen lds
    v_mfma_f32_16x16x32_bf16 v[48:51], v[116:119], v[80:83], 0
    ds_read_b128 v[224:227], v14 offset:11264
    v_mfma_f32_16x16x32_bf16 v[52:55], v[116:119], v[84:87], 0
    s_add_u32 m0, s59, 13312
    s_add_u32 s49, s48, 1310720
    buffer_load_dwordx4 v10, s[12:15], s49 offen lds
    v_mfma_f32_16x16x32_bf16 v[56:59], v[116:119], v[88:91], 0
    v_mfma_f32_16x16x32_bf16 v[60:63], v[116:119], v[92:95], 0
    s_add_u32 m0, s59, 14336
    s_add_u32 s49, s48, 20480
    buffer_load_dwordx4 v10, s[12:15], s49 offen lds
    s_add_u32 m0, s59, 15360
    s_add_u32 s49, s48, 1331200
    buffer_load_dwordx4 v10, s[12:15], s49 offen lds
    s_waitcnt lgkmcnt(6)
    v_mfma_f32_16x16x32_bf16 v[64:67], v[120:123], v[120:123], v[64:67]
    ds_read_b128 v[136:139], v17 offset:4096
    s_add_u32 s48, s6, 9
    v_mfma_f32_16x16x32_bf16 v[72:75], v[120:123], v[20:23], v[72:75]
    s_cmp_ge_u32 s48, 10
    s_cselect_b32 s51, 10, 0
    v_mfma_f32_16x16x32_bf16 v[32:35], v[120:123], v[96:99], v[32:35]
    s_sub_u32 s48, s48, s51
    s_lshl_b32 s48, s48, 7
    s_add_u32 s48, s48, s58
    v_mfma_f32_16x16x32_bf16 v[36:39], v[120:123], v[100:103], v[36:39]
    ds_read_b128 v[140:143], v17 offset:6144
    ds_read_b128 v[228:231], v14 offset:12288
    v_mfma_f32_16x16x32_bf16 v[40:43], v[120:123], v[104:107], v[40:43]
    s_add_u32 m0, s59, 0
    s_add_u32 s49, s48, 0
    buffer_load_dwordx4 v10, s[12:15], s49 offen lds
    v_mfma_f32_16x16x32_bf16 v[44:47], v[120:123], v[108:111], v[44:47]
    s_add_u32 m0, s59, 1024
    s_add_u32 s49, s48, 1310720
    buffer_load_dwordx4 v10, s[12:15], s49 offen lds
    v_mfma_f32_16x16x32_bf16 v[68:71], v[124:127], v[124:127], v[68:71]
    s_add_u32 m0, s59, 2048
    s_add_u32 s49, s48, 20480
    buffer_load_dwordx4 v10, s[12:15], s49 offen lds
    v_mfma_f32_16x16x32_bf16 v[76:79], v[124:127], v[20:23], v[76:79]
    ds_read_b128 v[232:235], v14 offset:13312
    s_add_u32 m0, s59, 3072
    s_add_u32 s49, s48, 1331200
    buffer_load_dwordx4 v10, s[12:15], s49 offen lds
    v_mfma_f32_16x16x32_bf16 v[48:51], v[124:127], v[96:99], v[48:51]
    s_add_u32 s53, s6, 5
    ds_read_b128 v[236:239], v14 offset:14336
    s_cmp_ge_u32 s53, 10
    s_cselect_b32 s52, 10, 0
    v_mfma_f32_16x16x32_bf16 v[52:55], v[124:127], v[100:103], v[52:55]
    s_sub_u32 s53, s53, s52
    s_mul_i32 s52, s56, 20480
    s_lshl_b32 s53, s53, 11
    v_mfma_f32_16x16x32_bf16 v[56:59], v[124:127], v[104:107], v[56:59]
    s_add_u32 s52, s52, s53
    ds_read_b128 v[240:243], v14 offset:15360
    s_add_u32 s53, s52, 327680
    v_mfma_f32_16x16x32_bf16 v[60:63], v[124:127], v[108:111], v[60:63]
    buffer_store_dwordx4 v[112:115], v1, s[16:19], s52 offen sc1
    buffer_store_dwordx4 v[116:119], v1, s[16:19], s53 offen sc1
    buffer_store_dwordx4 v[120:123], v1, s[16:19], s52 offen offset:1024 sc1
    buffer_store_dwordx4 v[124:127], v1, s[16:19], s53 offen offset:1024 sc1
    s_waitcnt lgkmcnt(6)
    v_mfma_f32_16x16x32_bf16 v[64:67], v[128:131], v[128:131], v[64:67]
    s_waitcnt vmcnt(12)
    ds_read_b128 v[144:147], v16 offset:8192
    v_mfma_f32_16x16x32_bf16 v[72:75], v[128:131], v[20:23], v[72:75]
    ds_read_b128 v[148:151], v16 offset:10240
    v_mfma_f32_16x16x32_bf16 v[32:35], v[128:131], v[212:215], v[32:35]
    v_mfma_f32_16x16x32_bf16 v[36:39], v[128:131], v[216:219], v[36:39]
    ds_read_b128 v[80:83], v14 offset:16384
    v_mfma_f32_16x16x32_bf16 v[40:43], v[128:131], v[220:223], v[40:43]
    ds_read_b128 v[84:87], v14 offset:17408
    v_mfma_f32_16x16x32_bf16 v[44:47], v[128:131], v[224:227], v[44:47]
    v_mfma_f32_16x16x32_bf16 v[68:71], v[132:135], v[132:135], v[68:71]
    ds_read_b128 v[88:91], v14 offset:18432
    v_mfma_f32_16x16x32_bf16 v[76:79], v[132:135], v[20:23], v[76:79]
    ds_read_b128 v[92:95], v14 offset:19456
    v_mfma_f32_16x16x32_bf16 v[48:51], v[132:135], v[212:215], v[48:51]
    v_mfma_f32_16x16x32_bf16 v[52:55], v[132:135], v[216:219], v[52:55]
    v_mfma_f32_16x16x32_bf16 v[56:59], v[132:135], v[220:223], v[56:59]
    v_mfma_f32_16x16x32_bf16 v[60:63], v[132:135], v[224:227], v[60:63]
    s_waitcnt lgkmcnt(6)
    v_mfma_f32_16x16x32_bf16 v[64:67], v[136:139], v[136:139], v[64:67]
    ds_read_b128 v[152:155], v17 offset:8192
    s_add_u32 s48, s6, 0
    v_mfma_f32_16x16x32_bf16 v[72:75], v[136:139], v[20:23], v[72:75]
    s_cmp_ge_u32 s48, 10
    s_cselect_b32 s51, 10, 0
    v_mfma_f32_16x16x32_bf16 v[32:35], v[136:139], v[228:231], v[32:35]
    s_sub_u32 s48, s48, s51
    ds_read_b128 v[156:159], v17 offset:10240
    v_mfma_f32_16x16x32_bf16 v[36:39], v[136:139], v[232:235], v[36:39]
    s_lshl_b32 s48, s48, 7
    s_add_u32 s48, s48, s58
    v_mfma_f32_16x16x32_bf16 v[40:43], v[136:139], v[236:239], v[40:43]
    ds_read_b128 v[96:99], v14 offset:20480
    ds_read_b128 v[100:103], v14 offset:21504
    v_mfma_f32_16x16x32_bf16 v[44:47], v[136:139], v[240:243], v[44:47]
    ds_read_b128 v[104:107], v14 offset:22528
    v_mfma_f32_16x16x32_bf16 v[68:71], v[140:143], v[140:143], v[68:71]
    v_mfma_f32_16x16x32_bf16 v[76:79], v[140:143], v[20:23], v[76:79]
    s_add_u32 m0, s59, 4096
    s_add_u32 s49, s48, 0
    buffer_load_dwordx4 v10, s[12:15], s49 offen lds
    v_mfma_f32_16x16x32_bf16 v[48:51], v[140:143], v[228:231], v[48:51]
    ds_read_b128 v[108:111], v14 offset:23552
    v_mfma_f32_16x16x32_bf16 v[52:55], v[140:143], v[232:235], v[52:55]
    s_add_u32 m0, s59, 5120
    s_add_u32 s49, s48, 1310720
    buffer_load_dwordx4 v10, s[12:15], s49 offen lds
    v_mfma_f32_16x16x32_bf16 v[56:59], v[140:143], v[236:239], v[56:59]
    v_mfma_f32_16x16x32_bf16 v[60:63], v[140:143], v[240:243], v[60:63]
    s_add_u32 m0, s59, 6144
    s_add_u32 s49, s48, 20480
    buffer_load_dwordx4 v10, s[12:15], s49 offen lds
    s_add_u32 m0, s59, 7168
    s_add_u32 s49, s48, 1331200
    buffer_load_dwordx4 v10, s[12:15], s49 offen lds
    s_waitcnt lgkmcnt(6)
    v_mfma_f32_16x16x32_bf16 v[64:67], v[144:147], v[144:147], v[64:67]
    s_waitcnt vmcnt(12)
    ds_read_b128 v[160:163], v16 offset:12288
    v_mfma_f32_16x16x32_bf16 v[72:75], v[144:147], v[20:23], v[72:75]
    ds_read_b128 v[164:167], v16 offset:14336
    v_mfma_f32_16x16x32_bf16 v[32:35], v[144:147], v[80:83], v[32:35]
    v_mfma_f32_16x16x32_bf16 v[36:39], v[144:147], v[84:87], v[36:39]
    ds_read_b128 v[212:215], v14 offset:24576
    v_mfma_f32_16x16x32_bf16 v[40:43], v[144:147], v[88:91], v[40:43]
    ds_read_b128 v[216:219], v14 offset:25600
    v_mfma_f32_16x16x32_bf16 v[44:47], v[144:147], v[92:95], v[44:47]
    v_mfma_f32_16x16x32_bf16 v[68:71], v[148:151], v[148:151], v[68:71]
    ds_read_b128 v[220:223], v14 offset:26624
    v_mfma_f32_16x16x32_bf16 v[76:79], v[148:151], v[20:23], v[76:79]
    ds_read_b128 v[224:227], v14 offset:27648
    v_mfma_f32_16x16x32_bf16 v[48:51], v[148:151], v[80:83], v[48:51]
    v_mfma_f32_16x16x32_bf16 v[52:55], v[148:151], v[84:87], v[52:55]
    v_mfma_f32_16x16x32_bf16 v[56:59], v[148:151], v[88:91], v[56:59]
    v_mfma_f32_16x16x32_bf16 v[60:63], v[148:151], v[92:95], v[60:63]
    s_waitcnt lgkmcnt(6)
    v_mfma_f32_16x16x32_bf16 v[64:67], v[152:155], v[152:155], v[64:67]
    ds_read_b128 v[168:171], v17 offset:12288
    s_add_u32 s48, s6, 1
    v_mfma_f32_16x16x32_bf16 v[72:75], v[152:155], v[20:23], v[72:75]
    s_cmp_ge_u32 s48, 10
    s_cselect_b32 s51, 10, 0
    v_mfma_f32_16x16x32_bf16 v[32:35], v[152:155], v[96:99], v[32:35]
    s_sub_u32 s48, s48, s51
    ds_read_b128 v[172:175], v17 offset:14336
    v_mfma_f32_16x16x32_bf16 v[36:39], v[152:155], v[100:103], v[36:39]
    s_lshl_b32 s48, s48, 7
    s_add_u32 s48, s48, s58
    v_mfma_f32_16x16x32_bf16 v[40:43], v[152:155], v[104:107], v[40:43]
    ds_read_b128 v[228:231], v14 offset:28672
    ds_read_b128 v[232:235], v14 offset:29696
    v_mfma_f32_16x16x32_bf16 v[44:47], v[152:155], v[108:111], v[44:47]
    ds_read_b128 v[236:239], v14 offset:30720
    v_mfma_f32_16x16x32_bf16 v[68:71], v[156:159], v[156:159], v[68:71]
    s_add_u32 m0, s59, 8192
    s_add_u32 s49, s48, 0
    buffer_load_dwordx4 v10, s[12:15], s49 offen lds
    v_mfma_f32_16x16x32_bf16 v[76:79], v[156:159], v[20:23], v[76:79]
    ds_read_b128 v[240:243], v14 offset:31744
    v_mfma_f32_16x16x32_bf16 v[48:51], v[156:159], v[96:99], v[48:51]
    s_add_u32 m0, s59, 9216
    s_add_u32 s49, s48, 1310720
    buffer_load_dwordx4 v10, s[12:15], s49 offen lds
    v_mfma_f32_16x16x32_bf16 v[52:55], v[156:159], v[100:103], v[52:55]
    v_mfma_f32_16x16x32_bf16 v[56:59], v[156:159], v[104:107], v[56:59]
    s_add_u32 m0, s59, 10240
    s_add_u32 s49, s48, 20480
    buffer_load_dwordx4 v10, s[12:15], s49 offen lds
    v_mfma_f32_16x16x32_bf16 v[60:63], v[156:159], v[108:111], v[60:63]
    s_add_u32 m0, s59, 11264
    s_add_u32 s49, s48, 1331200
    buffer_load_dwordx4 v10, s[12:15], s49 offen lds
    v_mov_b32 v251, 0
    buffer_load_dwordx2 v[248:249], v251, s[20:23], 0 offen sc1
    s_waitcnt lgkmcnt(6)
    v_mfma_f32_16x16x32_bf16 v[64:67], v[160:163], v[160:163], v[64:67]
    s_waitcnt vmcnt(13)
    ds_read_b128 v[112:115], v16 offset:0
    v_mfma_f32_16x16x32_bf16 v[72:75], v[160:163], v[20:23], v[72:75]
    ds_read_b128 v[116:119], v16 offset:2048
    v_mfma_f32_16x16x32_bf16 v[32:35], v[160:163], v[212:215], v[32:35]
    v_mfma_f32_16x16x32_bf16 v[36:39], v[160:163], v[216:219], v[36:39]
    ds_read_b128 v[80:83], v14 offset:32768
    v_mfma_f32_16x16x32_bf16 v[40:43], v[160:163], v[220:223], v[40:43]
    ds_read_b128 v[84:87], v14 offset:33792
    v_mfma_f32_16x16x32_bf16 v[44:47], v[160:163], v[224:227], v[44:47]
    v_mfma_f32_16x16x32_bf16 v[68:71], v[164:167], v[164:167], v[68:71]
    ds_read_b128 v[88:91], v14 offset:34816
    v_mfma_f32_16x16x32_bf16 v[76:79], v[164:167], v[20:23], v[76:79]
    ds_read_b128 v[92:95], v14 offset:35840
    v_mfma_f32_16x16x32_bf16 v[48:51], v[164:167], v[212:215], v[48:51]
    v_mfma_f32_16x16x32_bf16 v[52:55], v[164:167], v[216:219], v[52:55]
    v_mfma_f32_16x16x32_bf16 v[56:59], v[164:167], v[220:223], v[56:59]
    v_mfma_f32_16x16x32_bf16 v[60:63], v[164:167], v[224:227], v[60:63]
    s_waitcnt lgkmcnt(6)
    v_mfma_f32_16x16x32_bf16 v[64:67], v[168:171], v[168:171], v[64:67]
    ds_read_b128 v[120:123], v17 offset:0
    s_add_u32 s48, s6, 2
    v_mfma_f32_16x16x32_bf16 v[72:75], v[168:171], v[20:23], v[72:75]
    s_cmp_ge_u32 s48, 10
    s_cselect_b32 s51, 10, 0
    v_mfma_f32_16x16x32_bf16 v[32:35], v[168:171], v[228:231], v[32:35]
    s_sub_u32 s48, s48, s51
    ds_read_b128 v[124:127], v17 offset:2048
    v_mfma_f32_16x16x32_bf16 v[36:39], v[168:171], v[232:235], v[36:39]
    s_lshl_b32 s48, s48, 7
    s_add_u32 s48, s48, s58
    v_mfma_f32_16x16x32_bf16 v[40:43], v[168:171], v[236:239], v[40:43]
    ds_read_b128 v[96:99], v14 offset:36864
    ds_read_b128 v[100:103], v14 offset:37888
    v_mfma_f32_16x16x32_bf16 v[44:47], v[168:171], v[240:243], v[44:47]
    ds_read_b128 v[104:107], v14 offset:38912
    v_mfma_f32_16x16x32_bf16 v[68:71], v[172:175], v[172:175], v[68:71]
    v_mfma_f32_16x16x32_bf16 v[76:79], v[172:175], v[20:23], v[76:79]
    s_add_u32 m0, s59, 12288
    s_add_u32 s49, s48, 0
    buffer_load_dwordx4 v10, s[12:15], s49 offen lds
    v_mfma_f32_16x16x32_bf16 v[48:51], v[172:175], v[228:231], v[48:51]
    ds_read_b128 v[108:111], v14 offset:39936
    v_mfma_f32_16x16x32_bf16 v[52:55], v[172:175], v[232:235], v[52:55]
    s_add_u32 m0, s59, 13312
    s_add_u32 s49, s48, 1310720
    buffer_load_dwordx4 v10, s[12:15], s49 offen lds
    v_mfma_f32_16x16x32_bf16 v[56:59], v[172:175], v[236:239], v[56:59]
    v_mfma_f32_16x16x32_bf16 v[60:63], v[172:175], v[240:243], v[60:63]
    s_add_u32 m0, s59, 14336
    s_add_u32 s49, s48, 20480
    buffer_load_dwordx4 v10, s[12:15], s49 offen lds
    s_add_u32 m0, s59, 15360
    s_add_u32 s49, s48, 1331200
    buffer_load_dwordx4 v10, s[12:15], s49 offen lds
    s_waitcnt lgkmcnt(6)
    v_mfma_f32_16x16x32_bf16 v[64:67], v[112:115], v[112:115], v[64:67]
    s_waitcnt vmcnt(9)
    ds_read_b128 v[128:131], v16 offset:4096
    v_mfma_f32_16x16x32_bf16 v[72:75], v[112:115], v[20:23], v[72:75]
    ds_read_b128 v[132:135], v16 offset:6144
    v_mfma_f32_16x16x32_bf16 v[32:35], v[112:115], v[80:83], v[32:35]
    v_mfma_f32_16x16x32_bf16 v[36:39], v[112:115], v[84:87], v[36:39]
    ds_read_b128 v[212:215], v14 offset:0
    v_mfma_f32_16x16x32_bf16 v[40:43], v[112:115], v[88:91], v[40:43]
    ds_read_b128 v[216:219], v14 offset:1024
    v_mfma_f32_16x16x32_bf16 v[44:47], v[112:115], v[92:95], v[44:47]
    v_mfma_f32_16x16x32_bf16 v[68:71], v[116:119], v[116:119], v[68:71]
    ds_read_b128 v[220:223], v14 offset:2048
    v_mfma_f32_16x16x32_bf16 v[76:79], v[116:119], v[20:23], v[76:79]
    ds_read_b128 v[224:227], v14 offset:3072
    v_mfma_f32_16x16x32_bf16 v[48:51], v[116:119], v[80:83], v[48:51]
    v_mfma_f32_16x16x32_bf16 v[52:55], v[116:119], v[84:87], v[52:55]
    v_mfma_f32_16x16x32_bf16 v[56:59], v[116:119], v[88:91], v[56:59]
    v_mfma_f32_16x16x32_bf16 v[60:63], v[116:119], v[92:95], v[60:63]
    s_waitcnt lgkmcnt(6)
    v_mfma_f32_16x16x32_bf16 v[64:67], v[120:123], v[120:123], v[64:67]
    ds_read_b128 v[136:139], v17 offset:4096
    s_add_u32 s48, s6, 3
    v_mfma_f32_16x16x32_bf16 v[72:75], v[120:123], v[20:23], v[72:75]
    s_cmp_ge_u32 s48, 10
    s_cselect_b32 s51, 10, 0
    s_sub_u32 s48, s48, s51
    v_mfma_f32_16x16x32_bf16 v[32:35], v[120:123], v[96:99], v[32:35]
    s_lshl_b32 s48, s48, 7
    s_add_u32 s48, s48, s58
    v_mfma_f32_16x16x32_bf16 v[36:39], v[120:123], v[100:103], v[36:39]
    ds_read_b128 v[140:143], v17 offset:6144
    s_add_u32 m0, s59, 0
    s_add_u32 s49, s48, 0
    buffer_load_dwordx4 v10, s[12:15], s49 offen lds
    v_mfma_f32_16x16x32_bf16 v[40:43], v[120:123], v[104:107], v[40:43]
    s_add_u32 m0, s59, 1024
    s_add_u32 s49, s48, 1310720
    buffer_load_dwordx4 v10, s[12:15], s49 offen lds
    v_mfma_f32_16x16x32_bf16 v[44:47], v[120:123], v[108:111], v[44:47]
    ds_read_b128 v[228:231], v14 offset:4096
    s_add_u32 m0, s59, 2048
    s_add_u32 s49, s48, 20480
    buffer_load_dwordx4 v10, s[12:15], s49 offen lds
    v_mfma_f32_16x16x32_bf16 v[68:71], v[124:127], v[124:127], v[68:71]
    s_add_u32 m0, s59, 3072
    s_add_u32 s49, s48, 1331200
    buffer_load_dwordx4 v10, s[12:15], s49 offen lds
    s_waitcnt vmcnt(8)
    v_mfma_f32_16x16x32_bf16 v[76:79], v[124:127], v[20:23], v[76:79]
    ds_read_b128 v[232:235], v14 offset:5120
    ds_read_b128 v[236:239], v14 offset:6144
    v_mfma_f32_16x16x32_bf16 v[48:51], v[124:127], v[96:99], v[48:51]
    v_xor_b32 v32, v15, v32
    v_xor_b32 v33, v15, v33
    v_mfma_f32_16x16x32_bf16 v[52:55], v[124:127], v[100:103], v[52:55]
    v_xor_b32 v34, v15, v34
    v_xor_b32 v35, v15, v35
    v_xor_b32 v36, v15, v36
    v_mfma_f32_16x16x32_bf16 v[56:59], v[124:127], v[104:107], v[56:59]
    s_mov_b32 s55, 0
    v_mov_b32 v251, 0
tloop_m_14:
    v_readfirstlane_b32 s47, v248
    v_readfirstlane_b32 s46, v249
    s_nop 1
    s_cmp_lg_u32 s47, 0
    s_cbranch_scc1 tskip_m_13
    s_cmp_ge_u32 s55, 200000
    s_cbranch_scc1 tskip_m_13
    s_sleep 8
    buffer_load_dwordx2 v[248:249], v251, s[20:23], 0 offen sc1
    s_add_u32 s55, s55, 1
    s_waitcnt vmcnt(0)
    s_branch tloop_m_14
tskip_m_13:
    v_xor_b32 v37, v15, v37
    v_xor_b32 v38, v15, v38
    v_xor_b32 v39, v15, v39
    v_xor_b32 v40, v15, v40
    v_mfma_f32_16x16x32_bf16 v[60:63], v[124:127], v[108:111], v[60:63]
    s_add_u32 s55, s47, 1
    v_mov_b32 v250, s55
    v_mov_b32 v251, s46
    v_lshlrev_b32 v252, 25, v0
    v_xor_b32 v41, v15, v41
    v_xor_b32 v42, v15, v42
    v_xor_b32 v43, v15, v43
    v_xor_b32 v44, v15, v44
    v_xor_b32 v45, v15, v45
    v_xor_b32 v46, v15, v46
    v_xor_b32 v47, v15, v47
    ds_read_b128 v[240:243], v14 offset:7168
    s_barrier
    buffer_store_dwordx2 v[250:251], v252, s[16:19], s43 offen sc0 sc1
    s_waitcnt lgkmcnt(6)
    v_mfma_f32_16x16x32_bf16 v[64:67], v[128:131], v[128:131], v[64:67]
    s_waitcnt vmcnt(10)
    ds_read_b128 v[144:147], v16 offset:8192
    v_mfma_f32_16x16x32_bf16 v[72:75], v[128:131], v[20:23], v[72:75]
    v_xor_b32 v48, v15, v48
    v_xor_b32 v49, v15, v49
    v_mfma_f32_16x16x32_bf16 v[32:35], v[128:131], v[212:215], v[32:35]
    v_xor_b32 v50, v15, v50
    v_xor_b32 v51, v15, v51
    v_mfma_f32_16x16x32_bf16 v[36:39], v[128:131], v[216:219], v[36:39]
    v_xor_b32 v52, v15, v52
    v_xor_b32 v53, v15, v53
    v_mfma_f32_16x16x32_bf16 v[40:43], v[128:131], v[220:223], v[40:43]
    v_xor_b32 v54, v15, v54
    v_xor_b32 v55, v15, v55
    v_xor_b32 v56, v15, v56
    v_mfma_f32_16x16x32_bf16 v[44:47], v[128:131], v[224:227], v[44:47]
    v_xor_b32 v57, v15, v57
    v_xor_b32 v58, v15, v58
    v_xor_b32 v59, v15, v59
    v_xor_b32 v60, v15, v60
    v_xor_b32 v61, v15, v61
    v_xor_b32 v62, v15, v62
    v_xor_b32 v63, v15, v63
    v_mfma_f32_16x16x32_bf16 v[68:71], v[132:135], v[132:135], v[68:71]
    ds_read_b128 v[148:151], v16 offset:10240
    ds_read_b128 v[80:83], v14 offset:8192
    v_mfma_f32_16x16x32_bf16 v[76:79], v[132:135], v[20:23], v[76:79]
    ds_read_b128 v[84:87], v14 offset:9216
    ds_read_b128 v[88:91], v14 offset:10240
    v_mfma_f32_16x16x32_bf16 v[48:51], v[132:135], v[212:215], v[48:51]
    ds_read_b128 v[92:95], v14 offset:11264
    v_mfma_f32_16x16x32_bf16 v[52:55], v[132:135], v[216:219], v[52:55]
    v_mfma_f32_16x16x32_bf16 v[56:59], v[132:135], v[220:223], v[56:59]
    v_mfma_f32_16x16x32_bf16 v[60:63], v[132:135], v[224:227], v[60:63]
    s_waitcnt lgkmcnt(6)
    v_mfma_f32_16x16x32_bf16 v[64:67], v[136:139], v[136:139], v[64:67]
    ds_read_b128 v[152:155], v17 offset:8192
    s_add_u32 s48, s6, 4
    v_mfma_f32_16x16x32_bf16 v[72:75], v[136:139], v[20:23], v[72:75]
    s_cmp_ge_u32 s48, 10
    s_cselect_b32 s51, 10, 0
    v_mfma_f32_16x16x32_bf16 v[32:35], v[136:139], v[228:231], v[32:35]
    s_sub_u32 s48, s48, s51
    ds_read_b128 v[156:159], v17 offset:10240
    v_mfma_f32_16x16x32_bf16 v[36:39], v[136:139], v[232:235], v[36:39]
    s_lshl_b32 s48, s48, 7
    s_add_u32 s48, s48, s58
    v_mfma_f32_16x16x32_bf16 v[40:43], v[136:139], v[236:239], v[40:43]
    ds_read_b128 v[96:99], v14 offset:12288
    ds_read_b128 v[100:103], v14 offset:13312
    v_mfma_f32_16x16x32_bf16 v[44:47], v[136:139], v[240:243], v[44:47]
    ds_read_b128 v[104:107], v14 offset:14336
    v_mfma_f32_16x16x32_bf16 v[68:71], v[140:143], v[140:143], v[68:71]
    v_mfma_f32_16x16x32_bf16 v[76:79], v[140:143], v[20:23], v[76:79]
    s_add_u32 m0, s59, 4096
    s_add_u32 s49, s48, 0
    buffer_load_dwordx4 v10, s[12:15], s49 offen lds
    v_mfma_f32_16x16x32_bf16 v[48:51], v[140:143], v[228:231], v[48:51]
    ds_read_b128 v[108:111], v14 offset:15360
    v_mfma_f32_16x16x32_bf16 v[52:55], v[140:143], v[232:235], v[52:55]
    s_add_u32 m0, s59, 5120
    s_add_u32 s49, s48, 1310720
    buffer_load_dwordx4 v10, s[12:15], s49 offen lds
    v_mfma_f32_16x16x32_bf16 v[56:59], v[140:143], v[236:239], v[56:59]
    v_mfma_f32_16x16x32_bf16 v[60:63], v[140:143], v[240:243], v[60:63]
    s_add_u32 m0, s59, 6144
    s_add_u32 s49, s48, 20480
    buffer_load_dwordx4 v10, s[12:15], s49 offen lds
    s_add_u32 m0, s59, 7168
    s_add_u32 s49, s48, 1331200
    buffer_load_dwordx4 v10, s[12:15], s49 offen lds
    s_waitcnt lgkmcnt(6)
    v_mfma_f32_16x16x32_bf16 v[64:67], v[144:147], v[144:147], v[64:67]
    s_waitcnt vmcnt(9)
    v_mul_u32_u24 v18, 20480, v4
    v_mfma_f32_16x16x32_bf16 v[72:75], v[144:147], v[20:23], v[72:75]
    v_lshl_add_u32 v18, v5, 4, v18
    v_mov_b32 v176, -1
    v_mfma_f32_16x16x32_bf16 v[32:35], v[144:147], v[80:83], v[32:35]
    ds_read_b128 v[160:163], v16 offset:12288
    v_mov_b32 v177, -1
    v_mfma_f32_16x16x32_bf16 v[36:39], v[144:147], v[84:87], v[36:39]
    v_mov_b32 v178, -1
    v_mov_b32 v179, -1
    v_mfma_f32_16x16x32_bf16 v[40:43], v[144:147], v[88:91], v[40:43]
    ds_read_b128 v[164:167], v16 offset:14336
    s_mul_i32 s60, s32, 1280
    v_mfma_f32_16x16x32_bf16 v[44:47], v[144:147], v[92:95], v[44:47]
    s_lshl_b32 s61, s33, 7
    s_add_u32 s60, s60, s61
    v_mfma_f32_16x16x32_bf16 v[68:71], v[148:151], v[148:151], v[68:71]
    ds_read_b128 v[212:215], v14 offset:16384
    s_mul_i32 s61, s3, 655360
    v_mfma_f32_16x16x32_bf16 v[76:79], v[148:151], v[20:23], v[76:79]
    s_add_u32 s60, s60, s61
    s_add_u32 s61, s60, 5242880
    v_mfma_f32_16x16x32_bf16 v[48:51], v[148:151], v[80:83], v[48:51]
    ds_read_b128 v[216:219], v14 offset:17408
    buffer_store_dwordx4 v[176:179], v18, s[16:19], s61 offen sc1
    v_mfma_f32_16x16x32_bf16 v[52:55], v[148:151], v[84:87], v[52:55]
    s_add_u32 s61, s60, 5406720
    ds_read_b128 v[220:223], v14 offset:18432
    v_mfma_f32_16x16x32_bf16 v[56:59], v[148:151], v[88:91], v[56:59]
    buffer_store_dwordx4 v[176:179], v18, s[16:19], s61 offen sc1
    s_add_u32 s61, s60, 5570560
    v_mfma_f32_16x16x32_bf16 v[60:63], v[148:151], v[92:95], v[60:63]
    buffer_store_dwordx4 v[176:179], v18, s[16:19], s61 offen sc1
    ds_read_b128 v[224:227], v14 offset:19456
    s_add_u32 s61, s60, 5734400
    buffer_store_dwordx4 v[176:179], v18, s[16:19], s61 offen sc1
    s_waitcnt lgkmcnt(6)
    v_mfma_f32_16x16x32_bf16 v[64:67], v[152:155], v[152:155], v[64:67]
    ds_read_b128 v[168:171], v17 offset:12288
    ds_read_b128 v[172:175], v17 offset:14336
    v_mfma_f32_16x16x32_bf16 v[72:75], v[152:155], v[20:23], v[72:75]
    ds_read_b128 v[228:231], v14 offset:20480
    v_mfma_f32_16x16x32_bf16 v[32:35], v[152:155], v[96:99], v[32:35]
    v_mfma_f32_16x16x32_bf16 v[36:39], v[152:155], v[100:103], v[36:39]
    ds_read_b128 v[232:235], v14 offset:21504
    v_mfma_f32_16x16x32_bf16 v[40:43], v[152:155], v[104:107], v[40:43]
    v_mfma_f32_16x16x32_bf16 v[44:47], v[152:155], v[108:111], v[44:47]
    ds_read_b128 v[236:239], v14 offset:22528
    v_mfma_f32_16x16x32_bf16 v[68:71], v[156:159], v[156:159], v[68:71]
    v_mfma_f32_16x16x32_bf16 v[76:79], v[156:159], v[20:23], v[76:79]
    ds_read_b128 v[240:243], v14 offset:23552
    v_mfma_f32_16x16x32_bf16 v[48:51], v[156:159], v[96:99], v[48:51]
    v_mfma_f32_16x16x32_bf16 v[52:55], v[156:159], v[100:103], v[52:55]
    v_mfma_f32_16x16x32_bf16 v[56:59], v[156:159], v[104:107], v[56:59]
    v_mfma_f32_16x16x32_bf16 v[60:63], v[156:159], v[108:111], v[60:63]
    s_waitcnt lgkmcnt(6)
    v_mfma_f32_16x16x32_bf16 v[64:67], v[160:163], v[160:163], v[64:67]
    s_waitcnt vmcnt(9)
    ds_read_b128 v[112:115], v16 offset:0
    v_mfma_f32_16x16x32_bf16 v[72:75], v[160:163], v[20:23], v[72:75]
    ds_read_b128 v[116:119], v16 offset:2048
    v_mfma_f32_16x16x32_bf16 v[32:35], v[160:163], v[212:215], v[32:35]
    v_mfma_f32_16x16x32_bf16 v[36:39], v[160:163], v[216:219], v[36:39]
    ds_read_b128 v[80:83], v14 offset:24576
    v_mfma_f32_16x16x32_bf16 v[40:43], v[160:163], v[220:223], v[40:43]
    ds_read_b128 v[84:87], v14 offset:25600
    v_mfma_f32_16x16x32_bf16 v[44:47], v[160:163], v[224:227], v[44:47]
    v_mfma_f32_16x16x32_bf16 v[68:71], v[164:167], v[164:167], v[68:71]
    ds_read_b128 v[88:91], v14 offset:26624
    v_mfma_f32_16x16x32_bf16 v[76:79], v[164:167], v[20:23], v[76:79]
    ds_read_b128 v[92:95], v14 offset:27648
    v_mfma_f32_16x16x32_bf16 v[48:51], v[164:167], v[212:215], v[48:51]
    v_mfma_f32_16x16x32_bf16 v[52:55], v[164:167], v[216:219], v[52:55]
    v_mfma_f32_16x16x32_bf16 v[56:59], v[164:167], v[220:223], v[56:59]
    v_mfma_f32_16x16x32_bf16 v[60:63], v[164:167], v[224:227], v[60:63]
    s_waitcnt lgkmcnt(6)
    v_mfma_f32_16x16x32_bf16 v[64:67], v[168:171], v[168:171], v[64:67]
    ds_read_b128 v[120:123], v17 offset:0
    ds_read_b128 v[124:127], v17 offset:2048
    v_mfma_f32_16x16x32_bf16 v[72:75], v[168:171], v[20:23], v[72:75]
    ds_read_b128 v[96:99], v14 offset:28672
    v_mfma_f32_16x16x32_bf16 v[32:35], v[168:171], v[228:231], v[32:35]
    v_mfma_f32_16x16x32_bf16 v[36:39], v[168:171], v[232:235], v[36:39]
    ds_read_b128 v[100:103], v14 offset:29696
    v_mfma_f32_16x16x32_bf16 v[40:43], v[168:171], v[236:239], v[40:43]
    v_mfma_f32_16x16x32_bf16 v[44:47], v[168:171], v[240:243], v[44:47]
    ds_read_b128 v[104:107], v14 offset:30720
    v_mfma_f32_16x16x32_bf16 v[68:71], v[172:175], v[172:175], v[68:71]
    v_mfma_f32_16x16x32_bf16 v[76:79], v[172:175], v[20:23], v[76:79]
    ds_read_b128 v[108:111], v14 offset:31744
    v_mfma_f32_16x16x32_bf16 v[48:51], v[172:175], v[228:231], v[48:51]
    v_mfma_f32_16x16x32_bf16 v[52:55], v[172:175], v[232:235], v[52:55]
    v_mfma_f32_16x16x32_bf16 v[56:59], v[172:175], v[236:239], v[56:59]
    v_mfma_f32_16x16x32_bf16 v[60:63], v[172:175], v[240:243], v[60:63]
    s_waitcnt lgkmcnt(6)
    v_mfma_f32_16x16x32_bf16 v[64:67], v[112:115], v[112:115], v[64:67]
    s_waitcnt vmcnt(4)
    v_min_u32 v19, 19, v0
    v_mfma_f32_16x16x32_bf16 v[72:75], v[112:115], v[20:23], v[72:75]
    ds_read_b128 v[128:131], v16 offset:4096
    v_lshlrev_b32 v19, 10, v19
    v_mfma_f32_16x16x32_bf16 v[32:35], v[112:115], v[80:83], v[32:35]
    ds_read_b128 v[132:135], v16 offset:6144
    v_mfma_f32_16x16x32_bf16 v[36:39], v[112:115], v[84:87], v[36:39]
    s_lshl_b32 s53, s28, 7
    ds_read_b128 v[212:215], v14 offset:32768
    v_mfma_f32_16x16x32_bf16 v[40:43], v[112:115], v[88:91], v[40:43]
    ds_read_b128 v[216:219], v14 offset:33792
    v_mfma_f32_16x16x32_bf16 v[44:47], v[112:115], v[92:95], v[44:47]
    s_add_u32 s53, s53, 29229056
    v_mfma_f32_16x16x32_bf16 v[68:71], v[116:119], v[116:119], v[68:71]
    v_add_u32 v19, s53, v19
    ds_read_b128 v[220:223], v14 offset:34816
    v_mfma_f32_16x16x32_bf16 v[76:79], v[116:119], v[20:23], v[76:79]
    ds_read_b128 v[224:227], v14 offset:35840
    v_mfma_f32_16x16x32_bf16 v[48:51], v[116:119], v[80:83], v[48:51]
    buffer_load_dwordx2 v[10:11], v19, s[16:19], 0 offen sc1
    v_mfma_f32_16x16x32_bf16 v[52:55], v[116:119], v[84:87], v[52:55]
    v_mfma_f32_16x16x32_bf16 v[56:59], v[116:119], v[88:91], v[56:59]
    v_mfma_f32_16x16x32_bf16 v[60:63], v[116:119], v[92:95], v[60:63]
    s_waitcnt lgkmcnt(6)
    v_mfma_f32_16x16x32_bf16 v[64:67], v[120:123], v[120:123], v[64:67]
    ds_read_b128 v[136:139], v17 offset:4096
    v_and_b32 v24, 48, v0
    v_mfma_f32_16x16x32_bf16 v[72:75], v[120:123], v[20:23], v[72:75]
    v_lshl_add_u32 v24, v3, 2, v24
    v_lshlrev_b32 v24, 2, v24
    v_mfma_f32_16x16x32_bf16 v[32:35], v[120:123], v[96:99], v[32:35]
    s_mov_b32 s50, 0x3acccccd
    v_mov_b32 v25, 0x3727c5ac
    v_mfma_f32_16x16x32_bf16 v[36:39], v[120:123], v[100:103], v[36:39]
    ds_read_b128 v[140:143], v17 offset:6144
    s_lshl_b32 s49, s3, 8
    v_mfma_f32_16x16x32_bf16 v[40:43], v[120:123], v[104:107], v[40:43]
    s_add_u32 s49, s49, 126976
    v_lshlrev_b32 v26, 10, v3
    v_lshl_add_u32 v26, v2, 4, v26
    v_mfma_f32_16x16x32_bf16 v[44:47], v[120:123], v[108:111], v[44:47]
    ds_read_b128 v[228:231], v14 offset:36864
    v_add_u32 v26, s49, v26
    s_lshl_b32 s49, s3, 10
    v_mfma_f32_16x16x32_bf16 v[68:71], v[124:127], v[124:127], v[68:71]
    s_add_u32 s49, s49, 126976
    v_add_u32 v27, s49, v1
    v_mfma_f32_16x16x32_bf16 v[76:79], v[124:127], v[20:23], v[76:79]
    ds_read_b128 v[232:235], v14 offset:37888
    s_lshl_b32 s49, s3, 12
    s_add_u32 s49, s49, 143360
    v_lshlrev_b32 v28, 8, v3
    v_mfma_f32_16x16x32_bf16 v[48:51], v[124:127], v[96:99], v[48:51]
    v_lshl_add_u32 v28, v2, 2, v28
    ds_read_b128 v[236:239], v14 offset:38912
    v_add_u32 v28, s49, v28
    v_mfma_f32_16x16x32_bf16 v[52:55], v[124:127], v[100:103], v[52:55]
    v_add_u32 v29, s49, v1
    v_lshrrev_b32 v30, 3, v0
    v_and_b32 v31, 7, v0
    v_mfma_f32_16x16x32_bf16 v[56:59], v[124:127], v[104:107], v[56:59]
    v_mul_u32_u24 v30, 327680, v30
    ds_read_b128 v[240:243], v14 offset:39936
    v_lshl_add_u32 v31, v31, 4, v30
    v_mfma_f32_16x16x32_bf16 v[60:63], v[124:127], v[108:111], v[60:63]
    s_mul_i32 s48, s32, 1280
    s_lshl_b32 s49, s33, 7
    s_add_u32 s48, s48, s49
    s_mul_i32 s49, s3, 81920
    s_add_u32 s48, s48, s49
    s_add_u32 s48, s48, 5242880
    s_waitcnt lgkmcnt(0)
    v_mfma_f32_16x16x32_bf16 v[64:67], v[128:131], v[128:131], v[64:67]
    v_mfma_f32_16x16x32_bf16 v[72:75], v[128:131], v[20:23], v[72:75]
    v_mfma_f32_16x16x32_bf16 v[68:71], v[132:135], v[132:135], v[68:71]
    v_mfma_f32_16x16x32_bf16 v[76:79], v[132:135], v[20:23], v[76:79]
    v_mfma_f32_16x16x32_bf16 v[64:67], v[136:139], v[136:139], v[64:67]
    v_mfma_f32_16x16x32_bf16 v[72:75], v[136:139], v[20:23], v[72:75]
    v_mfma_f32_16x16x32_bf16 v[68:71], v[140:143], v[140:143], v[68:71]
    v_mfma_f32_16x16x32_bf16 v[76:79], v[140:143], v[20:23], v[76:79]
    v_mfma_f32_16x16x32_bf16 v[32:35], v[128:131], v[212:215], v[32:35]
    v_mfma_f32_16x16x32_bf16 v[48:51], v[132:135], v[212:215], v[48:51]
    v_mfma_f32_16x16x32_bf16 v[32:35], v[136:139], v[228:231], v[32:35]
    v_mfma_f32_16x16x32_bf16 v[48:51], v[140:143], v[228:231], v[48:51]
    s_nop 0
    ds_bpermute_b32 v64, v24, v64 offset:0
    ds_bpermute_b32 v65, v24, v65 offset:4
    ds_bpermute_b32 v66, v24, v66 offset:8
    v_mfma_f32_16x16x32_bf16 v[40:43], v[128:131], v[220:223], v[40:43]
    ds_bpermute_b32 v67, v24, v67 offset:12
    ds_bpermute_b32 v68, v24, v68 offset:0
    ds_bpermute_b32 v69, v24, v69 offset:4
    ds_bpermute_b32 v70, v24, v70 offset:8
    ds_bpermute_b32 v71, v24, v71 offset:12
    v_mul_f32 v72, s50, v72
    v_mul_f32 v73, s50, v73
    v_mfma_f32_16x16x32_bf16 v[56:59], v[132:135], v[220:223], v[56:59]
    v_mul_f32 v74, s50, v74
    v_mul_f32 v75, s50, v75
    v_mul_f32 v76, s50, v76
    v_mul_f32 v77, s50, v77
    v_mul_f32 v78, s50, v78
    v_mul_f32 v79, s50, v79
    v_mfma_f32_16x16x32_bf16 v[40:43], v[136:139], v[236:239], v[40:43]
    v_fma_f32 v72, -v72, v72, v25
    v_fma_f32 v73, -v73, v73, v25
    v_fma_f32 v74, -v74, v74, v25
    v_fma_f32 v75, -v75, v75, v25
    v_fma_f32 v76, -v76, v76, v25
    v_fma_f32 v77, -v77, v77, v25
    v_fma_f32 v78, -v78, v78, v25
    v_mfma_f32_16x16x32_bf16 v[56:59], v[140:143], v[236:239], v[56:59]
    v_fma_f32 v79, -v79, v79, v25
    s_waitcnt lgkmcnt(0)
    v_fma_f32 v64, v64, s50, v72
    v_fma_f32 v65, v65, s50, v73
    v_fma_f32 v66, v66, s50, v74
    v_fma_f32 v67, v67, s50, v75
    v_mfma_f32_16x16x32_bf16 v[36:39], v[128:131], v[216:219], v[36:39]
    v_fma_f32 v68, v68, s50, v76
    v_fma_f32 v69, v69, s50, v77
    v_fma_f32 v70, v70, s50, v78
    v_fma_f32 v71, v71, s50, v79
    v_max_f32 v64, v25, v64
    v_max_f32 v65, v25, v65
    v_max_f32 v66, v25, v66
    v_mfma_f32_16x16x32_bf16 v[52:55], v[132:135], v[216:219], v[52:55]
    v_max_f32 v67, v25, v67
    v_max_f32 v68, v25, v68
    v_max_f32 v69, v25, v69
    v_max_f32 v70, v25, v70
    v_max_f32 v71, v25, v71
    v_mfma_f32_16x16x32_bf16 v[36:39], v[136:139], v[232:235], v[36:39]
    v_rsq_f32 v64, v64
    v_rsq_f32 v65, v65
    v_rsq_f32 v66, v66
    v_rsq_f32 v67, v67
    v_mfma_f32_16x16x32_bf16 v[52:55], v[140:143], v[232:235], v[52:55]
    v_rsq_f32 v68, v68
    v_rsq_f32 v69, v69
    v_rsq_f32 v70, v70
    v_mfma_f32_16x16x32_bf16 v[44:47], v[128:131], v[224:227], v[44:47]
    v_rsq_f32 v71, v71
    v_mul_f32 v72, v184, v64
    v_mul_f32 v73, v185, v65
    v_mul_f32 v74, v186, v66
    v_mul_f32 v75, v187, v67
    v_mul_f32 v76, v188, v64
    v_mfma_f32_16x16x32_bf16 v[60:63], v[132:135], v[224:227], v[60:63]
    v_mul_f32 v77, v189, v65
    v_mul_f32 v78, v190, v66
    v_mul_f32 v79, v191, v67
    v_cvt_pk_bf16_f32 v200, -v76, -v77
    v_cvt_pk_bf16_f32 v201, -v78, -v79
    v_cvt_pk_bf16_f32 v202, v72, v73
    v_mfma_f32_16x16x32_bf16 v[44:47], v[136:139], v[240:243], v[44:47]
    v_cvt_pk_bf16_f32 v203, v74, v75
    v_cvt_pk_bf16_f32 v204, v76, v77
    v_cvt_pk_bf16_f32 v205, v78, v79
    v_mul_f32 v72, v184, v68
    v_mul_f32 v73, v185, v69
    v_mul_f32 v74, v186, v70
    v_mul_f32 v75, v187, v71
    v_mfma_f32_16x16x32_bf16 v[60:63], v[140:143], v[240:243], v[60:63]
    v_mul_f32 v76, v188, v68
    v_mul_f32 v77, v189, v69
    v_mul_f32 v78, v190, v70
    v_mul_f32 v79, v191, v71
    v_cvt_pk_bf16_f32 v206, -v76, -v77
    v_cvt_pk_bf16_f32 v207, -v78, -v79
    v_cvt_pk_bf16_f32 v208, v72, v73
    v_cvt_pk_bf16_f32 v209, v74, v75
    v_cvt_pk_bf16_f32 v210, v76, v77
    v_cvt_pk_bf16_f32 v211, v78, v79
    v_cvt_pk_bf16_f32 v112, v32, v33
    v_cvt_pk_bf16_f32 v113, v34, v35
    v_cvt_pk_bf16_f32 v114, v40, v41
    v_cvt_pk_bf16_f32 v115, v42, v43
    v_cvt_pk_bf16_f32 v116, v48, v49
    v_cvt_pk_bf16_f32 v117, v50, v51
    v_cvt_pk_bf16_f32 v118, v56, v57
    v_cvt_pk_bf16_f32 v119, v58, v59
    v_mfma_f32_16x16x32_bf16 v[128:131], v[202:205], v[112:115], 0
    v_mfma_f32_16x16x32_bf16 v[132:135], v[200:203], v[112:115], 0
    v_mfma_f32_16x16x32_bf16 v[136:139], v[208:211], v[116:119], 0
    v_mfma_f32_16x16x32_bf16 v[140:143], v[206:209], v[116:119], 0
    v_cvt_pk_bf16_f32 v120, v36, v37
    v_cvt_pk_bf16_f32 v121, v38, v39
    v_cvt_pk_bf16_f32 v122, v44, v45
    v_cvt_pk_bf16_f32 v123, v46, v47
    v_cvt_pk_bf16_f32 v124, v52, v53
    v_cvt_pk_bf16_f32 v125, v54, v55
    v_cvt_pk_bf16_f32 v126, v60, v61
    v_cvt_pk_bf16_f32 v127, v62, v63
    v_mfma_f32_16x16x32_bf16 v[144:147], v[202:205], v[120:123], 0
    v_mfma_f32_16x16x32_bf16 v[148:151], v[200:203], v[120:123], 0
    v_mfma_f32_16x16x32_bf16 v[152:155], v[208:211], v[124:127], 0
    v_mfma_f32_16x16x32_bf16 v[156:159], v[206:209], v[124:127], 0
    v_cvt_pk_bf16_f32 v80, v128, v132
    v_cvt_pk_bf16_f32 v81, v136, v140
    v_cvt_pk_bf16_f32 v82, v129, v133
    v_cvt_pk_bf16_f32 v83, v137, v141
    ds_write_b128 v26, v[80:83] offset:0
    v_cvt_pk_bf16_f32 v84, v130, v134
    v_cvt_pk_bf16_f32 v85, v138, v142
    v_cvt_pk_bf16_f32 v86, v131, v135
    v_cvt_pk_bf16_f32 v87, v139, v143
    ds_write_b128 v26, v[84:87] offset:4096
    v_cvt_pk_bf16_f32 v88, v144, v148
    v_cvt_pk_bf16_f32 v89, v152, v156
    v_cvt_pk_bf16_f32 v90, v145, v149
    v_cvt_pk_bf16_f32 v91, v153, v157
    ds_write_b128 v26, v[88:91] offset:8192
    v_cvt_pk_bf16_f32 v92, v146, v150
    v_cvt_pk_bf16_f32 v93, v154, v158
    v_cvt_pk_bf16_f32 v94, v147, v151
    v_cvt_pk_bf16_f32 v95, v155, v159
    ds_write_b128 v26, v[92:95] offset:12288
    s_waitcnt vmcnt(1) lgkmcnt(0)
    s_barrier
    ds_read_b128 v[96:99], v27 offset:0
    ds_read_b128 v[104:107], v27 offset:8192
    ds_read_b128 v[100:103], v27 offset:4096
    ds_read_b128 v[108:111], v27 offset:12288
    s_add_u32 s55, s47, 1
    v_mov_b32 v250, s55
    v_mov_b32 v251, s46
    v_lshlrev_b32 v252, 25, v0
    buffer_store_dwordx2 v[250:251], v252, s[16:19], s40 offen sc0 sc1
    s_waitcnt lgkmcnt(3)
    v_mfma_f32_16x16x16_bf16 v[32:35], v[192:193], v[96:97], 0
    v_mfma_f32_16x16x16_bf16 v[40:43], v[194:195], v[98:99], 0
    s_waitcnt lgkmcnt(2)
    v_mfma_f32_16x16x16_bf16 v[36:39], v[192:193], v[104:105], 0
    v_mfma_f32_16x16x16_bf16 v[44:47], v[194:195], v[106:107], 0
    s_waitcnt lgkmcnt(1)
    v_mfma_f32_16x16x16_bf16 v[48:51], v[196:197], v[100:101], 0
    v_mfma_f32_16x16x16_bf16 v[56:59], v[198:199], v[102:103], 0
    s_waitcnt lgkmcnt(0)
    v_mfma_f32_16x16x16_bf16 v[52:55], v[196:197], v[108:109], 0
    v_mfma_f32_16x16x16_bf16 v[60:63], v[198:199], v[110:111], 0
    v_cvt_pk_bf16_f32 v64, v32, v33
    v_cvt_pk_bf16_f32 v65, v34, v35
    ds_write2_b32 v28, v64, v65 offset0:0 offset1:32
    v_cvt_pk_bf16_f32 v66, v36, v37
    v_cvt_pk_bf16_f32 v67, v38, v39
    ds_write2_b32 v28, v66, v67 offset0:16 offset1:48
    v_add_u32 v28, 1024, v28
    v_cvt_pk_bf16_f32 v68, v40, v41
    v_cvt_pk_bf16_f32 v69, v42, v43
    ds_write2_b32 v28, v68, v69 offset0:0 offset1:32
    v_cvt_pk_bf16_f32 v70, v44, v45
    v_cvt_pk_bf16_f32 v71, v46, v47
    ds_write2_b32 v28, v70, v71 offset0:16 offset1:48
    v_add_u32 v28, 1024, v28
    v_cvt_pk_bf16_f32 v72, v48, v49
    v_cvt_pk_bf16_f32 v73, v50, v51
    ds_write2_b32 v28, v72, v73 offset0:0 offset1:32
    v_cvt_pk_bf16_f32 v74, v52, v53
    v_cvt_pk_bf16_f32 v75, v54, v55
    ds_write2_b32 v28, v74, v75 offset0:16 offset1:48
    v_add_u32 v28, 1024, v28
    v_cvt_pk_bf16_f32 v76, v56, v57
    v_cvt_pk_bf16_f32 v77, v58, v59
    ds_write2_b32 v28, v76, v77 offset0:0 offset1:32
    v_cvt_pk_bf16_f32 v78, v60, v61
    v_cvt_pk_bf16_f32 v79, v62, v63
    ds_write2_b32 v28, v78, v79 offset0:16 offset1:48
    s_waitcnt lgkmcnt(6)
    ds_read_b128 v[112:115], v29 offset:0
    s_waitcnt lgkmcnt(5)
    ds_read_b128 v[116:119], v29 offset:1024
    s_waitcnt lgkmcnt(4)
    ds_read_b128 v[120:123], v29 offset:2048
    s_waitcnt lgkmcnt(3)
    ds_read_b128 v[124:127], v29 offset:3072
    s_waitcnt lgkmcnt(3)
    buffer_store_dwordx4 v[112:115], v31, s[16:19], s48 offen sc1
    s_add_u32 s48, s48, 20480
    s_waitcnt lgkmcnt(2)
    buffer_store_dwordx4 v[116:119], v31, s[16:19], s48 offen sc1
    s_add_u32 s48, s48, 20480
    s_waitcnt lgkmcnt(1)
    buffer_store_dwordx4 v[120:123], v31, s[16:19], s48 offen sc1
    s_add_u32 s48, s48, 20480
    s_waitcnt lgkmcnt(0)
    buffer_store_dwordx4 v[124:127], v31, s[16:19], s48 offen sc1
    v_mov_b32 v176, -1
    v_mov_b32 v177, -1
    v_mov_b32 v178, -1
    v_mov_b32 v179, -1
    s_add_u32 s35, s48, 2621440
    v_mov_b32 v180, v31
    s_mov_b32 s55, 0
    s_add_u32 s54, s47, 1
    s_waitcnt vmcnt(5)
ploop_m_16:
    v_subrev_u32 v10, s54, v10
    v_xor_b32 v11, s46, v11
    v_lshl_or_b32 v10, v11, 3, v10
    v_and_b32 v11, -8, v11
    v_or_b32 v10, v10, v11
    v_cmp_le_u32 vcc, 7, v10
    s_add_u32 s55, s55, 1
    s_cmp_ge_u32 s55, 200000
    s_cbranch_scc1 pok_m_15
    s_nop 2
    s_cbranch_vccz pok_m_15
    s_sleep 1
    buffer_load_dwordx2 v[10:11], v19, s[16:19], 0 offen sc1
    s_waitcnt vmcnt(0)
    s_branch ploop_m_16
pok_m_15:
    v_min_u32 v241, 6, v0
    v_add_u32 v241, s34, v241
    v_min_u32 v241, 53, v241
    v_lshlrev_b32 v241, 7, v241
    v_add_u32 v241, 29216768, v241
    v_min_u32 v240, 19, v0
    v_lshlrev_b32 v240, 10, v240
    s_lshl_b32 s54, s28, 7
    s_add_u32 s54, s54, 29229056
    v_add_u32 v240, s54, v240
    s_bitcmp1_b32 s3, 0
    s_cselect_b32 s48, s37, s36
    s_cselect_b32 s56, s39, s38
    s_bitcmp1_b32 s3, 0
    s_cselect_b32 s53, s37, s36
    s_cselect_b32 s62, s39, s38
    s_bitcmp1_b32 s3, 1
    s_cselect_b32 s56, s56, s48
    s_bitcmp1_b32 s3, 1
    s_cselect_b32 s62, s62, s53
    s_xor_b32 s57, s3, 1
    s_lshr_b32 s48, s3, 1
    s_xor_b32 s52, s3, 1
    s_or_b32 s48, s48, s36
    s_cmp_eq_u32 s48, 0
    s_cselect_b32 s57, s3, s57
    s_lshr_b32 s53, s3, 1
    v_mul_u32_u24 v4, 5120, v3
    s_or_b32 s53, s53, s36
    v_lshl_add_u32 v4, v2, 4, v4
    v_xor_b32 v5, 768, v1
    s_cmp_eq_u32 s53, 0
    s_cselect_b32 s52, s3, s52
    v_and_b32 v7, 3, v2
    v_lshl_add_u32 v7, v3, 2, v7
    v_mul_u32_u24 v7, 1280, v7
    s_bitcmp1_b32 s52, 0
    s_cselect_b32 s53, s37, s36
    s_cselect_b32 s63, s39, s38
    v_lshrrev_b32 v6, 2, v2
    v_add_u32 v6, 1, v6
    s_bitcmp1_b32 s52, 1
    s_cselect_b32 s63, s63, s53
    v_lshl_add_u32 v6, v6, 8, v7
    v_cvt_f32_u32 v10, v2
    s_mul_i32 s62, s62, 20480
    v_mul_f32 v10, 0x3d800000, v10
    s_cmp_eq_u32 s56, 0
    s_cselect_b32 s48, 0x3f800000, 0x3f700000
    s_add_u32 s62, s62, 0
    v_sub_f32 v11, s48, v10
    s_mul_i32 s63, s63, 20480
    v_lshlrev_b32 v12, 2, v3
    v_cvt_f32_u32 v12, v12
    s_add_u32 s63, s63, 0
    v_add_f32 v13, 0, v12
    v_mul_f32 v14, v13, v10
    s_lshl_b32 s53, s3, 10
    v_cos_f32 v15, v14
    v_sin_f32 v14, v14
    s_nop 0
    v_cvt_pk_bf16_f32 v16, v15, v14
    s_lshl_b32 s52, s52, 10
    v_mul_f32 v14, v13, v11
    v_cos_f32 v15, v14
    s_add_u32 m0, s53, 0
    s_add_u32 s61, s62, 0
    buffer_load_dwordx4 v1, s[16:19], s61 offen sc1 lds
    v_sin_f32 v14, v14
    s_nop 0
    v_cvt_pk_bf16_f32 v20, v15, v14
    s_add_u32 m0, s53, 4096
    s_add_u32 s61, s62, 1024
    buffer_load_dwordx4 v1, s[16:19], s61 offen sc1 lds
    v_add_f32 v13, 1.0, v12
    v_mul_f32 v14, v13, v10
    s_add_u32 m0, s52, 73728
    s_add_u32 s61, s63, 18432
    buffer_load_dwordx4 v1, s[16:19], s61 offen sc1 lds
    v_cos_f32 v15, v14
    v_sin_f32 v14, v14
    s_add_u32 m0, s52, 77824
    s_add_u32 s61, s63, 19456
    buffer_load_dwordx4 v1, s[16:19], s61 offen sc1 lds
    v_cvt_pk_bf16_f32 v17, v15, v14
    v_mul_f32 v14, v13, v11
    s_add_u32 m0, s53, 8192
    s_add_u32 s61, s62, 2048
    buffer_load_dwordx4 v1, s[16:19], s61 offen sc1 lds
    v_cos_f32 v15, v14
    v_sin_f32 v14, v14
    s_add_u32 m0, s53, 12288
    s_add_u32 s61, s62, 3072
    buffer_load_dwordx4 v1, s[16:19], s61 offen sc1 lds
    v_cvt_pk_bf16_f32 v21, v15, v14
    v_add_f32 v13, 2.0, v12
    v_mul_f32 v14, v13, v10
    s_add_u32 m0, s52, 65536
    s_add_u32 s61, s63, 16384
    buffer_load_dwordx4 v1, s[16:19], s61 offen sc1 lds
    v_cos_f32 v15, v14
    v_sin_f32 v14, v14
    s_add_u32 m0, s52, 69632
    s_add_u32 s61, s63, 17408
    buffer_load_dwordx4 v1, s[16:19], s61 offen sc1 lds
    v_cvt_pk_bf16_f32 v18, v15, v14
    v_mul_f32 v14, v13, v11
    s_add_u32 m0, s53, 16384
    s_add_u32 s61, s62, 4096
    buffer_load_dwordx4 v1, s[16:19], s61 offen sc1 lds
    v_cos_f32 v15, v14
    v_sin_f32 v14, v14
    s_add_u32 m0, s53, 20480
    s_add_u32 s61, s62, 5120
    buffer_load_dwordx4 v1, s[16:19], s61 offen sc1 lds
    v_cvt_pk_bf16_f32 v22, v15, v14
    v_add_f32 v13, 0x40400000, v12
    s_add_u32 m0, s52, 57344
    s_add_u32 s61, s63, 14336
    buffer_load_dwordx4 v1, s[16:19], s61 offen sc1 lds
    v_mul_f32 v14, v13, v10
    v_cos_f32 v15, v14
    s_add_u32 m0, s52, 61440
    s_add_u32 s61, s63, 15360
    buffer_load_dwordx4 v1, s[16:19], s61 offen sc1 lds
    v_sin_f32 v14, v14
    s_nop 0
    v_cvt_pk_bf16_f32 v19, v15, v14
    s_add_u32 m0, s53, 24576
    s_add_u32 s61, s62, 6144
    buffer_load_dwordx4 v1, s[16:19], s61 offen sc1 lds
    v_mul_f32 v14, v13, v11
    v_cos_f32 v15, v14
    v_sin_f32 v14, v14
    s_add_u32 m0, s53, 28672
    s_add_u32 s61, s62, 7168
    buffer_load_dwordx4 v1, s[16:19], s61 offen sc1 lds
    v_cvt_pk_bf16_f32 v23, v15, v14
    v_cmp_eq_u32 vcc, 0, v2
    s_add_u32 m0, s52, 49152
    s_add_u32 s61, s63, 12288
    buffer_load_dwordx4 v1, s[16:19], s61 offen sc1 lds
    v_cndmask_b32 v10, -1, 0, vcc
    s_lshl_b32 s48, s3, 10
    s_add_u32 m0, s52, 53248
    s_add_u32 s61, s63, 13312
    buffer_load_dwordx4 v1, s[16:19], s61 offen sc1 lds
    v_add_u32 v11, s48, v1
    s_lshl_b32 s48, s57, 10
    s_add_u32 m0, s53, 32768
    s_add_u32 s61, s62, 8192
    buffer_load_dwordx4 v1, s[16:19], s61 offen sc1 lds
    s_add_u32 s48, s48, 40960
    v_add_u32 v12, s48, v5
    s_add_u32 m0, s53, 36864
    s_add_u32 s61, s62, 9216
    buffer_load_dwordx4 v1, s[16:19], s61 offen sc1 lds
    v_mov_b32 v5, v1
    v_add_u32 v13, 40960, v1
    s_add_u32 m0, s52, 40960
    s_add_u32 s61, s63, 10240
    buffer_load_dwordx4 v1, s[16:19], s61 offen sc1 lds
    s_mul_i32 s59, s56, 20480
    s_add_u32 s59, s59, 5242880
    s_add_u32 m0, s52, 45056
    s_add_u32 s61, s63, 11264
    buffer_load_dwordx4 v1, s[16:19], s61 offen sc1 lds
    buffer_store_dwordx4 v[176:179], v180, s[16:19], s35 offen sc1
    s_sub_u32 s35, s35, 20480
    buffer_store_dwordx4 v[176:179], v180, s[16:19], s35 offen sc1
    s_sub_u32 s35, s35, 20480
    buffer_store_dwordx4 v[176:179], v180, s[16:19], s35 offen sc1
    s_sub_u32 s35, s35, 20480
    buffer_store_dwordx4 v[176:179], v180, s[16:19], s35 offen sc1
    s_branch j2_m_7
join_m_3:
    s_waitcnt vmcnt(0)
    s_mov_b32 s55, 0
    v_mov_b32 v251, 0
tloop_m_18:
    v_readfirstlane_b32 s47, v248
    v_readfirstlane_b32 s46, v249
    s_nop 1
    s_cmp_lg_u32 s47, 0
    s_cbranch_scc1 tskip_m_17
    s_cmp_ge_u32 s55, 200000
    s_cbranch_scc1 tskip_m_17
    s_sleep 8
    buffer_load_dwordx2 v[248:249], v251, s[20:23], 0 offen sc1
    s_add_u32 s55, s55, 1
    s_waitcnt vmcnt(0)
    s_branch tloop_m_18
tskip_m_17:
    s_add_u32 s55, s47, 1
    v_mov_b32 v250, s55
    v_mov_b32 v251, s46
    v_lshlrev_b32 v252, 25, v0
    s_waitcnt vmcnt(0)
    s_barrier
    buffer_store_dwordx2 v[250:251], v252, s[16:19], s40 offen sc0 sc1
    v_min_u32 v241, 53, v0
    v_lshlrev_b32 v241, 7, v241
    v_add_u32 v241, 29216768, v241
    v_min_u32 v240, 19, v0
    v_lshlrev_b32 v240, 10, v240
    s_lshl_b32 s54, s28, 7
    s_add_u32 s54, s54, 29229056
    v_add_u32 v240, s54, v240
    s_bitcmp1_b32 s3, 0
    s_cselect_b32 s48, s37, s36
    s_cselect_b32 s56, s39, s38
    s_bitcmp1_b32 s3, 1
    s_cselect_b32 s56, s56, s48
    s_xor_b32 s57, s3, 1
    s_lshr_b32 s48, s3, 1
    s_or_b32 s48, s48, s36
    s_cmp_eq_u32 s48, 0
    s_cselect_b32 s57, s3, s57
    v_mul_u32_u24 v4, 5120, v3
    v_lshl_add_u32 v4, v2, 4, v4
    v_xor_b32 v5, 768, v1
    v_and_b32 v7, 3, v2
    v_lshl_add_u32 v7, v3, 2, v7
    v_mul_u32_u24 v7, 1280, v7
    v_lshrrev_b32 v6, 2, v2
    v_add_u32 v6, 1, v6
    v_lshl_add_u32 v6, v6, 8, v7
    v_cvt_f32_u32 v10, v2
    v_mul_f32 v10, 0x3d800000, v10
    s_cmp_eq_u32 s56, 0
    s_cselect_b32 s48, 0x3f800000, 0x3f700000
    v_sub_f32 v11, s48, v10
    v_lshlrev_b32 v12, 2, v3
    v_cvt_f32_u32 v12, v12
    v_add_f32 v13, 0, v12
    v_mul_f32 v14, v13, v10
    v_cos_f32 v15, v14
    v_sin_f32 v14, v14
    s_nop 0
    v_cvt_pk_bf16_f32 v16, v15, v14
    v_mul_f32 v14, v13, v11
    v_cos_f32 v15, v14
    v_sin_f32 v14, v14
    s_nop 0
    v_cvt_pk_bf16_f32 v20, v15, v14
    v_add_f32 v13, 1.0, v12
    v_mul_f32 v14, v13, v10
    v_cos_f32 v15, v14
    v_sin_f32 v14, v14
    s_nop 0
    v_cvt_pk_bf16_f32 v17, v15, v14
    v_mul_f32 v14, v13, v11
    v_cos_f32 v15, v14
    v_sin_f32 v14, v14
    s_nop 0
    v_cvt_pk_bf16_f32 v21, v15, v14
    v_add_f32 v13, 2.0, v12
    v_mul_f32 v14, v13, v10
    v_cos_f32 v15, v14
    v_sin_f32 v14, v14
    s_nop 0
    v_cvt_pk_bf16_f32 v18, v15, v14
    v_mul_f32 v14, v13, v11
    v_cos_f32 v15, v14
    v_sin_f32 v14, v14
    s_nop 0
    v_cvt_pk_bf16_f32 v22, v15, v14
    v_add_f32 v13, 0x40400000, v12
    v_mul_f32 v14, v13, v10
    v_cos_f32 v15, v14
    v_sin_f32 v14, v14
    s_nop 0
    v_cvt_pk_bf16_f32 v19, v15, v14
    v_mul_f32 v14, v13, v11
    v_cos_f32 v15, v14
    v_sin_f32 v14, v14
    s_nop 0
    v_cvt_pk_bf16_f32 v23, v15, v14
    v_cmp_eq_u32 vcc, 0, v2
    s_nop 1
    v_cndmask_b32 v10, -1, 0, vcc
    s_lshl_b32 s48, s3, 10
    v_add_u32 v11, s48, v1
    s_lshl_b32 s48, s57, 10
    s_add_u32 s48, s48, 40960
    v_add_u32 v12, s48, v5
    v_mov_b32 v5, v1
    v_add_u32 v13, 40960, v1
    s_mul_i32 s59, s56, 20480
    s_add_u32 s59, s59, 5242880
    buffer_load_dwordx2 v[244:245], v240, s[16:19], 0 offen sc1
    s_mov_b32 s55, 0
    s_add_u32 s54, s47, 1
    s_waitcnt vmcnt(0)
ploop_m_20:
    v_subrev_u32 v244, s54, v244
    v_xor_b32 v245, s46, v245
    v_lshl_or_b32 v244, v245, 3, v244
    v_and_b32 v245, -8, v245
    v_or_b32 v244, v244, v245
    v_cmp_le_u32 vcc, 7, v244
    s_add_u32 s55, s55, 1
    s_cmp_ge_u32 s55, 200000
    s_cbranch_scc1 pok_m_19
    s_nop 2
    s_cbranch_vccz pok_m_19
    s_sleep 2
    buffer_load_dwordx2 v[244:245], v240, s[16:19], 0 offen sc1
    s_waitcnt vmcnt(0)
    s_branch ploop_m_20
pok_m_19:
    s_bitcmp1_b32 s3, 0
    s_cselect_b32 s53, s37, s36
    s_cselect_b32 s62, s39, s38
    s_bitcmp1_b32 s3, 1
    s_cselect_b32 s62, s62, s53
    s_xor_b32 s52, s3, 1
    s_lshr_b32 s53, s3, 1
    s_or_b32 s53, s53, s36
    s_cmp_eq_u32 s53, 0
    s_cselect_b32 s52, s3, s52
    s_bitcmp1_b32 s52, 0
    s_cselect_b32 s53, s37, s36
    s_cselect_b32 s63, s39, s38
    s_bitcmp1_b32 s52, 1
    s_cselect_b32 s63, s63, s53
    s_mul_i32 s62, s62, 20480
    s_add_u32 s62, s62, 0
    s_mul_i32 s63, s63, 20480
    s_add_u32 s63, s63, 0
    s_lshl_b32 s53, s3, 10
    s_lshl_b32 s52, s52, 10
    s_add_u32 m0, s53, 0
    s_add_u32 s61, s62, 0
    buffer_load_dwordx4 v1, s[16:19], s61 offen sc1 lds
    s_add_u32 m0, s53, 4096
    s_add_u32 s61, s62, 1024
    buffer_load_dwordx4 v1, s[16:19], s61 offen sc1 lds
    s_add_u32 m0, s52, 73728
    s_add_u32 s61, s63, 18432
    buffer_load_dwordx4 v1, s[16:19], s61 offen sc1 lds
    s_add_u32 m0, s52, 77824
    s_add_u32 s61, s63, 19456
    buffer_load_dwordx4 v1, s[16:19], s61 offen sc1 lds
    s_add_u32 m0, s53, 8192
    s_add_u32 s61, s62, 2048
    buffer_load_dwordx4 v1, s[16:19], s61 offen sc1 lds
    s_add_u32 m0, s53, 12288
    s_add_u32 s61, s62, 3072
    buffer_load_dwordx4 v1, s[16:19], s61 offen sc1 lds
    s_add_u32 m0, s52, 65536
    s_add_u32 s61, s63, 16384
    buffer_load_dwordx4 v1, s[16:19], s61 offen sc1 lds
    s_add_u32 m0, s52, 69632
    s_add_u32 s61, s63, 17408
    buffer_load_dwordx4 v1, s[16:19], s61 offen sc1 lds
    s_add_u32 m0, s53, 16384
    s_add_u32 s61, s62, 4096
    buffer_load_dwordx4 v1, s[16:19], s61 offen sc1 lds
    s_add_u32 m0, s53, 20480
    s_add_u32 s61, s62, 5120
    buffer_load_dwordx4 v1, s[16:19], s61 offen sc1 lds
    s_add_u32 m0, s52, 57344
    s_add_u32 s61, s63, 14336
    buffer_load_dwordx4 v1, s[16:19], s61 offen sc1 lds
    s_add_u32 m0, s52, 61440
    s_add_u32 s61, s63, 15360
    buffer_load_dwordx4 v1, s[16:19], s61 offen sc1 lds
    s_add_u32 m0, s53, 24576
    s_add_u32 s61, s62, 6144
    buffer_load_dwordx4 v1, s[16:19], s61 offen sc1 lds
    s_add_u32 m0, s53, 28672
    s_add_u32 s61, s62, 7168
    buffer_load_dwordx4 v1, s[16:19], s61 offen sc1 lds
    s_add_u32 m0, s52, 49152
    s_add_u32 s61, s63, 12288
    buffer_load_dwordx4 v1, s[16:19], s61 offen sc1 lds
    s_add_u32 m0, s52, 53248
    s_add_u32 s61, s63, 13312
    buffer_load_dwordx4 v1, s[16:19], s61 offen sc1 lds
    s_add_u32 m0, s53, 32768
    s_add_u32 s61, s62, 8192
    buffer_load_dwordx4 v1, s[16:19], s61 offen sc1 lds
    s_add_u32 m0, s53, 36864
    s_add_u32 s61, s62, 9216
    buffer_load_dwordx4 v1, s[16:19], s61 offen sc1 lds
    s_add_u32 m0, s52, 40960
    s_add_u32 s61, s63, 10240
    buffer_load_dwordx4 v1, s[16:19], s61 offen sc1 lds
    s_add_u32 m0, s52, 45056
    s_add_u32 s61, s63, 11264
    buffer_load_dwordx4 v1, s[16:19], s61 offen sc1 lds
    s_waitcnt vmcnt(0)
    s_sub_u32 s48, s29, 20
    s_mul_i32 s49, s3, 12
    s_add_u32 s48, s48, s49
    s_cmp_ge_u32 s48, 54
    s_cselect_b32 s49, 1073741824, 24641536
    s_mul_i32 s48, s48, 40960
    s_add_u32 s48, s48, s49
j2_m_7:
    s_waitcnt vmcnt(4)
    ds_read_b128 v[112:115], v11 offset:0
    ds_read_b128 v[116:119], v11 offset:4096
    ds_read_b128 v[120:123], v12 offset:32768
    ds_read_b128 v[124:127], v12 offset:36864
    s_waitcnt lgkmcnt(0)
    v_lshlrev_b32 v128, 16, v112
    v_lshlrev_b32 v129, 16, v114
    v_lshlrev_b32 v130, 16, v116
    v_lshlrev_b32 v131, 16, v118
    v_and_b32 v132, s10, v112
    v_and_b32 v133, s10, v114
    v_and_b32 v134, s10, v116
    v_and_b32 v135, s10, v118
    v_lshlrev_b32 v136, 16, v113
    v_lshlrev_b32 v137, 16, v115
    v_lshlrev_b32 v138, 16, v117
    v_lshlrev_b32 v139, 16, v119
    v_and_b32 v140, s10, v113
    v_and_b32 v141, s10, v115
    v_and_b32 v142, s10, v117
    v_and_b32 v143, s10, v119
    v_and_b32 v144, s10, v127
    v_and_b32 v145, s10, v125
    v_and_b32 v146, s10, v123
    v_and_b32 v147, s10, v121
    v_lshlrev_b32 v148, 16, v127
    v_lshlrev_b32 v149, 16, v125
    v_lshlrev_b32 v150, 16, v123
    v_lshlrev_b32 v151, 16, v121
    v_and_b32 v152, s10, v126
    v_and_b32 v153, s10, v124
    v_and_b32 v154, s10, v122
    v_and_b32 v155, s10, v120
    v_lshlrev_b32 v156, 16, v126
    v_lshlrev_b32 v157, 16, v124
    v_lshlrev_b32 v158, 16, v122
    v_lshlrev_b32 v159, 16, v120
    s_mul_i32 s48, s3, 5120
    v_min_u32 v246, 39, v0
    v_lshlrev_b32 v246, 7, v246
    s_add_u32 s48, s48, 29196288
    v_add_u32 v246, s48, v246
    s_waitcnt lgkmcnt(0)
    buffer_load_dwordx2 v[242:243], v241, s[16:19], 0 offen sc1
    buffer_load_dwordx2 v[250:251], v246, s[16:19], 0 offen sc1
    s_mov_b32 s55, 0
    s_add_u32 s54, s47, 1
    s_waitcnt vmcnt(0)
ploop_m_22:
    v_subrev_u32 v250, s54, v250
    v_xor_b32 v251, s46, v251
    v_lshl_or_b32 v250, v251, 3, v250
    v_and_b32 v251, -8, v251
    v_or_b32 v250, v250, v251
    v_cmp_le_u32 vcc, 7, v250
    s_add_u32 s55, s55, 1
    s_cmp_ge_u32 s55, 200000
    s_cbranch_scc1 pok_m_21
    s_nop 2
    s_cbranch_vccz pok_m_21
    s_sleep 1
    buffer_load_dwordx2 v[250:251], v246, s[16:19], 0 offen sc1
    s_waitcnt vmcnt(0)
    s_branch ploop_m_22
pok_m_21:
    s_barrier
    buffer_load_dwordx4 v[32:35], v4, s[16:19], s59 offen sc1
    buffer_load_dwordx4 v[36:39], v4, s[16:19], s59 offen offset:1280 sc1
    buffer_load_dwordx4 v[40:43], v4, s[16:19], s59 offen offset:2560 sc1
    buffer_load_dwordx4 v[44:47], v4, s[16:19], s59 offen offset:3840 sc1
    buffer_load_dword v8, v6, s[16:19], s59 offen sc1
    s_add_u32 s48, s59, 256
    buffer_load_dwordx4 v[48:51], v4, s[16:19], s48 offen sc1
    buffer_load_dwordx4 v[52:55], v4, s[16:19], s48 offen offset:1280 sc1
    buffer_load_dwordx4 v[56:59], v4, s[16:19], s48 offen offset:2560 sc1
    buffer_load_dwordx4 v[60:63], v4, s[16:19], s48 offen offset:3840 sc1
    s_mov_b32 s55, 0
    s_add_u32 s54, s47, 1
    s_waitcnt vmcnt(10)
ploop_m_24:
    v_subrev_u32 v242, s54, v242
    v_xor_b32 v243, s46, v243
    v_lshl_or_b32 v242, v243, 3, v242
    v_and_b32 v243, -8, v243
    v_or_b32 v242, v242, v243
    v_cmp_le_u32 vcc, 7, v242
    s_add_u32 s55, s55, 1
    s_cmp_ge_u32 s55, 200000
    s_cbranch_scc1 pok_m_23
    s_nop 2
    s_cbranch_vccz pok_m_23
    s_sleep 1
    buffer_load_dwordx2 v[242:243], v241, s[16:19], 0 offen sc1
    s_waitcnt vmcnt(0)
    s_branch ploop_m_24
pok_m_23:
    s_add_u32 s60, s44, 0
    buffer_load_dwordx4 a[0:3], v1, s[16:19], s60 offen sc1
    buffer_load_dwordx4 a[4:7], v1, s[16:19], s60 offen offset:1024 sc1
    buffer_load_dwordx4 a[8:11], v1, s[16:19], s60 offen offset:2048 sc1
    buffer_load_dwordx4 a[12:15], v1, s[16:19], s60 offen offset:3072 sc1
    s_add_u32 s60, s44, 36864
    buffer_load_dwordx4 a[16:19], v1, s[16:19], s60 offen sc1
    buffer_load_dwordx4 a[20:23], v1, s[16:19], s60 offen offset:1024 sc1
    buffer_load_dwordx4 a[24:27], v1, s[16:19], s60 offen offset:2048 sc1
    buffer_load_dwordx4 a[28:31], v1, s[16:19], s60 offen offset:3072 sc1
    s_add_u32 s60, s45, 0
    buffer_load_dwordx4 a[32:35], v1, s[16:19], s60 offen sc1
    buffer_load_dwordx4 a[36:39], v1, s[16:19], s60 offen offset:1024 sc1
    buffer_load_dwordx4 a[40:43], v1, s[16:19], s60 offen offset:2048 sc1
    buffer_load_dwordx4 a[44:47], v1, s[16:19], s60 offen offset:3072 sc1
    s_add_u32 s60, s45, 36864
    buffer_load_dwordx4 a[48:51], v1, s[16:19], s60 offen sc1
    buffer_load_dwordx4 a[52:55], v1, s[16:19], s60 offen offset:1024 sc1
    buffer_load_dwordx4 a[56:59], v1, s[16:19], s60 offen offset:2048 sc1
    buffer_load_dwordx4 a[60:63], v1, s[16:19], s60 offen offset:3072 sc1
    s_waitcnt vmcnt(20)
    v_max3_u32 v28, v32, v36, v40
    v_max3_u32 v28, v28, v44, v8
    v_cmp_eq_u32 vcc, -1, v28
    s_nop 3
    s_cbranch_vccnz vrt_m_25
vbk_m_26:
    v_mov_b32_dpp v28, v8 row_shr:15 row_mask:0xf bank_mask:0xf
    v_mov_b32_dpp v29, v8 row_shr:14 row_mask:0xf bank_mask:0xf
    v_mov_b32_dpp v30, v8 row_shr:13 row_mask:0xf bank_mask:0xf
    v_mov_b32_dpp v31, v8 row_shr:12 row_mask:0xf bank_mask:0xf
    v_mov_b32_dpp v28, v32 row_shl:1 row_mask:0xf bank_mask:0xf
    v_mov_b32_dpp v29, v36 row_shl:1 row_mask:0xf bank_mask:0xf
    v_mov_b32_dpp v30, v40 row_shl:1 row_mask:0xf bank_mask:0xf
    v_mov_b32_dpp v31, v44 row_shl:1 row_mask:0xf bank_mask:0xf
    v_swap_b32 v33, v36
    v_swap_b32 v34, v40
    v_swap_b32 v35, v44
    v_swap_b32 v38, v41
    v_swap_b32 v39, v45
    v_swap_b32 v43, v46
    v_and_b32 v32, v10, v32
    v_and_b32 v33, v10, v33
    v_and_b32 v34, v10, v34
    v_and_b32 v35, v10, v35
    v_mfma_f32_16x16x32_bf16 v[156:159], v[28:31], v[20:23], v[156:159]
    s_nop 0
    v_mfma_f32_16x16x32_bf16 v[128:131], v[32:35], v[16:19], v[128:131]
    v_mfma_f32_16x16x32_bf16 v[132:135], v[36:39], v[16:19], v[132:135]
    v_mfma_f32_16x16x32_bf16 v[136:139], v[40:43], v[16:19], v[136:139]
    v_mfma_f32_16x16x32_bf16 v[140:143], v[44:47], v[16:19], v[140:143]
    v_mfma_f32_16x16x32_bf16 v[144:147], v[36:39], v[20:23], v[144:147]
    v_mfma_f32_16x16x32_bf16 v[148:151], v[40:43], v[20:23], v[148:151]
    v_mfma_f32_16x16x32_bf16 v[152:155], v[44:47], v[20:23], v[152:155]
    ds_read_b128 v[32:35], v11 offset:8192
    ds_read_b128 v[36:39], v11 offset:12288
    ds_read_b128 v[40:43], v12 offset:24576
    ds_read_b128 v[44:47], v12 offset:28672
    v_cvt_pk_bf16_f32 v112, v128, v132
    v_cvt_pk_bf16_f32 v113, v136, v140
    v_cvt_pk_bf16_f32 v114, v129, v133
    v_cvt_pk_bf16_f32 v115, v137, v141
    ds_write_b128 v11, v[112:115] offset:0
    v_cvt_pk_bf16_f32 v116, v130, v134
    v_cvt_pk_bf16_f32 v117, v138, v142
    v_cvt_pk_bf16_f32 v118, v131, v135
    v_cvt_pk_bf16_f32 v119, v139, v143
    ds_write_b128 v11, v[116:119] offset:4096
    v_cvt_pk_bf16_f32 v120, v159, v155
    v_cvt_pk_bf16_f32 v121, v151, v147
    v_cvt_pk_bf16_f32 v122, v158, v154
    v_cvt_pk_bf16_f32 v123, v150, v146
    ds_write_b128 v12, v[120:123] offset:32768
    v_cvt_pk_bf16_f32 v124, v157, v153
    v_cvt_pk_bf16_f32 v125, v149, v145
    v_cvt_pk_bf16_f32 v126, v156, v152
    v_cvt_pk_bf16_f32 v127, v148, v144
    ds_write_b128 v12, v[124:127] offset:36864
    s_waitcnt lgkmcnt(0)
    s_barrier
    ds_read_b128 v[160:163], v5 offset:0
    ds_read_b128 v[164:167], v5 offset:1024
    ds_read_b128 v[168:171], v5 offset:2048
    ds_read_b128 v[172:175], v5 offset:3072
    s_waitcnt lgkmcnt(8)
    s_add_u32 s60, s44, 4096
    v_lshlrev_b32 v128, 16, v32
    buffer_load_dwordx4 a[64:67], v1, s[16:19], s60 offen sc1
    v_lshlrev_b32 v129, 16, v34
    v_lshlrev_b32 v130, 16, v36
    buffer_load_dwordx4 a[68:71], v1, s[16:19], s60 offen offset:1024 sc1
    v_lshlrev_b32 v131, 16, v38
    v_and_b32 v132, s10, v32
    v_and_b32 v133, s10, v34
    v_and_b32 v134, s10, v36
    v_and_b32 v135, s10, v38
    v_lshlrev_b32 v136, 16, v33
    v_lshlrev_b32 v137, 16, v35
    s_waitcnt vmcnt(2) lgkmcnt(0)
    v_mfma_f32_16x16x32_bf16 v[192:195], a[0:3], v[160:163], 0
    buffer_load_dwordx4 a[72:75], v1, s[16:19], s60 offen offset:2048 sc1
    v_mfma_f32_16x16x32_bf16 v[200:203], a[0:3], v[164:167], 0
    v_lshlrev_b32 v138, 16, v37
    ds_read_b128 v[176:179], v5 offset:4096
    v_mfma_f32_16x16x32_bf16 v[208:211], a[0:3], v[168:171], 0
    buffer_load_dwordx4 a[76:79], v1, s[16:19], s60 offen offset:3072 sc1
    v_mfma_f32_16x16x32_bf16 v[216:219], a[0:3], v[172:175], 0
    s_add_u32 s60, s44, 32768
    ds_read_b128 v[180:183], v5 offset:5120
    v_mfma_f32_16x16x32_bf16 v[196:199], a[4:7], v[160:163], 0
    v_lshlrev_b32 v139, 16, v39
    v_and_b32 v140, s10, v33
    v_mfma_f32_16x16x32_bf16 v[204:207], a[4:7], v[164:167], 0
    buffer_load_dwordx4 a[80:83], v1, s[16:19], s60 offen sc1
    v_and_b32 v141, s10, v35
    v_and_b32 v142, s10, v37
    v_and_b32 v143, s10, v39
    ds_read_b128 v[184:187], v5 offset:6144
    v_mfma_f32_16x16x32_bf16 v[212:215], a[4:7], v[168:171], 0
    buffer_load_dwordx4 a[84:87], v1, s[16:19], s60 offen offset:1024 sc1
    v_and_b32 v144, s10, v47
    v_and_b32 v145, s10, v45
    v_and_b32 v146, s10, v43
    v_mfma_f32_16x16x32_bf16 v[220:223], a[4:7], v[172:175], 0
    buffer_load_dwordx4 a[88:91], v1, s[16:19], s60 offen offset:2048 sc1
    v_and_b32 v147, s10, v41
    v_lshlrev_b32 v148, 16, v47
    ds_read_b128 v[188:191], v5 offset:7168
    v_mfma_f32_16x16x32_bf16 v[224:227], a[32:35], v[160:163], 0
    buffer_load_dwordx4 a[92:95], v1, s[16:19], s60 offen offset:3072 sc1
    v_lshlrev_b32 v149, 16, v45
    v_lshlrev_b32 v150, 16, v43
    s_add_u32 s60, s45, 4096
    v_lshlrev_b32 v151, 16, v41
    v_mfma_f32_16x16x32_bf16 v[232:235], a[32:35], v[164:167], 0
    buffer_load_dwordx4 a[96:99], v1, s[16:19], s60 offen sc1
    v_and_b32 v152, s10, v46
    v_and_b32 v153, s10, v44
    v_mfma_f32_16x16x32_bf16 v[240:243], a[32:35], v[168:171], 0
    v_and_b32 v154, s10, v42
    buffer_load_dwordx4 a[100:103], v1, s[16:19], s60 offen offset:1024 sc1
    v_and_b32 v155, s10, v40
    v_lshlrev_b32 v156, 16, v46
    v_mfma_f32_16x16x32_bf16 v[248:251], a[32:35], v[172:175], 0
    buffer_load_dwordx4 a[104:107], v1, s[16:19], s60 offen offset:2048 sc1
    v_lshlrev_b32 v157, 16, v44
    v_lshlrev_b32 v158, 16, v42
    v_mfma_f32_16x16x32_bf16 v[228:231], a[36:39], v[160:163], 0
    v_lshlrev_b32 v159, 16, v40
    buffer_load_dwordx4 a[108:111], v1, s[16:19], s60 offen offset:3072 sc1
    s_waitcnt vmcnt(28)
    v_max3_u32 v28, v48, v52, v56
    v_mfma_f32_16x16x32_bf16 v[236:239], a[36:39], v[164:167], 0
    s_add_u32 s60, s45, 32768
    v_max3_u32 v28, v28, v60, v8
    v_cmp_eq_u32 vcc, -1, v28
    s_nop 3
    s_cbranch_vccnz vrt_m_28
vbk_m_29:
    v_mfma_f32_16x16x32_bf16 v[244:247], a[36:39], v[168:171], 0
    buffer_load_dwordx4 a[112:115], v1, s[16:19], s60 offen sc1
    v_mov_b32_dpp v28, v8 row_shr:11 row_mask:0xf bank_mask:0xf
    v_mov_b32_dpp v29, v8 row_shr:10 row_mask:0xf bank_mask:0xf
    v_mfma_f32_16x16x32_bf16 v[252:255], a[36:39], v[172:175], 0
    buffer_load_dwordx4 a[116:119], v1, s[16:19], s60 offen offset:1024 sc1
    v_mov_b32_dpp v30, v8 row_shr:9 row_mask:0xf bank_mask:0xf
    v_mov_b32_dpp v31, v8 row_shr:8 row_mask:0xf bank_mask:0xf
    v_mov_b32_dpp v28, v48 row_shl:1 row_mask:0xf bank_mask:0xf
    s_waitcnt lgkmcnt(0)
    v_mfma_f32_16x16x32_bf16 v[192:195], a[8:11], v[176:179], v[192:195]
    buffer_load_dwordx4 a[120:123], v1, s[16:19], s60 offen offset:2048 sc1
    v_mov_b32_dpp v29, v52 row_shl:1 row_mask:0xf bank_mask:0xf
    v_mov_b32_dpp v30, v56 row_shl:1 row_mask:0xf bank_mask:0xf
    v_mfma_f32_16x16x32_bf16 v[200:203], a[8:11], v[180:183], v[200:203]
    buffer_load_dwordx4 a[124:127], v1, s[16:19], s60 offen offset:3072 sc1
    v_mov_b32_dpp v31, v60 row_shl:1 row_mask:0xf bank_mask:0xf
    v_swap_b32 v49, v52
    s_add_u32 s48, s59, 512
    ds_read_b128 v[160:163], v13 offset:32768
    v_mfma_f32_16x16x32_bf16 v[208:211], a[8:11], v[184:187], v[208:211]
    buffer_load_dwordx4 v[64:67], v4, s[16:19], s48 offen sc1
    v_swap_b32 v50, v56
    v_mfma_f32_16x16x32_bf16 v[216:219], a[8:11], v[188:191], v[216:219]
    v_swap_b32 v51, v60
    buffer_load_dwordx4 v[68:71], v4, s[16:19], s48 offen offset:1280 sc1
    ds_read_b128 v[164:167], v13 offset:33792
    v_mfma_f32_16x16x32_bf16 v[196:199], a[12:15], v[176:179], v[196:199]
    v_swap_b32 v54, v57
    buffer_load_dwordx4 v[72:75], v4, s[16:19], s48 offen offset:2560 sc1
    v_swap_b32 v55, v61
    v_mfma_f32_16x16x32_bf16 v[204:207], a[12:15], v[180:183], v[204:207]
    buffer_load_dwordx4 v[76:79], v4, s[16:19], s48 offen offset:3840 sc1
    v_swap_b32 v59, v62
    v_mfma_f32_16x16x32_bf16 v[156:159], v[28:31], v[20:23], v[156:159]
    s_add_u32 s48, s59, 768
    v_mfma_f32_16x16x32_bf16 v[128:131], v[48:51], v[16:19], v[128:131]
    ds_read_b128 v[168:171], v13 offset:34816
    v_mfma_f32_16x16x32_bf16 v[212:215], a[12:15], v[184:187], v[212:215]
    buffer_load_dwordx4 v[80:83], v4, s[16:19], s48 offen sc1
    v_mfma_f32_16x16x32_bf16 v[132:135], v[52:55], v[16:19], v[132:135]
    buffer_load_dwordx4 v[84:87], v4, s[16:19], s48 offen offset:1280 sc1
    v_mfma_f32_16x16x32_bf16 v[136:139], v[56:59], v[16:19], v[136:139]
    buffer_load_dwordx4 v[88:91], v4, s[16:19], s48 offen offset:2560 sc1
    v_mfma_f32_16x16x32_bf16 v[140:143], v[60:63], v[16:19], v[140:143]
    v_mfma_f32_16x16x32_bf16 v[144:147], v[52:55], v[20:23], v[144:147]
    v_mfma_f32_16x16x32_bf16 v[148:151], v[56:59], v[20:23], v[148:151]
    v_mfma_f32_16x16x32_bf16 v[152:155], v[60:63], v[20:23], v[152:155]
    ds_read_b128 v[48:51], v11 offset:16384
    ds_read_b128 v[52:55], v11 offset:20480
    v_mfma_f32_16x16x32_bf16 v[220:223], a[12:15], v[188:191], v[220:223]
    ds_read_b128 v[56:59], v12 offset:16384
    ds_read_b128 v[172:175], v13 offset:35840
    v_mfma_f32_16x16x32_bf16 v[224:227], a[40:43], v[176:179], v[224:227]
    buffer_load_dwordx4 v[92:95], v4, s[16:19], s48 offen offset:3840 sc1
    v_mfma_f32_16x16x32_bf16 v[232:235], a[40:43], v[180:183], v[232:235]
    buffer_load_dword v9, v7, s[16:19], s59 offen sc1
    v_mfma_f32_16x16x32_bf16 v[240:243], a[40:43], v[184:187], v[240:243]
    s_add_u32 s48, s59, 1024
    ds_read_b128 v[60:63], v12 offset:20480
    v_mfma_f32_16x16x32_bf16 v[248:251], a[40:43], v[188:191], v[248:251]
    buffer_load_dwordx4 v[96:99], v4, s[16:19], s48 offen sc1
    v_mfma_f32_16x16x32_bf16 v[228:231], a[44:47], v[176:179], v[228:231]
    buffer_load_dwordx4 v[100:103], v4, s[16:19], s48 offen offset:1280 sc1
    v_mfma_f32_16x16x32_bf16 v[236:239], a[44:47], v[180:183], v[236:239]
    buffer_load_dwordx4 v[104:107], v4, s[16:19], s48 offen offset:2560 sc1
    v_cvt_pk_bf16_f32 v32, v128, v132
    v_mfma_f32_16x16x32_bf16 v[244:247], a[44:47], v[184:187], v[244:247]
    v_cvt_pk_bf16_f32 v33, v136, v140
    v_cvt_pk_bf16_f32 v34, v129, v133
    v_mfma_f32_16x16x32_bf16 v[252:255], a[44:47], v[188:191], v[252:255]
    buffer_load_dwordx4 v[108:111], v4, s[16:19], s48 offen offset:3840 sc1
    v_cvt_pk_bf16_f32 v35, v137, v141
    s_waitcnt lgkmcnt(1)
    v_mfma_f32_16x16x32_bf16 v[192:195], a[16:19], v[160:163], v[192:195]
    s_add_u32 s60, s44, 8192
    v_mfma_f32_16x16x32_bf16 v[200:203], a[16:19], v[164:167], v[200:203]
    ds_write_b128 v11, v[32:35] offset:8192
    buffer_load_dwordx4 a[128:131], v1, s[16:19], s60 offen sc1
    v_cvt_pk_bf16_f32 v36, v130, v134
    ds_read_b128 v[176:179], v13 offset:36864
    v_mfma_f32_16x16x32_bf16 v[208:211], a[16:19], v[168:171], v[208:211]
    buffer_load_dwordx4 a[132:135], v1, s[16:19], s60 offen offset:1024 sc1
    v_cvt_pk_bf16_f32 v37, v138, v142
    v_cvt_pk_bf16_f32 v38, v131, v135
    v_mfma_f32_16x16x32_bf16 v[216:219], a[16:19], v[172:175], v[216:219]
    buffer_load_dwordx4 a[136:139], v1, s[16:19], s60 offen offset:2048 sc1
    v_cvt_pk_bf16_f32 v39, v139, v143
    ds_read_b128 v[180:183], v13 offset:37888
    v_mfma_f32_16x16x32_bf16 v[196:199], a[20:23], v[160:163], v[196:199]
    buffer_load_dwordx4 a[140:143], v1, s[16:19], s60 offen offset:3072 sc1
    s_add_u32 s60, s44, 28672
    v_mfma_f32_16x16x32_bf16 v[204:207], a[20:23], v[164:167], v[204:207]
    ds_write_b128 v11, v[36:39] offset:12288
    buffer_load_dwordx4 a[144:147], v1, s[16:19], s60 offen sc1
    v_cvt_pk_bf16_f32 v40, v159, v155
    ds_read_b128 v[184:187], v13 offset:38912
    v_mfma_f32_16x16x32_bf16 v[212:215], a[20:23], v[168:171], v[212:215]
    buffer_load_dwordx4 a[148:151], v1, s[16:19], s60 offen offset:1024 sc1
    v_cvt_pk_bf16_f32 v41, v151, v147
    v_cvt_pk_bf16_f32 v42, v158, v154
    v_cvt_pk_bf16_f32 v43, v150, v146
    v_mfma_f32_16x16x32_bf16 v[220:223], a[20:23], v[172:175], v[220:223]
    buffer_load_dwordx4 a[152:155], v1, s[16:19], s60 offen offset:2048 sc1
    ds_read_b128 v[188:191], v13 offset:39936
    v_mfma_f32_16x16x32_bf16 v[224:227], a[48:51], v[160:163], v[224:227]
    buffer_load_dwordx4 a[156:159], v1, s[16:19], s60 offen offset:3072 sc1
    v_mfma_f32_16x16x32_bf16 v[232:235], a[48:51], v[164:167], v[232:235]
    ds_write_b128 v12, v[40:43] offset:24576
    s_add_u32 s60, s45, 8192
    v_cvt_pk_bf16_f32 v44, v157, v153
    v_mfma_f32_16x16x32_bf16 v[240:243], a[48:51], v[168:171], v[240:243]
    buffer_load_dwordx4 a[160:163], v1, s[16:19], s60 offen sc1
    v_cvt_pk_bf16_f32 v45, v149, v145
    v_cvt_pk_bf16_f32 v46, v156, v152
    v_cvt_pk_bf16_f32 v47, v148, v144
    v_mfma_f32_16x16x32_bf16 v[248:251], a[48:51], v[172:175], v[248:251]
    buffer_load_dwordx4 a[164:167], v1, s[16:19], s60 offen offset:1024 sc1
    v_mfma_f32_16x16x32_bf16 v[228:231], a[52:55], v[160:163], v[228:231]
    buffer_load_dwordx4 a[168:171], v1, s[16:19], s60 offen offset:2048 sc1
    v_mfma_f32_16x16x32_bf16 v[236:239], a[52:55], v[164:167], v[236:239]
    buffer_load_dwordx4 a[172:175], v1, s[16:19], s60 offen offset:3072 sc1
    s_add_u32 s60, s45, 28672
    v_mfma_f32_16x16x32_bf16 v[244:247], a[52:55], v[168:171], v[244:247]
    buffer_load_dwordx4 a[176:179], v1, s[16:19], s60 offen sc1
    v_mfma_f32_16x16x32_bf16 v[252:255], a[52:55], v[172:175], v[252:255]
    buffer_load_dwordx4 a[180:183], v1, s[16:19], s60 offen offset:1024 sc1
    ds_write_b128 v12, v[44:47] offset:28672
    buffer_load_dwordx4 a[184:187], v1, s[16:19], s60 offen offset:2048 sc1
    buffer_load_dwordx4 a[188:191], v1, s[16:19], s60 offen offset:3072 sc1
    s_waitcnt lgkmcnt(0)
    s_barrier
    s_waitcnt lgkmcnt(2)
    v_mfma_f32_16x16x32_bf16 v[192:195], a[24:27], v[176:179], v[192:195]
    s_waitcnt lgkmcnt(8)
    v_min_u32 v24, 26, v0
    v_mfma_f32_16x16x32_bf16 v[200:203], a[24:27], v[180:183], v[200:203]
    v_lshlrev_b32 v128, 16, v48
    ds_read_b128 v[160:163], v5 offset:8192
    v_mfma_f32_16x16x32_bf16 v[208:211], a[24:27], v[184:187], v[208:211]
    v_lshlrev_b32 v129, 16, v50
    v_lshlrev_b32 v130, 16, v52
    v_mfma_f32_16x16x32_bf16 v[216:219], a[24:27], v[188:191], v[216:219]
    v_lshlrev_b32 v24, 7, v24
    v_lshlrev_b32 v131, 16, v54
    ds_read_b128 v[164:167], v5 offset:9216
    v_mfma_f32_16x16x32_bf16 v[196:199], a[28:31], v[176:179], v[196:199]
    v_and_b32 v132, s10, v48
    v_and_b32 v133, s10, v50
    v_mfma_f32_16x16x32_bf16 v[204:207], a[28:31], v[180:183], v[204:207]
    v_add_u32 v24, 29223680, v24
    v_and_b32 v134, s10, v52
    v_and_b32 v135, s10, v54
    ds_read_b128 v[168:171], v5 offset:10240
    v_mfma_f32_16x16x32_bf16 v[212:215], a[28:31], v[184:187], v[212:215]
    v_lshlrev_b32 v136, 16, v49
    v_lshlrev_b32 v137, 16, v51
    v_mfma_f32_16x16x32_bf16 v[220:223], a[28:31], v[188:191], v[220:223]
    v_lshlrev_b32 v138, 16, v53
    v_lshlrev_b32 v139, 16, v55
    ds_read_b128 v[172:175], v5 offset:11264
    v_mfma_f32_16x16x32_bf16 v[224:227], a[56:59], v[176:179], v[224:227]
    buffer_load_dwordx2 v[26:27], v24, s[16:19], 0 offen sc1
    v_and_b32 v140, s10, v49
    v_and_b32 v141, s10, v51
    v_mfma_f32_16x16x32_bf16 v[232:235], a[56:59], v[180:183], v[232:235]
    v_and_b32 v142, s10, v53
    s_add_u32 s60, s44, 12288
    v_and_b32 v143, s10, v55
    v_mfma_f32_16x16x32_bf16 v[240:243], a[56:59], v[184:187], v[240:243]
    v_and_b32 v144, s10, v63
    v_and_b32 v145, s10, v61
    v_mfma_f32_16x16x32_bf16 v[248:251], a[56:59], v[188:191], v[248:251]
    v_and_b32 v146, s10, v59
    v_and_b32 v147, s10, v57
    v_mfma_f32_16x16x32_bf16 v[228:231], a[60:63], v[176:179], v[228:231]
    buffer_load_dwordx4 a[192:195], v1, s[16:19], s60 offen sc1
    v_lshlrev_b32 v148, 16, v63
    v_lshlrev_b32 v149, 16, v61
    v_mfma_f32_16x16x32_bf16 v[236:239], a[60:63], v[180:183], v[236:239]
    v_lshlrev_b32 v150, 16, v59
    v_lshlrev_b32 v151, 16, v57
    v_mfma_f32_16x16x32_bf16 v[244:247], a[60:63], v[184:187], v[244:247]
    v_and_b32 v152, s10, v62
    v_and_b32 v153, s10, v60
    v_mfma_f32_16x16x32_bf16 v[252:255], a[60:63], v[188:191], v[252:255]
    v_and_b32 v154, s10, v58
    v_and_b32 v155, s10, v56
    s_waitcnt vmcnt(31) lgkmcnt(0)
    v_mfma_f32_16x16x32_bf16 v[192:195], a[64:67], v[160:163], v[192:195]
    buffer_load_dwordx4 a[196:199], v1, s[16:19], s60 offen offset:1024 sc1
    v_lshlrev_b32 v156, 16, v62
    v_lshlrev_b32 v157, 16, v60
    v_mfma_f32_16x16x32_bf16 v[200:203], a[64:67], v[164:167], v[200:203]
    v_lshlrev_b32 v158, 16, v58
    v_lshlrev_b32 v159, 16, v56
    ds_read_b128 v[176:179], v5 offset:12288
    v_mfma_f32_16x16x32_bf16 v[208:211], a[64:67], v[168:171], v[208:211]
    buffer_load_dwordx4 a[200:203], v1, s[16:19], s60 offen offset:2048 sc1
    s_waitcnt vmcnt(29)
    v_max3_u32 v28, v64, v68, v72
    v_mfma_f32_16x16x32_bf16 v[216:219], a[64:67], v[172:175], v[216:219]
    v_max3_u32 v28, v28, v76, v8
    ds_read_b128 v[180:183], v5 offset:13312
    v_mfma_f32_16x16x32_bf16 v[196:199], a[68:71], v[160:163], v[196:199]
    v_cmp_eq_u32 vcc, -1, v28
    s_nop 3
    s_cbranch_vccnz vrt_m_31
vbk_m_32:
    v_mov_b32_dpp v28, v8 row_shr:7 row_mask:0xf bank_mask:0xf
    v_mfma_f32_16x16x32_bf16 v[204:207], a[68:71], v[164:167], v[204:207]
    v_mov_b32_dpp v29, v8 row_shr:6 row_mask:0xf bank_mask:0xf
    v_mov_b32_dpp v30, v8 row_shr:5 row_mask:0xf bank_mask:0xf
    ds_read_b128 v[184:187], v5 offset:14336
    v_mfma_f32_16x16x32_bf16 v[212:215], a[68:71], v[168:171], v[212:215]
    buffer_load_dwordx4 a[204:207], v1, s[16:19], s60 offen offset:3072 sc1
    v_mov_b32_dpp v31, v8 row_shr:4 row_mask:0xf bank_mask:0xf
    v_mov_b32_dpp v28, v64 row_shl:1 row_mask:0xf bank_mask:0xf
    v_mfma_f32_16x16x32_bf16 v[220:223], a[68:71], v[172:175], v[220:223]
    v_mov_b32_dpp v29, v68 row_shl:1 row_mask:0xf bank_mask:0xf
    v_mov_b32_dpp v30, v72 row_shl:1 row_mask:0xf bank_mask:0xf
    ds_read_b128 v[188:191], v5 offset:15360
    v_mfma_f32_16x16x32_bf16 v[224:227], a[96:99], v[160:163], v[224:227]
    s_add_u32 s60, s44, 24576
    v_mov_b32_dpp v31, v76 row_shl:1 row_mask:0xf bank_mask:0xf
    v_mfma_f32_16x16x32_bf16 v[232:235], a[96:99], v[164:167], v[232:235]
    v_swap_b32 v65, v68
    v_mfma_f32_16x16x32_bf16 v[240:243], a[96:99], v[168:171], v[240:243]
    buffer_load_dwordx4 a[208:211], v1, s[16:19], s60 offen sc1
    v_swap_b32 v66, v72
    v_mfma_f32_16x16x32_bf16 v[248:251], a[96:99], v[172:175], v[248:251]
    v_swap_b32 v67, v76
    v_mfma_f32_16x16x32_bf16 v[228:231], a[100:103], v[160:163], v[228:231]
    v_swap_b32 v70, v73
    v_mfma_f32_16x16x32_bf16 v[236:239], a[100:103], v[164:167], v[236:239]
    buffer_load_dwordx4 a[212:215], v1, s[16:19], s60 offen offset:1024 sc1
    v_swap_b32 v71, v77
    v_mfma_f32_16x16x32_bf16 v[244:247], a[100:103], v[168:171], v[244:247]
    v_swap_b32 v75, v78
    v_mfma_f32_16x16x32_bf16 v[156:159], v[28:31], v[20:23], v[156:159]
    buffer_load_dwordx4 a[216:219], v1, s[16:19], s60 offen offset:2048 sc1
    v_mfma_f32_16x16x32_bf16 v[128:131], v[64:67], v[16:19], v[128:131]
    v_mfma_f32_16x16x32_bf16 v[132:135], v[68:71], v[16:19], v[132:135]
    v_mfma_f32_16x16x32_bf16 v[136:139], v[72:75], v[16:19], v[136:139]
    v_mfma_f32_16x16x32_bf16 v[140:143], v[76:79], v[16:19], v[140:143]
    v_mfma_f32_16x16x32_bf16 v[144:147], v[68:71], v[20:23], v[144:147]
    v_mfma_f32_16x16x32_bf16 v[148:151], v[72:75], v[20:23], v[148:151]
    v_mfma_f32_16x16x32_bf16 v[152:155], v[76:79], v[20:23], v[152:155]
    ds_read_b128 v[64:67], v11 offset:24576
    ds_read_b128 v[68:71], v11 offset:28672
    v_mfma_f32_16x16x32_bf16 v[252:255], a[100:103], v[172:175], v[252:255]
    ds_read_b128 v[72:75], v12 offset:8192
    s_waitcnt lgkmcnt(3)
    v_mfma_f32_16x16x32_bf16 v[192:195], a[72:75], v[176:179], v[192:195]
    buffer_load_dwordx4 a[220:223], v1, s[16:19], s60 offen offset:3072 sc1
    v_mfma_f32_16x16x32_bf16 v[200:203], a[72:75], v[180:183], v[200:203]
    ds_read_b128 v[76:79], v12 offset:12288
    ds_read_b128 v[160:163], v13 offset:24576
    v_mfma_f32_16x16x32_bf16 v[208:211], a[72:75], v[184:187], v[208:211]
    v_cvt_pk_bf16_f32 v48, v128, v132
    v_cvt_pk_bf16_f32 v49, v136, v140
    v_mfma_f32_16x16x32_bf16 v[216:219], a[72:75], v[188:191], v[216:219]
    s_add_u32 s60, s45, 12288
    ds_read_b128 v[164:167], v13 offset:25600
    v_mfma_f32_16x16x32_bf16 v[196:199], a[76:79], v[176:179], v[196:199]
    v_cvt_pk_bf16_f32 v50, v129, v133
    v_cvt_pk_bf16_f32 v51, v137, v141
    v_mfma_f32_16x16x32_bf16 v[204:207], a[76:79], v[180:183], v[204:207]
    ds_read_b128 v[168:171], v13 offset:26624
    v_mfma_f32_16x16x32_bf16 v[212:215], a[76:79], v[184:187], v[212:215]
    buffer_load_dwordx4 a[224:227], v1, s[16:19], s60 offen sc1
    v_mfma_f32_16x16x32_bf16 v[220:223], a[76:79], v[188:191], v[220:223]
    ds_read_b128 v[172:175], v13 offset:27648
    v_mfma_f32_16x16x32_bf16 v[224:227], a[104:107], v[176:179], v[224:227]
    buffer_load_dwordx4 a[228:231], v1, s[16:19], s60 offen offset:1024 sc1
    v_mfma_f32_16x16x32_bf16 v[232:235], a[104:107], v[180:183], v[232:235]
    v_mfma_f32_16x16x32_bf16 v[240:243], a[104:107], v[184:187], v[240:243]
    v_mfma_f32_16x16x32_bf16 v[248:251], a[104:107], v[188:191], v[248:251]
    buffer_load_dwordx4 a[232:235], v1, s[16:19], s60 offen offset:2048 sc1
    v_mfma_f32_16x16x32_bf16 v[228:231], a[108:111], v[176:179], v[228:231]
    v_mfma_f32_16x16x32_bf16 v[236:239], a[108:111], v[180:183], v[236:239]
    ds_write_b128 v11, v[48:51] offset:16384
    v_cvt_pk_bf16_f32 v52, v130, v134
    v_mfma_f32_16x16x32_bf16 v[244:247], a[108:111], v[184:187], v[244:247]
    v_cvt_pk_bf16_f32 v53, v138, v142
    v_cvt_pk_bf16_f32 v54, v131, v135
    v_mfma_f32_16x16x32_bf16 v[252:255], a[108:111], v[188:191], v[252:255]
    v_cvt_pk_bf16_f32 v55, v139, v143
    s_waitcnt lgkmcnt(1)
    v_mfma_f32_16x16x32_bf16 v[192:195], a[80:83], v[160:163], v[192:195]
    buffer_load_dwordx4 a[236:239], v1, s[16:19], s60 offen offset:3072 sc1
    v_mfma_f32_16x16x32_bf16 v[200:203], a[80:83], v[164:167], v[200:203]
    s_add_u32 s60, s45, 24576
    ds_read_b128 v[176:179], v13 offset:28672
    v_mfma_f32_16x16x32_bf16 v[208:211], a[80:83], v[168:171], v[208:211]
    ds_write_b128 v11, v[52:55] offset:20480
    v_cvt_pk_bf16_f32 v56, v159, v155
    v_mfma_f32_16x16x32_bf16 v[216:219], a[80:83], v[172:175], v[216:219]
    v_cvt_pk_bf16_f32 v57, v151, v147
    v_cvt_pk_bf16_f32 v58, v158, v154
    ds_read_b128 v[180:183], v13 offset:29696
    v_mfma_f32_16x16x32_bf16 v[196:199], a[84:87], v[160:163], v[196:199]
    v_cvt_pk_bf16_f32 v59, v150, v146
    v_mfma_f32_16x16x32_bf16 v[204:207], a[84:87], v[164:167], v[204:207]
    ds_read_b128 v[184:187], v13 offset:30720
    v_mfma_f32_16x16x32_bf16 v[212:215], a[84:87], v[168:171], v[212:215]
    buffer_load_dwordx4 a[240:243], v1, s[16:19], s60 offen sc1
    v_mfma_f32_16x16x32_bf16 v[220:223], a[84:87], v[172:175], v[220:223]
    ds_write_b128 v12, v[56:59] offset:16384
    v_cvt_pk_bf16_f32 v60, v157, v153
    ds_read_b128 v[188:191], v13 offset:31744
    v_mfma_f32_16x16x32_bf16 v[224:227], a[112:115], v[160:163], v[224:227]
    v_cvt_pk_bf16_f32 v61, v149, v145
    v_cvt_pk_bf16_f32 v62, v156, v152
    v_mfma_f32_16x16x32_bf16 v[232:235], a[112:115], v[164:167], v[232:235]
    buffer_load_dwordx4 a[244:247], v1, s[16:19], s60 offen offset:1024 sc1
    v_cvt_pk_bf16_f32 v63, v148, v144
    v_mfma_f32_16x16x32_bf16 v[240:243], a[112:115], v[168:171], v[240:243]
    buffer_load_dwordx4 a[248:251], v1, s[16:19], s60 offen offset:2048 sc1
    v_mfma_f32_16x16x32_bf16 v[248:251], a[112:115], v[172:175], v[248:251]
    v_mfma_f32_16x16x32_bf16 v[228:231], a[116:119], v[160:163], v[228:231]
    buffer_load_dwordx4 a[252:255], v1, s[16:19], s60 offen offset:3072 sc1
    v_mfma_f32_16x16x32_bf16 v[236:239], a[116:119], v[164:167], v[236:239]
    v_mfma_f32_16x16x32_bf16 v[244:247], a[116:119], v[168:171], v[244:247]
    v_mfma_f32_16x16x32_bf16 v[252:255], a[116:119], v[172:175], v[252:255]
    ds_write_b128 v12, v[60:63] offset:20480
    s_waitcnt lgkmcnt(0)
    s_barrier
    s_waitcnt lgkmcnt(1)
    v_mfma_f32_16x16x32_bf16 v[192:195], a[88:91], v[176:179], v[192:195]
    s_waitcnt lgkmcnt(12)
    v_lshlrev_b32 v128, 16, v64
    v_mfma_f32_16x16x32_bf16 v[200:203], a[88:91], v[180:183], v[200:203]
    v_lshlrev_b32 v129, 16, v66
    ds_read_b128 v[160:163], v5 offset:16384
    v_mfma_f32_16x16x32_bf16 v[208:211], a[88:91], v[184:187], v[208:211]
    v_lshlrev_b32 v130, 16, v68
    v_lshlrev_b32 v131, 16, v70
    v_mfma_f32_16x16x32_bf16 v[216:219], a[88:91], v[188:191], v[216:219]
    v_and_b32 v132, s10, v64
    ds_read_b128 v[164:167], v5 offset:17408
    v_mfma_f32_16x16x32_bf16 v[196:199], a[92:95], v[176:179], v[196:199]
    v_and_b32 v133, s10, v66
    v_and_b32 v134, s10, v68
    v_mfma_f32_16x16x32_bf16 v[204:207], a[92:95], v[180:183], v[204:207]
    v_and_b32 v135, s10, v70
    ds_read_b128 v[168:171], v5 offset:18432
    v_mfma_f32_16x16x32_bf16 v[212:215], a[92:95], v[184:187], v[212:215]
    v_lshlrev_b32 v136, 16, v65
    v_lshlrev_b32 v137, 16, v67
    v_mfma_f32_16x16x32_bf16 v[220:223], a[92:95], v[188:191], v[220:223]
    v_lshlrev_b32 v138, 16, v69
    v_lshlrev_b32 v139, 16, v71
    ds_read_b128 v[172:175], v5 offset:19456
    v_mfma_f32_16x16x32_bf16 v[224:227], a[120:123], v[176:179], v[224:227]
    v_and_b32 v140, s10, v65
    v_and_b32 v141, s10, v67
    v_mfma_f32_16x16x32_bf16 v[232:235], a[120:123], v[180:183], v[232:235]
    v_and_b32 v142, s10, v69
    v_and_b32 v143, s10, v71
    v_mfma_f32_16x16x32_bf16 v[240:243], a[120:123], v[184:187], v[240:243]
    v_and_b32 v144, s10, v79
    v_and_b32 v145, s10, v77
    v_mfma_f32_16x16x32_bf16 v[248:251], a[120:123], v[188:191], v[248:251]
    v_and_b32 v146, s10, v75
    v_and_b32 v147, s10, v73
    v_mfma_f32_16x16x32_bf16 v[228:231], a[124:127], v[176:179], v[228:231]
    v_lshlrev_b32 v148, 16, v79
    v_lshlrev_b32 v149, 16, v77
    v_mfma_f32_16x16x32_bf16 v[236:239], a[124:127], v[180:183], v[236:239]
    v_lshlrev_b32 v150, 16, v75
    v_lshlrev_b32 v151, 16, v73
    v_mfma_f32_16x16x32_bf16 v[244:247], a[124:127], v[184:187], v[244:247]
    v_and_b32 v152, s10, v78
    v_and_b32 v153, s10, v76
    v_mfma_f32_16x16x32_bf16 v[252:255], a[124:127], v[188:191], v[252:255]
    v_and_b32 v154, s10, v74
    v_and_b32 v155, s10, v72
    s_waitcnt vmcnt(17) lgkmcnt(0)
    v_mfma_f32_16x16x32_bf16 v[192:195], a[128:131], v[160:163], v[192:195]
    v_lshlrev_b32 v156, 16, v78
    v_lshlrev_b32 v157, 16, v76
    v_mfma_f32_16x16x32_bf16 v[200:203], a[128:131], v[164:167], v[200:203]
    v_lshlrev_b32 v158, 16, v74
    v_lshlrev_b32 v159, 16, v72
    ds_read_b128 v[176:179], v5 offset:20480
    v_mfma_f32_16x16x32_bf16 v[208:211], a[128:131], v[168:171], v[208:211]
    s_waitcnt vmcnt(38)
    v_max3_u32 v28, v80, v84, v88
    v_mfma_f32_16x16x32_bf16 v[216:219], a[128:131], v[172:175], v[216:219]
    v_max3_u32 v28, v28, v92, v8
    ds_read_b128 v[180:183], v5 offset:21504
    v_mfma_f32_16x16x32_bf16 v[196:199], a[132:135], v[160:163], v[196:199]
    v_cmp_eq_u32 vcc, -1, v28
    s_nop 3
    s_cbranch_vccnz vrt_m_34
vbk_m_35:
    v_mov_b32_dpp v28, v8 row_shr:3 row_mask:0xf bank_mask:0xf
    v_mfma_f32_16x16x32_bf16 v[204:207], a[132:135], v[164:167], v[204:207]
    s_mov_b32 s55, 0
    s_add_u32 s54, s47, 1
    s_waitcnt vmcnt(16)
ploop_m_38:
    v_subrev_u32 v26, s54, v26
    v_xor_b32 v27, s46, v27
    v_lshl_or_b32 v26, v27, 3, v26
    v_and_b32 v27, -8, v27
    v_or_b32 v26, v26, v27
    v_cmp_le_u32 vcc, 7, v26
    s_add_u32 s55, s55, 1
    s_cmp_ge_u32 s55, 200000
    s_cbranch_scc1 pok_m_37
    s_nop 2
    s_cbranch_vccz pok_m_37
    s_sleep 1
    buffer_load_dwordx2 v[26:27], v24, s[16:19], 0 offen sc1
    s_waitcnt vmcnt(0)
    s_branch ploop_m_38
pok_m_37:
    v_mov_b32_dpp v29, v8 row_shr:2 row_mask:0xf bank_mask:0xf
    v_mov_b32_dpp v30, v8 row_shr:1 row_mask:0xf bank_mask:0xf
    ds_read_b128 v[184:187], v5 offset:22528
    v_mfma_f32_16x16x32_bf16 v[212:215], a[132:135], v[168:171], v[212:215]
    s_add_u32 s60, s44, 16384
    v_mov_b32 v31, v8
    v_mov_b32_dpp v28, v80 row_shl:1 row_mask:0xf bank_mask:0xf
    v_mfma_f32_16x16x32_bf16 v[220:223], a[132:135], v[172:175], v[220:223]
    buffer_load_dwordx4 a[0:3], v1, s[16:19], s60 offen sc1
    v_mov_b32_dpp v29, v84 row_shl:1 row_mask:0xf bank_mask:0xf
    v_mov_b32_dpp v30, v88 row_shl:1 row_mask:0xf bank_mask:0xf
    ds_read_b128 v[188:191], v5 offset:23552
    v_mfma_f32_16x16x32_bf16 v[224:227], a[160:163], v[160:163], v[224:227]
    buffer_load_dwordx4 a[4:7], v1, s[16:19], s60 offen offset:1024 sc1
    v_mov_b32_dpp v31, v92 row_shl:1 row_mask:0xf bank_mask:0xf
    v_mfma_f32_16x16x32_bf16 v[232:235], a[160:163], v[164:167], v[232:235]
    v_swap_b32 v81, v84
    v_mfma_f32_16x16x32_bf16 v[240:243], a[160:163], v[168:171], v[240:243]
    buffer_load_dwordx4 a[8:11], v1, s[16:19], s60 offen offset:2048 sc1
    v_swap_b32 v82, v88
    v_mfma_f32_16x16x32_bf16 v[248:251], a[160:163], v[172:175], v[248:251]
    v_swap_b32 v83, v92
    v_mfma_f32_16x16x32_bf16 v[228:231], a[164:167], v[160:163], v[228:231]
    buffer_load_dwordx4 a[12:15], v1, s[16:19], s60 offen offset:3072 sc1
    v_swap_b32 v86, v89
    v_mfma_f32_16x16x32_bf16 v[236:239], a[164:167], v[164:167], v[236:239]
    s_add_u32 s60, s44, 20480
    v_swap_b32 v87, v93
    v_mfma_f32_16x16x32_bf16 v[244:247], a[164:167], v[168:171], v[244:247]
    buffer_load_dwordx4 a[16:19], v1, s[16:19], s60 offen sc1
    v_swap_b32 v91, v94
    v_mfma_f32_16x16x32_bf16 v[156:159], v[28:31], v[20:23], v[156:159]
    buffer_load_dwordx4 a[20:23], v1, s[16:19], s60 offen offset:1024 sc1
    v_mfma_f32_16x16x32_bf16 v[128:131], v[80:83], v[16:19], v[128:131]
    v_mfma_f32_16x16x32_bf16 v[132:135], v[84:87], v[16:19], v[132:135]
    v_mfma_f32_16x16x32_bf16 v[136:139], v[88:91], v[16:19], v[136:139]
    v_mfma_f32_16x16x32_bf16 v[140:143], v[92:95], v[16:19], v[140:143]
    v_mfma_f32_16x16x32_bf16 v[144:147], v[84:87], v[20:23], v[144:147]
    v_mfma_f32_16x16x32_bf16 v[148:151], v[88:91], v[20:23], v[148:151]
    v_mfma_f32_16x16x32_bf16 v[152:155], v[92:95], v[20:23], v[152:155]
    ds_read_b128 v[80:83], v11 offset:32768
    ds_read_b128 v[84:87], v11 offset:36864
    v_mfma_f32_16x16x32_bf16 v[252:255], a[164:167], v[172:175], v[252:255]
    ds_read_b128 v[88:91], v12 offset:0
    s_waitcnt lgkmcnt(3)
    v_mfma_f32_16x16x32_bf16 v[192:195], a[136:139], v[176:179], v[192:195]
    buffer_load_dwordx4 a[32:35], v1, s[16:19], s60 offen offset:2048 sc1
    v_mfma_f32_16x16x32_bf16 v[200:203], a[136:139], v[180:183], v[200:203]
    ds_read_b128 v[92:95], v12 offset:4096
    ds_read_b128 v[160:163], v13 offset:16384
    v_mfma_f32_16x16x32_bf16 v[208:211], a[136:139], v[184:187], v[208:211]
    buffer_load_dwordx4 a[36:39], v1, s[16:19], s60 offen offset:3072 sc1
    v_mfma_f32_16x16x32_bf16 v[216:219], a[136:139], v[188:191], v[216:219]
    s_add_u32 s60, s45, 16384
    ds_read_b128 v[164:167], v13 offset:17408
    v_mfma_f32_16x16x32_bf16 v[196:199], a[140:143], v[176:179], v[196:199]
    buffer_load_dwordx4 a[40:43], v1, s[16:19], s60 offen sc1
    v_mfma_f32_16x16x32_bf16 v[204:207], a[140:143], v[180:183], v[204:207]
    v_cvt_pk_bf16_f32 v64, v128, v132
    ds_read_b128 v[168:171], v13 offset:18432
    v_mfma_f32_16x16x32_bf16 v[212:215], a[140:143], v[184:187], v[212:215]
    buffer_load_dwordx4 a[44:47], v1, s[16:19], s60 offen offset:1024 sc1
    v_mfma_f32_16x16x32_bf16 v[220:223], a[140:143], v[188:191], v[220:223]
    v_cvt_pk_bf16_f32 v65, v136, v140
    ds_read_b128 v[172:175], v13 offset:19456
    v_mfma_f32_16x16x32_bf16 v[224:227], a[168:171], v[176:179], v[224:227]
    buffer_load_dwordx4 a[48:51], v1, s[16:19], s60 offen offset:2048 sc1
    v_mfma_f32_16x16x32_bf16 v[232:235], a[168:171], v[180:183], v[232:235]
    v_cvt_pk_bf16_f32 v66, v129, v133
    v_cvt_pk_bf16_f32 v67, v137, v141
    v_mfma_f32_16x16x32_bf16 v[240:243], a[168:171], v[184:187], v[240:243]
    buffer_load_dwordx4 a[52:55], v1, s[16:19], s60 offen offset:3072 sc1
    v_mfma_f32_16x16x32_bf16 v[248:251], a[168:171], v[188:191], v[248:251]
    s_add_u32 s60, s45, 20480
    v_mfma_f32_16x16x32_bf16 v[228:231], a[172:175], v[176:179], v[228:231]
    buffer_load_dwordx4 a[24:27], v1, s[16:19], s60 offen sc1
    v_mfma_f32_16x16x32_bf16 v[236:239], a[172:175], v[180:183], v[236:239]
    ds_write_b128 v11, v[64:67] offset:24576
    v_cvt_pk_bf16_f32 v68, v130, v134
    v_mfma_f32_16x16x32_bf16 v[244:247], a[172:175], v[184:187], v[244:247]
    v_cvt_pk_bf16_f32 v69, v138, v142
    v_cvt_pk_bf16_f32 v70, v131, v135
    v_mfma_f32_16x16x32_bf16 v[252:255], a[172:175], v[188:191], v[252:255]
    v_cvt_pk_bf16_f32 v71, v139, v143
    s_waitcnt lgkmcnt(1)
    v_mfma_f32_16x16x32_bf16 v[192:195], a[144:147], v[160:163], v[192:195]
    buffer_load_dwordx4 a[28:31], v1, s[16:19], s60 offen offset:1024 sc1
    v_mfma_f32_16x16x32_bf16 v[200:203], a[144:147], v[164:167], v[200:203]
    ds_read_b128 v[176:179], v13 offset:20480
    v_mfma_f32_16x16x32_bf16 v[208:211], a[144:147], v[168:171], v[208:211]
    ds_write_b128 v11, v[68:71] offset:28672
    v_cvt_pk_bf16_f32 v72, v159, v155
    v_mfma_f32_16x16x32_bf16 v[216:219], a[144:147], v[172:175], v[216:219]
    buffer_load_dwordx4 a[56:59], v1, s[16:19], s60 offen offset:2048 sc1
    v_cvt_pk_bf16_f32 v73, v151, v147
    v_cvt_pk_bf16_f32 v74, v158, v154
    ds_read_b128 v[180:183], v13 offset:21504
    v_mfma_f32_16x16x32_bf16 v[196:199], a[148:151], v[160:163], v[196:199]
    buffer_load_dwordx4 a[60:63], v1, s[16:19], s60 offen offset:3072 sc1
    v_cvt_pk_bf16_f32 v75, v150, v146
    v_mfma_f32_16x16x32_bf16 v[204:207], a[148:151], v[164:167], v[204:207]
    s_mul_i32 s60, s41, 5
    ds_read_b128 v[184:187], v13 offset:22528
    v_mfma_f32_16x16x32_bf16 v[212:215], a[148:151], v[168:171], v[212:215]
    s_add_u32 s60, s60, s8
    v_mfma_f32_16x16x32_bf16 v[220:223], a[148:151], v[172:175], v[220:223]
    ds_write_b128 v12, v[72:75] offset:8192
    v_cvt_pk_bf16_f32 v76, v157, v153
    ds_read_b128 v[188:191], v13 offset:23552
    v_mfma_f32_16x16x32_bf16 v[224:227], a[176:179], v[160:163], v[224:227]
    s_cmp_eq_u32 s41, 1073741824
    s_cselect_b32 s60, 1073741824, s60
    v_cvt_pk_bf16_f32 v77, v149, v145
    v_cvt_pk_bf16_f32 v78, v156, v152
    v_mfma_f32_16x16x32_bf16 v[232:235], a[176:179], v[164:167], v[232:235]
    buffer_load_dwordx4 a[64:67], v1, s[16:19], s60 offen sc1
    v_cvt_pk_bf16_f32 v79, v148, v144
    v_mfma_f32_16x16x32_bf16 v[240:243], a[176:179], v[168:171], v[240:243]
    buffer_load_dwordx4 a[68:71], v1, s[16:19], s60 offen offset:1024 sc1
    v_mfma_f32_16x16x32_bf16 v[248:251], a[176:179], v[172:175], v[248:251]
    buffer_load_dwordx4 a[72:75], v1, s[16:19], s60 offen offset:2048 sc1
    v_mfma_f32_16x16x32_bf16 v[228:231], a[180:183], v[160:163], v[228:231]
    buffer_load_dwordx4 a[76:79], v1, s[16:19], s60 offen offset:3072 sc1
    v_mfma_f32_16x16x32_bf16 v[236:239], a[180:183], v[164:167], v[236:239]
    s_add_u32 s60, s60, 4096
    v_mfma_f32_16x16x32_bf16 v[244:247], a[180:183], v[168:171], v[244:247]
    buffer_load_dwordx4 a[80:83], v1, s[16:19], s60 offen sc1
    v_mfma_f32_16x16x32_bf16 v[252:255], a[180:183], v[172:175], v[252:255]
    ds_write_b128 v12, v[76:79] offset:12288
    s_waitcnt lgkmcnt(0)
    s_barrier
    s_waitcnt lgkmcnt(1)
    v_mfma_f32_16x16x32_bf16 v[192:195], a[152:155], v[176:179], v[192:195]
    s_waitcnt lgkmcnt(12)
    s_mul_i32 s60, s42, 5
    v_mfma_f32_16x16x32_bf16 v[200:203], a[152:155], v[180:183], v[200:203]
    v_lshlrev_b32 v128, 16, v80
    ds_read_b128 v[160:163], v5 offset:24576
    v_mfma_f32_16x16x32_bf16 v[208:211], a[152:155], v[184:187], v[208:211]
    v_lshlrev_b32 v129, 16, v82
    s_add_u32 s60, s60, s8
    v_mfma_f32_16x16x32_bf16 v[216:219], a[152:155], v[188:191], v[216:219]
    v_lshlrev_b32 v130, 16, v84
    ds_read_b128 v[164:167], v5 offset:25600
    v_mfma_f32_16x16x32_bf16 v[196:199], a[156:159], v[176:179], v[196:199]
    v_lshlrev_b32 v131, 16, v86
    v_and_b32 v132, s10, v80
    v_mfma_f32_16x16x32_bf16 v[204:207], a[156:159], v[180:183], v[204:207]
    v_and_b32 v133, s10, v82
    v_and_b32 v134, s10, v84
    ds_read_b128 v[168:171], v5 offset:26624
    v_mfma_f32_16x16x32_bf16 v[212:215], a[156:159], v[184:187], v[212:215]
    s_cmp_eq_u32 s42, 1073741824
    s_cselect_b32 s60, 1073741824, s60
    v_and_b32 v135, s10, v86
    v_lshlrev_b32 v136, 16, v81
    v_mfma_f32_16x16x32_bf16 v[220:223], a[156:159], v[188:191], v[220:223]
    v_lshlrev_b32 v137, 16, v83
    v_lshlrev_b32 v138, 16, v85
    ds_read_b128 v[172:175], v5 offset:27648
    v_mfma_f32_16x16x32_bf16 v[224:227], a[184:187], v[176:179], v[224:227]
    buffer_load_dwordx4 a[84:87], v1, s[16:19], s60 offen sc1
    v_lshlrev_b32 v139, 16, v87
    v_and_b32 v140, s10, v81
    v_mfma_f32_16x16x32_bf16 v[232:235], a[184:187], v[180:183], v[232:235]
    buffer_load_dwordx4 a[96:99], v1, s[16:19], s60 offen offset:1024 sc1
    v_and_b32 v141, s10, v83
    v_and_b32 v142, s10, v85
    v_mfma_f32_16x16x32_bf16 v[240:243], a[184:187], v[184:187], v[240:243]
    v_and_b32 v143, s10, v87
    v_and_b32 v144, s10, v95
    v_mfma_f32_16x16x32_bf16 v[248:251], a[184:187], v[188:191], v[248:251]
    buffer_load_dwordx4 a[100:103], v1, s[16:19], s60 offen offset:2048 sc1
    v_and_b32 v145, s10, v93
    v_and_b32 v146, s10, v91
    v_mfma_f32_16x16x32_bf16 v[228:231], a[188:191], v[176:179], v[228:231]
    v_and_b32 v147, s10, v89
    v_lshlrev_b32 v148, 16, v95
    v_mfma_f32_16x16x32_bf16 v[236:239], a[188:191], v[180:183], v[236:239]
    buffer_load_dwordx4 a[104:107], v1, s[16:19], s60 offen offset:3072 sc1
    v_lshlrev_b32 v149, 16, v93
    v_lshlrev_b32 v150, 16, v91
    v_mfma_f32_16x16x32_bf16 v[244:247], a[188:191], v[184:187], v[244:247]
    v_lshlrev_b32 v151, 16, v89
    s_add_u32 s60, s60, 4096
    v_and_b32 v152, s10, v94
    v_mfma_f32_16x16x32_bf16 v[252:255], a[188:191], v[188:191], v[252:255]
    v_and_b32 v153, s10, v92
    s_waitcnt vmcnt(25) lgkmcnt(0)
    v_mfma_f32_16x16x32_bf16 v[192:195], a[192:195], v[160:163], v[192:195]
    buffer_load_dwordx4 a[108:111], v1, s[16:19], s60 offen sc1
    v_and_b32 v154, s10, v90
    v_and_b32 v155, s10, v88
    v_mfma_f32_16x16x32_bf16 v[200:203], a[192:195], v[164:167], v[200:203]
    v_lshlrev_b32 v156, 16, v94
    v_lshlrev_b32 v157, 16, v92
    ds_read_b128 v[176:179], v5 offset:28672
    v_mfma_f32_16x16x32_bf16 v[208:211], a[192:195], v[168:171], v[208:211]
    s_cmp_le_i32 s9, 0
    s_cselect_b32 s61, s7, s3
    v_lshlrev_b32 v158, 16, v90
    v_lshlrev_b32 v159, 16, v88
    v_mfma_f32_16x16x32_bf16 v[216:219], a[192:195], v[172:175], v[216:219]
    s_waitcnt vmcnt(59)
    v_max3_u32 v28, v96, v100, v104
    ds_read_b128 v[180:183], v5 offset:29696
    v_mfma_f32_16x16x32_bf16 v[196:199], a[196:199], v[160:163], v[196:199]
    s_mul_i32 s60, s61, 5120
    v_max3_u32 v28, v28, v108, v9
    v_mfma_f32_16x16x32_bf16 v[204:207], a[196:199], v[164:167], v[204:207]
    v_cmp_eq_u32 vcc, -1, v28
    s_nop 3
    s_cbranch_vccnz vrt_m_39
vbk_m_40:
    v_mov_b32_dpp v28, v9 row_shr:15 row_mask:0xf bank_mask:0xf
    ds_read_b128 v[184:187], v5 offset:30720
    v_mfma_f32_16x16x32_bf16 v[212:215], a[196:199], v[168:171], v[212:215]
    s_add_u32 s60, s60, s8
    v_mov_b32_dpp v29, v9 row_shr:14 row_mask:0xf bank_mask:0xf
    v_mov_b32_dpp v30, v9 row_shr:13 row_mask:0xf bank_mask:0xf
    v_mfma_f32_16x16x32_bf16 v[220:223], a[196:199], v[172:175], v[220:223]
    v_mov_b32_dpp v31, v9 row_shr:12 row_mask:0xf bank_mask:0xf
    v_mov_b32_dpp v28, v96 row_shl:1 row_mask:0xf bank_mask:0xf
    ds_read_b128 v[188:191], v5 offset:31744
    v_mfma_f32_16x16x32_bf16 v[224:227], a[224:227], v[160:163], v[224:227]
    buffer_load_dwordx4 a[112:115], v1, s[16:19], s60 offen sc1
    v_mov_b32_dpp v29, v100 row_shl:1 row_mask:0xf bank_mask:0xf
    v_mov_b32_dpp v30, v104 row_shl:1 row_mask:0xf bank_mask:0xf
    v_mfma_f32_16x16x32_bf16 v[232:235], a[224:227], v[164:167], v[232:235]
    buffer_load_dwordx4 a[116:119], v1, s[16:19], s60 offen offset:1024 sc1
    v_mov_b32_dpp v31, v108 row_shl:1 row_mask:0xf bank_mask:0xf
    v_mfma_f32_16x16x32_bf16 v[240:243], a[224:227], v[168:171], v[240:243]
    v_swap_b32 v97, v100
    v_mfma_f32_16x16x32_bf16 v[248:251], a[224:227], v[172:175], v[248:251]
    buffer_load_dwordx4 a[88:91], v1, s[16:19], s60 offen offset:2048 sc1
    v_swap_b32 v98, v104
    v_mfma_f32_16x16x32_bf16 v[228:231], a[228:231], v[160:163], v[228:231]
    v_swap_b32 v99, v108
    v_mfma_f32_16x16x32_bf16 v[236:239], a[228:231], v[164:167], v[236:239]
    buffer_load_dwordx4 a[92:95], v1, s[16:19], s60 offen offset:3072 sc1
    v_swap_b32 v102, v105
    v_mfma_f32_16x16x32_bf16 v[244:247], a[228:231], v[168:171], v[244:247]
    v_swap_b32 v103, v109
    v_mfma_f32_16x16x32_bf16 v[252:255], a[228:231], v[172:175], v[252:255]
    s_add_u32 s60, s60, 4096
    v_swap_b32 v107, v110
    v_mfma_f32_16x16x32_bf16 v[156:159], v[28:31], v[20:23], v[156:159]
    s_waitcnt lgkmcnt(0)
    v_mfma_f32_16x16x32_bf16 v[192:195], a[200:203], v[176:179], v[192:195]
    buffer_load_dwordx4 a[120:123], v1, s[16:19], s60 offen sc1
    v_mfma_f32_16x16x32_bf16 v[128:131], v[96:99], v[16:19], v[128:131]
    s_cmp_le_i32 s9, 4
    s_cselect_b32 s61, s7, s3
    v_mfma_f32_16x16x32_bf16 v[132:135], v[100:103], v[16:19], v[132:135]
    v_mfma_f32_16x16x32_bf16 v[136:139], v[104:107], v[16:19], v[136:139]
    v_mfma_f32_16x16x32_bf16 v[140:143], v[108:111], v[16:19], v[140:143]
    v_mfma_f32_16x16x32_bf16 v[144:147], v[100:103], v[20:23], v[144:147]
    v_mfma_f32_16x16x32_bf16 v[148:151], v[104:107], v[20:23], v[148:151]
    v_mfma_f32_16x16x32_bf16 v[152:155], v[108:111], v[20:23], v[152:155]
    s_nop 2
    v_cvt_pk_bf16_f32 v80, v128, v132
    s_nop 0
    v_cvt_pk_bf16_f32 v81, v136, v140
    v_mfma_f32_16x16x32_bf16 v[200:203], a[200:203], v[180:183], v[200:203]
    s_add_u32 s61, s61, 4
    ds_read_b128 v[160:163], v13 offset:8192
    v_mfma_f32_16x16x32_bf16 v[208:211], a[200:203], v[184:187], v[208:211]
    s_mul_i32 s60, s61, 5120
    v_cvt_pk_bf16_f32 v82, v129, v133
    v_mfma_f32_16x16x32_bf16 v[216:219], a[200:203], v[188:191], v[216:219]
    s_add_u32 s60, s60, s8
    ds_read_b128 v[164:167], v13 offset:9216
    v_mfma_f32_16x16x32_bf16 v[196:199], a[204:207], v[176:179], v[196:199]
    buffer_load_dwordx4 a[124:127], v1, s[16:19], s60 offen sc1
    v_mfma_f32_16x16x32_bf16 v[204:207], a[204:207], v[180:183], v[204:207]
    v_cvt_pk_bf16_f32 v83, v137, v141
    ds_read_b128 v[168:171], v13 offset:10240
    v_mfma_f32_16x16x32_bf16 v[212:215], a[204:207], v[184:187], v[212:215]
    buffer_load_dwordx4 a[128:131], v1, s[16:19], s60 offen offset:1024 sc1
    v_mfma_f32_16x16x32_bf16 v[220:223], a[204:207], v[188:191], v[220:223]
    ds_read_b128 v[172:175], v13 offset:11264
    v_mfma_f32_16x16x32_bf16 v[224:227], a[232:235], v[176:179], v[224:227]
    buffer_load_dwordx4 a[132:135], v1, s[16:19], s60 offen offset:2048 sc1
    v_mfma_f32_16x16x32_bf16 v[232:235], a[232:235], v[180:183], v[232:235]
    v_mfma_f32_16x16x32_bf16 v[240:243], a[232:235], v[184:187], v[240:243]
    buffer_load_dwordx4 a[136:139], v1, s[16:19], s60 offen offset:3072 sc1
    v_mfma_f32_16x16x32_bf16 v[248:251], a[232:235], v[188:191], v[248:251]
    v_mfma_f32_16x16x32_bf16 v[228:231], a[236:239], v[176:179], v[228:231]
    ds_write_b128 v11, v[80:83] offset:32768
    v_mfma_f32_16x16x32_bf16 v[236:239], a[236:239], v[180:183], v[236:239]
    v_cvt_pk_bf16_f32 v84, v130, v134
    v_cvt_pk_bf16_f32 v85, v138, v142
    v_mfma_f32_16x16x32_bf16 v[244:247], a[236:239], v[184:187], v[244:247]
    v_cvt_pk_bf16_f32 v86, v131, v135
    s_add_u32 s60, s60, 4096
    v_mfma_f32_16x16x32_bf16 v[252:255], a[236:239], v[188:191], v[252:255]
    v_cvt_pk_bf16_f32 v87, v139, v143
    s_waitcnt lgkmcnt(1)
    v_mfma_f32_16x16x32_bf16 v[192:195], a[208:211], v[160:163], v[192:195]
    buffer_load_dwordx4 a[140:143], v1, s[16:19], s60 offen sc1
    v_mfma_f32_16x16x32_bf16 v[200:203], a[208:211], v[164:167], v[200:203]
    ds_read_b128 v[176:179], v13 offset:12288
    v_mfma_f32_16x16x32_bf16 v[208:211], a[208:211], v[168:171], v[208:211]
    ds_write_b128 v11, v[84:87] offset:36864
    v_cvt_pk_bf16_f32 v88, v159, v155
    v_mfma_f32_16x16x32_bf16 v[216:219], a[208:211], v[172:175], v[216:219]
    v_cvt_pk_bf16_f32 v89, v151, v147
    v_cvt_pk_bf16_f32 v90, v158, v154
    ds_read_b128 v[180:183], v13 offset:13312
    v_mfma_f32_16x16x32_bf16 v[196:199], a[212:215], v[160:163], v[196:199]
    s_cmp_le_i32 s9, 8
    s_cselect_b32 s61, s7, s3
    v_cvt_pk_bf16_f32 v91, v150, v146
    v_mfma_f32_16x16x32_bf16 v[204:207], a[212:215], v[164:167], v[204:207]
    s_add_u32 s61, s61, 8
    ds_read_b128 v[184:187], v13 offset:14336
    v_mfma_f32_16x16x32_bf16 v[212:215], a[212:215], v[168:171], v[212:215]
    s_mul_i32 s60, s61, 5120
    s_add_u32 s60, s60, s8
    v_mfma_f32_16x16x32_bf16 v[220:223], a[212:215], v[172:175], v[220:223]
    ds_write_b128 v12, v[88:91] offset:0
    v_cvt_pk_bf16_f32 v92, v157, v153
    ds_read_b128 v[188:191], v13 offset:15360
    v_mfma_f32_16x16x32_bf16 v[224:227], a[240:243], v[160:163], v[224:227]
    buffer_load_dwordx4 a[144:147], v1, s[16:19], s60 offen sc1
    v_cvt_pk_bf16_f32 v93, v149, v145
    v_cvt_pk_bf16_f32 v94, v156, v152
    v_mfma_f32_16x16x32_bf16 v[232:235], a[240:243], v[164:167], v[232:235]
    buffer_load_dwordx4 a[148:151], v1, s[16:19], s60 offen offset:1024 sc1
    v_cvt_pk_bf16_f32 v95, v148, v144
    v_mfma_f32_16x16x32_bf16 v[240:243], a[240:243], v[168:171], v[240:243]
    buffer_load_dwordx4 a[160:163], v1, s[16:19], s60 offen offset:2048 sc1
    v_mfma_f32_16x16x32_bf16 v[248:251], a[240:243], v[172:175], v[248:251]
    buffer_load_dwordx4 a[164:167], v1, s[16:19], s60 offen offset:3072 sc1
    v_mfma_f32_16x16x32_bf16 v[228:231], a[244:247], v[160:163], v[228:231]
    s_add_u32 s60, s60, 4096
    v_mfma_f32_16x16x32_bf16 v[236:239], a[244:247], v[164:167], v[236:239]
    buffer_load_dwordx4 a[168:171], v1, s[16:19], s60 offen sc1
    v_mfma_f32_16x16x32_bf16 v[244:247], a[244:247], v[168:171], v[244:247]
    v_mfma_f32_16x16x32_bf16 v[252:255], a[244:247], v[172:175], v[252:255]
    ds_write_b128 v12, v[92:95] offset:4096
    s_waitcnt lgkmcnt(0)
    s_barrier
    s_waitcnt lgkmcnt(1)
    v_mfma_f32_16x16x32_bf16 v[192:195], a[216:219], v[176:179], v[192:195]
    s_mul_i32 s50, s36, 55296
    s_add_u32 s50, s50, 10485760
    v_mfma_f32_16x16x32_bf16 v[200:203], a[216:219], v[180:183], v[200:203]
    v_add_u32 v28, s50, v1
    ds_read_b128 v[160:163], v5 offset:32768
    v_mfma_f32_16x16x32_bf16 v[208:211], a[216:219], v[184:187], v[208:211]
    s_cmp_le_i32 s9, 12
    s_cselect_b32 s61, s7, s3
    v_mfma_f32_16x16x32_bf16 v[216:219], a[216:219], v[188:191], v[216:219]
    s_mul_i32 s50, s37, 55296
    ds_read_b128 v[164:167], v5 offset:33792
    v_mfma_f32_16x16x32_bf16 v[196:199], a[220:223], v[176:179], v[196:199]
    s_add_u32 s61, s61, 12
    s_add_u32 s50, s50, 10485760
    v_mfma_f32_16x16x32_bf16 v[204:207], a[220:223], v[180:183], v[204:207]
    v_add_u32 v29, s50, v1
    ds_read_b128 v[168:171], v5 offset:36864
    v_mfma_f32_16x16x32_bf16 v[212:215], a[220:223], v[184:187], v[212:215]
    s_mul_i32 s60, s61, 5120
    s_mul_i32 s50, s38, 55296
    v_mfma_f32_16x16x32_bf16 v[220:223], a[220:223], v[188:191], v[220:223]
    s_add_u32 s50, s50, 10485760
    v_add_u32 v30, s50, v1
    ds_read_b128 v[172:175], v5 offset:37888
    v_mfma_f32_16x16x32_bf16 v[224:227], a[248:251], v[176:179], v[224:227]
    s_add_u32 s60, s60, s8
    s_mul_i32 s50, s39, 55296
    v_mfma_f32_16x16x32_bf16 v[232:235], a[248:251], v[180:183], v[232:235]
    buffer_load_dwordx4 a[172:175], v1, s[16:19], s60 offen sc1
    s_add_u32 s50, s50, 10485760
    v_add_u32 v31, s50, v1
    v_mfma_f32_16x16x32_bf16 v[240:243], a[248:251], v[184:187], v[240:243]
    s_mul_i32 s48, s31, 5
    s_lshr_b32 s48, s48, 1
    v_mfma_f32_16x16x32_bf16 v[248:251], a[248:251], v[188:191], v[248:251]
    buffer_load_dwordx4 a[176:179], v1, s[16:19], s60 offen offset:1024 sc1
    s_and_b32 s58, s31, 1
    v_mfma_f32_16x16x32_bf16 v[228:231], a[252:255], v[176:179], v[228:231]
    s_add_u32 s56, s48, s58
    s_add_u32 s49, s48, 2
    v_mfma_f32_16x16x32_bf16 v[236:239], a[252:255], v[180:183], v[236:239]
    buffer_load_dwordx4 a[180:183], v1, s[16:19], s60 offen offset:2048 sc1
    v_mfma_f32_16x16x32_bf16 v[244:247], a[252:255], v[184:187], v[244:247]
    s_cmp_eq_u32 s58, 0
    s_cselect_b32 s57, s49, s48
    v_mfma_f32_16x16x32_bf16 v[252:255], a[252:255], v[188:191], v[252:255]
    s_xor_b32 s50, s3, 0
    ds_read_b128 v[176:179], v13 offset:0
    ds_read_b128 v[180:183], v13 offset:1024
    ds_read_b128 v[184:187], v13 offset:4096
    ds_read_b128 v[188:191], v13 offset:5120
    s_waitcnt vmcnt(28) lgkmcnt(7)
    v_mfma_f32_16x16x32_bf16 v[192:195], a[0:3], v[160:163], v[192:195]
    buffer_load_dwordx4 a[152:155], v1, s[16:19], s60 offen offset:3072 sc1
    v_mfma_f32_16x16x32_bf16 v[196:199], a[4:7], v[160:163], v[196:199]
    s_bitcmp1_b32 s50, 0
    s_cselect_b32 s48, s37, s36
    s_cselect_b32 s51, s39, s38
    v_mfma_f32_16x16x32_bf16 v[224:227], a[40:43], v[160:163], v[224:227]
    s_bitcmp1_b32 s50, 1
    s_cselect_b32 s51, s51, s48
    v_mfma_f32_16x16x32_bf16 v[228:231], a[44:47], v[160:163], v[228:231]
    s_add_u32 s60, s60, 4096
    s_mov_b32 s59, s51
    s_mul_i32 s51, s51, 55296
    ds_read_b128 v[160:163], v5 offset:34816
    s_waitcnt lgkmcnt(7)
    v_mfma_f32_16x16x32_bf16 v[200:203], a[0:3], v[164:167], v[200:203]
    buffer_load_dwordx4 a[156:159], v1, s[16:19], s60 offen sc1
    s_add_u32 s51, s51, 10485760
    v_mfma_f32_16x16x32_bf16 v[204:207], a[4:7], v[164:167], v[204:207]
    v_add_u32 v6, s51, v1
    s_mul_i32 s51, s50, 15360
    v_mfma_f32_16x16x32_bf16 v[232:235], a[40:43], v[164:167], v[232:235]
    s_cmp_le_i32 s9, 16
    s_cselect_b32 s61, s7, s3
    v_add_u32 v10, s51, v1
    v_mfma_f32_16x16x32_bf16 v[236:239], a[44:47], v[164:167], v[236:239]
    s_xor_b32 s50, s3, 1
    ds_read_b128 v[164:167], v5 offset:35840
    s_waitcnt lgkmcnt(7)
    v_mfma_f32_16x16x32_bf16 v[192:195], a[8:11], v[168:171], v[192:195]
    s_bitcmp1_b32 s50, 0
    s_cselect_b32 s48, s37, s36
    s_cselect_b32 s51, s39, s38
    v_mfma_f32_16x16x32_bf16 v[196:199], a[12:15], v[168:171], v[196:199]
    s_add_u32 s61, s61, 16
    s_mul_i32 s60, s61, 5120
    v_mfma_f32_16x16x32_bf16 v[224:227], a[48:51], v[168:171], v[224:227]
    s_bitcmp1_b32 s50, 1
    s_cselect_b32 s51, s51, s48
    s_mul_i32 s51, s51, 55296
    v_mfma_f32_16x16x32_bf16 v[228:231], a[52:55], v[168:171], v[228:231]
    s_add_u32 s51, s51, 10485760
    ds_read_b128 v[168:171], v5 offset:38912
    s_waitcnt lgkmcnt(7)
    v_mfma_f32_16x16x32_bf16 v[200:203], a[8:11], v[172:175], v[200:203]
    s_add_u32 s60, s60, s8
    v_add_u32 v7, s51, v1
    s_mul_i32 s51, s50, 15360
    v_mfma_f32_16x16x32_bf16 v[204:207], a[12:15], v[172:175], v[204:207]
    buffer_load_dwordx4 a[184:187], v1, s[16:19], s60 offen sc1
    v_add_u32 v11, s51, v1
    v_mfma_f32_16x16x32_bf16 v[232:235], a[48:51], v[172:175], v[232:235]
    buffer_load_dwordx4 a[188:191], v1, s[16:19], s60 offen offset:1024 sc1
    s_xor_b32 s50, s3, 2
    v_mfma_f32_16x16x32_bf16 v[236:239], a[52:55], v[172:175], v[236:239]
    ds_read_b128 v[172:175], v5 offset:39936
    s_waitcnt lgkmcnt(7)
    v_mfma_f32_16x16x32_bf16 v[192:195], a[16:19], v[176:179], v[192:195]
    s_bitcmp1_b32 s50, 0
    s_cselect_b32 s48, s37, s36
    s_cselect_b32 s51, s39, s38
    v_mfma_f32_16x16x32_bf16 v[196:199], a[20:23], v[176:179], v[196:199]
    buffer_load_dwordx4 a[192:195], v1, s[16:19], s60 offen offset:2048 sc1
    s_bitcmp1_b32 s50, 1
    s_cselect_b32 s51, s51, s48
    v_mfma_f32_16x16x32_bf16 v[224:227], a[24:27], v[176:179], v[224:227]
    s_mul_i32 s51, s51, 55296
    s_add_u32 s51, s51, 10485760
    v_mfma_f32_16x16x32_bf16 v[228:231], a[28:31], v[176:179], v[228:231]
    v_add_u32 v8, s51, v1
    ds_read_b128 v[176:179], v13 offset:2048
    s_waitcnt lgkmcnt(7)
    v_mfma_f32_16x16x32_bf16 v[200:203], a[16:19], v[180:183], v[200:203]
    buffer_load_dwordx4 a[196:199], v1, s[16:19], s60 offen offset:3072 sc1
    s_mul_i32 s51, s50, 15360
    s_add_u32 s51, s51, 5120
    v_mfma_f32_16x16x32_bf16 v[204:207], a[20:23], v[180:183], v[204:207]
    s_add_u32 s60, s60, 4096
    v_add_u32 v12, s51, v1
    v_mfma_f32_16x16x32_bf16 v[232:235], a[24:27], v[180:183], v[232:235]
    buffer_load_dwordx4 a[200:203], v1, s[16:19], s60 offen sc1
    s_xor_b32 s50, s3, 3
    v_mfma_f32_16x16x32_bf16 v[236:239], a[28:31], v[180:183], v[236:239]
    ds_read_b128 v[180:183], v13 offset:3072
    s_waitcnt lgkmcnt(7)
    v_mfma_f32_16x16x32_bf16 v[192:195], a[32:35], v[184:187], v[192:195]
    s_bitcmp1_b32 s50, 0
    s_cselect_b32 s48, s37, s36
    s_cselect_b32 s51, s39, s38
    v_mfma_f32_16x16x32_bf16 v[196:199], a[36:39], v[184:187], v[196:199]
    s_cmp_le_i32 s9, 20
    s_cselect_b32 s61, s7, s3
    s_bitcmp1_b32 s50, 1
    s_cselect_b32 s51, s51, s48
    v_mfma_f32_16x16x32_bf16 v[224:227], a[56:59], v[184:187], v[224:227]
    s_mul_i32 s51, s51, 55296
    s_add_u32 s61, s61, 20
    s_add_u32 s51, s51, 10485760
    v_mfma_f32_16x16x32_bf16 v[228:231], a[60:63], v[184:187], v[228:231]
    v_add_u32 v9, s51, v1
    ds_read_b128 v[184:187], v13 offset:6144
    s_waitcnt lgkmcnt(7)
    v_mfma_f32_16x16x32_bf16 v[200:203], a[32:35], v[188:191], v[200:203]
    s_mul_i32 s60, s61, 5120
    s_mul_i32 s51, s50, 15360
    s_add_u32 s51, s51, 10240
    v_mfma_f32_16x16x32_bf16 v[204:207], a[36:39], v[188:191], v[204:207]
    s_add_u32 s60, s60, s8
    v_add_u32 v14, s51, v1
    v_mfma_f32_16x16x32_bf16 v[232:235], a[56:59], v[188:191], v[232:235]
    buffer_load_dwordx4 a[204:207], v1, s[16:19], s60 offen sc1
    v_and_b32 v4, 7, v0
    v_lshlrev_b32 v4, 12, v4
    v_mfma_f32_16x16x32_bf16 v[236:239], a[60:63], v[188:191], v[236:239]
    s_lshl_b32 s48, s30, 3
    s_add_u32 s48, s48, s28
    ds_read_b128 v[188:191], v13 offset:7168
    s_lshl_b32 s48, s48, 7
    s_add_u32 s48, s48, 29229056
    v_add_u32 v4, s48, v4
    buffer_load_dwordx4 a[208:211], v1, s[16:19], s60 offen offset:1024 sc1
    s_waitcnt lgkmcnt(7)
    v_mfma_f32_16x16x32_bf16 v[208:211], a[0:3], v[160:163], v[208:211]
    v_mfma_f32_16x16x32_bf16 v[212:215], a[4:7], v[160:163], v[212:215]
    v_mfma_f32_16x16x32_bf16 v[240:243], a[40:43], v[160:163], v[240:243]
    v_mfma_f32_16x16x32_bf16 v[244:247], a[44:47], v[160:163], v[244:247]
    s_waitcnt lgkmcnt(6)
    v_mfma_f32_16x16x32_bf16 v[216:219], a[0:3], v[164:167], v[216:219]
    v_cvt_pk_bf16_f32 v80, v192, v193
    v_cvt_pk_bf16_f32 v81, v194, v195
    v_mfma_f32_16x16x32_bf16 v[220:223], a[4:7], v[164:167], v[220:223]
    v_cvt_pk_bf16_f32 v82, v196, v197
    v_mfma_f32_16x16x32_bf16 v[248:251], a[40:43], v[164:167], v[248:251]
    v_cvt_pk_bf16_f32 v83, v198, v199
    v_pk_max_i16 v80, v80, 0
    v_mfma_f32_16x16x32_bf16 v[252:255], a[44:47], v[164:167], v[252:255]
    v_pk_max_i16 v81, v81, 0
    s_waitcnt lgkmcnt(5)
    v_mfma_f32_16x16x32_bf16 v[208:211], a[8:11], v[168:171], v[208:211]
    v_pk_max_i16 v82, v82, 0
    v_pk_max_i16 v83, v83, 0
    v_mfma_f32_16x16x32_bf16 v[212:215], a[12:15], v[168:171], v[212:215]
    buffer_store_dwordx4 v[80:83], v28, s[16:19], s41 offen sc1
    v_mfma_f32_16x16x32_bf16 v[240:243], a[48:51], v[168:171], v[240:243]
    v_mfma_f32_16x16x32_bf16 v[244:247], a[52:55], v[168:171], v[244:247]
    v_cvt_pk_bf16_f32 v84, v200, v201
    s_waitcnt lgkmcnt(4)
    v_mfma_f32_16x16x32_bf16 v[216:219], a[8:11], v[172:175], v[216:219]
    v_cvt_pk_bf16_f32 v85, v202, v203
    v_cvt_pk_bf16_f32 v86, v204, v205
    v_mfma_f32_16x16x32_bf16 v[220:223], a[12:15], v[172:175], v[220:223]
    v_cvt_pk_bf16_f32 v87, v206, v207
    v_pk_max_i16 v84, v84, 0
    v_mfma_f32_16x16x32_bf16 v[248:251], a[48:51], v[172:175], v[248:251]
    v_pk_max_i16 v85, v85, 0
    v_mfma_f32_16x16x32_bf16 v[252:255], a[52:55], v[172:175], v[252:255]
    v_pk_max_i16 v86, v86, 0
    s_waitcnt lgkmcnt(3)
    v_mfma_f32_16x16x32_bf16 v[208:211], a[16:19], v[176:179], v[208:211]
    v_pk_max_i16 v87, v87, 0
    v_mfma_f32_16x16x32_bf16 v[212:215], a[20:23], v[176:179], v[212:215]
    buffer_store_dwordx4 v[84:87], v29, s[16:19], s41 offen sc1
    v_mfma_f32_16x16x32_bf16 v[240:243], a[24:27], v[176:179], v[240:243]
    v_cvt_pk_bf16_f32 v96, v224, v225
    v_cvt_pk_bf16_f32 v97, v226, v227
    v_mfma_f32_16x16x32_bf16 v[244:247], a[28:31], v[176:179], v[244:247]
    v_cvt_pk_bf16_f32 v98, v228, v229
    s_waitcnt lgkmcnt(2)
    v_mfma_f32_16x16x32_bf16 v[216:219], a[16:19], v[180:183], v[216:219]
    v_cvt_pk_bf16_f32 v99, v230, v231
    v_pk_max_i16 v96, v96, 0
    v_mfma_f32_16x16x32_bf16 v[220:223], a[20:23], v[180:183], v[220:223]
    v_pk_max_i16 v97, v97, 0
    v_mfma_f32_16x16x32_bf16 v[248:251], a[24:27], v[180:183], v[248:251]
    v_pk_max_i16 v98, v98, 0
    v_pk_max_i16 v99, v99, 0
    v_mfma_f32_16x16x32_bf16 v[252:255], a[28:31], v[180:183], v[252:255]
    s_waitcnt lgkmcnt(1)
    v_mfma_f32_16x16x32_bf16 v[208:211], a[32:35], v[184:187], v[208:211]
    buffer_store_dwordx4 v[96:99], v28, s[16:19], s42 offen sc1
    v_mfma_f32_16x16x32_bf16 v[212:215], a[36:39], v[184:187], v[212:215]
    v_cvt_pk_bf16_f32 v100, v232, v233
    v_cvt_pk_bf16_f32 v101, v234, v235
    v_mfma_f32_16x16x32_bf16 v[240:243], a[56:59], v[184:187], v[240:243]
    v_cvt_pk_bf16_f32 v102, v236, v237
    v_mfma_f32_16x16x32_bf16 v[244:247], a[60:63], v[184:187], v[244:247]
    v_cvt_pk_bf16_f32 v103, v238, v239
    s_waitcnt lgkmcnt(0)
    v_mfma_f32_16x16x32_bf16 v[216:219], a[32:35], v[188:191], v[216:219]
    v_pk_max_i16 v100, v100, 0
    v_pk_max_i16 v101, v101, 0
    v_mfma_f32_16x16x32_bf16 v[220:223], a[36:39], v[188:191], v[220:223]
    v_pk_max_i16 v102, v102, 0
    v_pk_max_i16 v103, v103, 0
    v_mfma_f32_16x16x32_bf16 v[248:251], a[56:59], v[188:191], v[248:251]
    buffer_store_dwordx4 v[100:103], v29, s[16:19], s42 offen sc1
    v_mfma_f32_16x16x32_bf16 v[252:255], a[60:63], v[188:191], v[252:255]
    v_cvt_pk_bf16_f32 v88, v208, v209
    v_cvt_pk_bf16_f32 v89, v210, v211
    v_cvt_pk_bf16_f32 v90, v212, v213
    v_cvt_pk_bf16_f32 v91, v214, v215
    v_pk_max_i16 v88, v88, 0
    v_pk_max_i16 v89, v89, 0
    v_pk_max_i16 v90, v90, 0
    v_pk_max_i16 v91, v91, 0
    buffer_store_dwordx4 v[88:91], v30, s[16:19], s41 offen sc1
    v_cvt_pk_bf16_f32 v92, v216, v217
    v_cvt_pk_bf16_f32 v93, v218, v219
    v_cvt_pk_bf16_f32 v94, v220, v221
    v_cvt_pk_bf16_f32 v95, v222, v223
    v_pk_max_i16 v92, v92, 0
    v_pk_max_i16 v93, v93, 0
    v_pk_max_i16 v94, v94, 0
    v_pk_max_i16 v95, v95, 0
    buffer_store_dwordx4 v[92:95], v31, s[16:19], s41 offen sc1
    v_cvt_pk_bf16_f32 v104, v240, v241
    v_cvt_pk_bf16_f32 v105, v242, v243
    v_cvt_pk_bf16_f32 v106, v244, v245
    v_cvt_pk_bf16_f32 v107, v246, v247
    v_pk_max_i16 v104, v104, 0
    v_pk_max_i16 v105, v105, 0
    v_pk_max_i16 v106, v106, 0
    v_pk_max_i16 v107, v107, 0
    buffer_store_dwordx4 v[104:107], v30, s[16:19], s42 offen sc1
    v_cvt_pk_bf16_f32 v108, v248, v249
    v_cvt_pk_bf16_f32 v109, v250, v251
    v_cvt_pk_bf16_f32 v110, v252, v253
    v_cvt_pk_bf16_f32 v111, v254, v255
    v_pk_max_i16 v108, v108, 0
    v_pk_max_i16 v109, v109, 0
    v_pk_max_i16 v110, v110, 0
    v_pk_max_i16 v111, v111, 0
    buffer_store_dwordx4 v[108:111], v31, s[16:19], s42 offen sc1
    s_lshl_b32 s52, s3, 10
    v_add_u32 v5, s52, v1
    v_add_u32 v13, 40960, v5
    ds_read_b128 v[224:227], v5 offset:0
    ds_read_b128 v[228:231], v5 offset:4096
    ds_read_b128 v[232:235], v5 offset:8192
    buffer_load_dwordx4 a[212:215], v1, s[16:19], s60 offen offset:2048 sc1
    ds_read_b128 v[236:239], v5 offset:12288
    ds_read_b128 v[240:243], v5 offset:16384
    ds_read_b128 v[244:247], v5 offset:20480
    v_mov_b32 v188, 0x3f803f80
    v_mov_b32 v189, 0x3f803f80
    buffer_load_dwordx4 a[224:227], v1, s[16:19], s60 offen offset:3072 sc1
    v_mov_b32 v190, 0x3f803f80
    v_mov_b32 v191, 0x3f803f80
    s_waitcnt lgkmcnt(5)
    v_mfma_f32_16x16x32_bf16 v[180:183], v[224:227], v[224:227], 0
    s_lshl_b32 s50, s56, 12
    s_add_u32 s60, s60, 4096
    v_add_u32 v76, s50, v5
    v_mfma_f32_16x16x32_bf16 v[184:187], v[188:191], v[224:227], 0
    ds_read_b128 v[224:227], v5 offset:24576
    s_waitcnt lgkmcnt(5)
    v_mfma_f32_16x16x32_bf16 v[180:183], v[228:231], v[228:231], v[180:183]
    v_lshrrev_b32 v252, 1, v3
    buffer_load_dwordx4 a[228:231], v1, s[16:19], s60 offen sc1
    v_lshlrev_b32 v252, 8, v252
    v_mfma_f32_16x16x32_bf16 v[184:187], v[188:191], v[228:231], v[184:187]
    ds_read_b128 v[228:231], v5 offset:28672
    s_waitcnt lgkmcnt(5)
    v_mfma_f32_16x16x32_bf16 v[180:183], v[232:235], v[232:235], v[180:183]
    s_cmp_le_i32 s9, 24
    s_cselect_b32 s61, s7, s3
    v_lshl_add_u32 v252, v2, 4, v252
    v_and_b32 v15, 1, v3
    v_mfma_f32_16x16x32_bf16 v[184:187], v[188:191], v[232:235], v[184:187]
    ds_read_b128 v[232:235], v5 offset:32768
    s_waitcnt lgkmcnt(5)
    s_add_u32 s61, s61, 24
    v_mfma_f32_16x16x32_bf16 v[180:183], v[236:239], v[236:239], v[180:183]
    v_lshl_add_u32 v77, v15, 3, v252
    v_mfma_f32_16x16x32_bf16 v[184:187], v[188:191], v[236:239], v[184:187]
    ds_read_b128 v[236:239], v5 offset:36864
    s_waitcnt lgkmcnt(5)
    v_mfma_f32_16x16x32_bf16 v[180:183], v[240:243], v[240:243], v[180:183]
    s_mul_i32 s60, s61, 5120
    s_lshl_b32 s50, s57, 12
    v_mfma_f32_16x16x32_bf16 v[184:187], v[188:191], v[240:243], v[184:187]
    ds_read_b128 v[240:243], v13 offset:0
    s_waitcnt lgkmcnt(5)
    v_mfma_f32_16x16x32_bf16 v[180:183], v[244:247], v[244:247], v[180:183]
    s_add_u32 s60, s60, s8
    s_add_u32 s50, s50, s52
    v_mfma_f32_16x16x32_bf16 v[184:187], v[188:191], v[244:247], v[184:187]
    ds_read_b128 v[244:247], v13 offset:4096
    s_waitcnt lgkmcnt(5)
    v_mfma_f32_16x16x32_bf16 v[180:183], v[224:227], v[224:227], v[180:183]
    buffer_load_dwordx4 a[232:235], v1, s[16:19], s60 offen sc1
    s_lshl_b32 s51, s58, 9
    v_mfma_f32_16x16x32_bf16 v[184:187], v[188:191], v[224:227], v[184:187]
    ds_read_b128 v[224:227], v13 offset:8192
    s_waitcnt lgkmcnt(5)
    v_mfma_f32_16x16x32_bf16 v[180:183], v[228:231], v[228:231], v[180:183]
    buffer_load_dwordx4 a[236:239], v1, s[16:19], s60 offen offset:1024 sc1
    v_mfma_f32_16x16x32_bf16 v[184:187], v[188:191], v[228:231], v[184:187]
    ds_read_b128 v[228:231], v13 offset:12288
    s_waitcnt lgkmcnt(5)
    v_mfma_f32_16x16x32_bf16 v[180:183], v[232:235], v[232:235], v[180:183]
    s_add_u32 s50, s50, s51
    v_mfma_f32_16x16x32_bf16 v[184:187], v[188:191], v[232:235], v[184:187]
    buffer_load_dwordx4 a[240:243], v1, s[16:19], s60 offen offset:2048 sc1
    ds_read_b128 v[232:235], v13 offset:16384
    s_waitcnt lgkmcnt(5)
    v_mfma_f32_16x16x32_bf16 v[180:183], v[236:239], v[236:239], v[180:183]
    v_add_u32 v77, s50, v77
    v_mfma_f32_16x16x32_bf16 v[184:187], v[188:191], v[236:239], v[184:187]
    buffer_load_dwordx4 a[244:247], v1, s[16:19], s60 offen offset:3072 sc1
    ds_read_b128 v[236:239], v13 offset:20480
    s_waitcnt lgkmcnt(5)
    v_mfma_f32_16x16x32_bf16 v[180:183], v[240:243], v[240:243], v[180:183]
    v_lshl_add_u32 v252, v15, 30, v252
    v_mfma_f32_16x16x32_bf16 v[184:187], v[188:191], v[240:243], v[184:187]
    s_add_u32 s60, s60, 4096
    ds_read_b128 v[240:243], v13 offset:24576
    s_waitcnt lgkmcnt(5)
    v_mfma_f32_16x16x32_bf16 v[180:183], v[244:247], v[244:247], v[180:183]
    v_and_b32 v78, 3, v2
    v_mfma_f32_16x16x32_bf16 v[184:187], v[188:191], v[244:247], v[184:187]
    ds_read_b128 v[244:247], v13 offset:28672
    buffer_load_dwordx4 a[216:219], v1, s[16:19], s60 offen sc1
    s_waitcnt lgkmcnt(5)
    v_mfma_f32_16x16x32_bf16 v[180:183], v[224:227], v[224:227], v[180:183]
    v_lshrrev_b32 v79, 2, v2
    v_mfma_f32_16x16x32_bf16 v[184:187], v[188:191], v[224:227], v[184:187]
    ds_read_b128 v[224:227], v13 offset:32768
    s_cmp_le_i32 s9, 28
    s_cselect_b32 s61, s7, s3
    s_waitcnt lgkmcnt(5)
    v_mfma_f32_16x16x32_bf16 v[180:183], v[228:231], v[228:231], v[180:183]
    v_lshl_add_u32 v79, v79, 4, v2
    v_mfma_f32_16x16x32_bf16 v[184:187], v[188:191], v[228:231], v[184:187]
    ds_read_b128 v[228:231], v13 offset:36864
    s_add_u32 s61, s61, 28
    s_waitcnt lgkmcnt(5)
    v_mfma_f32_16x16x32_bf16 v[180:183], v[232:235], v[232:235], v[180:183]
    v_lshlrev_b32 v79, 2, v79
    v_mfma_f32_16x16x32_bf16 v[184:187], v[188:191], v[232:235], v[184:187]
    s_mov_b32 s50, 0x3acccccd
    s_waitcnt lgkmcnt(4)
    s_mul_i32 s60, s61, 5120
    v_mfma_f32_16x16x32_bf16 v[180:183], v[236:239], v[236:239], v[180:183]
    v_mfma_f32_16x16x32_bf16 v[184:187], v[188:191], v[236:239], v[184:187]
    v_mov_b32 v254, 0x3727c5ac
    s_waitcnt lgkmcnt(3)
    v_mfma_f32_16x16x32_bf16 v[180:183], v[240:243], v[240:243], v[180:183]
    s_add_u32 s60, s60, s8
    v_mfma_f32_16x16x32_bf16 v[184:187], v[188:191], v[240:243], v[184:187]
    s_waitcnt lgkmcnt(2)
    v_mfma_f32_16x16x32_bf16 v[180:183], v[244:247], v[244:247], v[180:183]
    v_mfma_f32_16x16x32_bf16 v[184:187], v[188:191], v[244:247], v[184:187]
    s_waitcnt lgkmcnt(1)
    buffer_load_dwordx4 a[220:223], v1, s[16:19], s60 offen sc1
    v_mfma_f32_16x16x32_bf16 v[180:183], v[224:227], v[224:227], v[180:183]
    v_mfma_f32_16x16x32_bf16 v[184:187], v[188:191], v[224:227], v[184:187]
    s_waitcnt lgkmcnt(0)
    v_mfma_f32_16x16x32_bf16 v[180:183], v[228:231], v[228:231], v[180:183]
    v_mfma_f32_16x16x32_bf16 v[184:187], v[188:191], v[228:231], v[184:187]
    buffer_load_dwordx4 a[248:251], v1, s[16:19], s60 offen offset:1024 sc1
    s_bitcmp1_b32 s3, 0
    s_cbranch_scc0 nsw_m_42
    v_swap_b32 v80, v84
    v_swap_b32 v81, v85
    v_swap_b32 v82, v86
    v_swap_b32 v83, v87
    v_swap_b32 v88, v92
    v_swap_b32 v89, v93
    v_swap_b32 v90, v94
    v_swap_b32 v91, v95
    v_swap_b32 v96, v100
    v_swap_b32 v97, v101
    v_swap_b32 v98, v102
    v_swap_b32 v99, v103
    v_swap_b32 v104, v108
    v_swap_b32 v105, v109
    v_swap_b32 v106, v110
    v_swap_b32 v107, v111
nsw_m_42:
    s_bitcmp1_b32 s3, 1
    s_cbranch_scc0 nsw_m_43
    v_swap_b32 v80, v88
    v_swap_b32 v81, v89
    v_swap_b32 v82, v90
    v_swap_b32 v83, v91
    v_swap_b32 v84, v92
    v_swap_b32 v85, v93
    v_swap_b32 v86, v94
    v_swap_b32 v87, v95
    v_swap_b32 v96, v104
    v_swap_b32 v97, v105
    v_swap_b32 v98, v106
    v_swap_b32 v99, v107
    v_swap_b32 v100, v108
    v_swap_b32 v101, v109
    v_swap_b32 v102, v110
    v_swap_b32 v103, v111
nsw_m_43:
    s_add_u32 s55, s47, 2
    v_mov_b32 v248, s55
    v_mov_b32 v249, s46
    v_lshlrev_b32 v250, 25, v0
    s_waitcnt vmcnt(10)
    s_barrier
    buffer_store_dwordx2 v[248:249], v250, s[16:19], s43 offen sc0 sc1
    s_waitcnt vmcnt(51)
    v_mfma_f32_16x16x32_bf16 v[36:39], a[64:67], v[84:87], 0
    ds_read_b128 v[232:235], v76
    ds_read_b128 v[236:239], v76 offset:4096
    v_mfma_f32_16x16x32_bf16 v[40:43], a[68:71], v[84:87], 0
    buffer_load_dwordx4 a[252:255], v1, s[16:19], s60 offen offset:2048 sc1
    v_mfma_f32_16x16x32_bf16 v[44:47], a[72:75], v[84:87], 0
    buffer_load_dwordx4 a[0:3], v1, s[16:19], s60 offen offset:3072 sc1
    v_mfma_f32_16x16x32_bf16 v[48:51], a[76:79], v[84:87], 0
    s_add_u32 s60, s60, 4096
    ds_read_b64 v[240:241], v77
    v_mfma_f32_16x16x32_bf16 v[52:55], a[80:83], v[84:87], 0
    buffer_load_dwordx4 a[4:7], v1, s[16:19], s60 offen sc1
    v_mfma_f32_16x16x32_bf16 v[56:59], a[64:67], v[88:91], 0
    s_cmp_le_i32 s9, 32
    s_cselect_b32 s61, s7, s3
    v_mfma_f32_16x16x32_bf16 v[60:63], a[68:71], v[88:91], 0
    s_add_u32 s61, s61, 32
    v_mfma_f32_16x16x32_bf16 v[64:67], a[72:75], v[88:91], 0
    v_cmp_eq_u32 vcc, 1, v78
    s_nop 1
    v_cndmask_b32 v180, v180, v181, vcc
    v_mfma_f32_16x16x32_bf16 v[68:71], a[76:79], v[88:91], 0
    s_mul_i32 s60, s61, 5120
    s_add_u32 s60, s60, s8
    v_mfma_f32_16x16x32_bf16 v[72:75], a[80:83], v[88:91], 0
    buffer_load_dwordx4 a[8:11], v1, s[16:19], s60 offen sc1
    v_mfma_f32_16x16x32_bf16 v[160:163], a[64:67], v[92:95], 0
    buffer_load_dwordx4 a[12:15], v1, s[16:19], s60 offen offset:1024 sc1
    v_mfma_f32_16x16x32_bf16 v[164:167], a[68:71], v[92:95], 0
    buffer_load_dwordx4 a[16:19], v1, s[16:19], s60 offen offset:2048 sc1
    v_mfma_f32_16x16x32_bf16 v[168:171], a[72:75], v[92:95], 0
    v_cmp_eq_u32 vcc, 2, v78
    s_nop 1
    v_cndmask_b32 v180, v180, v182, vcc
    v_mfma_f32_16x16x32_bf16 v[172:175], a[76:79], v[92:95], 0
    buffer_load_dwordx4 a[20:23], v1, s[16:19], s60 offen offset:3072 sc1
    v_mfma_f32_16x16x32_bf16 v[176:179], a[80:83], v[92:95], 0
    s_add_u32 s60, s60, 4096
    v_mfma_f32_16x16x32_bf16 v[16:19], a[64:67], v[80:83], 0
    buffer_load_dwordx4 a[32:35], v1, s[16:19], s60 offen sc1
    v_mfma_f32_16x16x32_bf16 v[20:23], a[68:71], v[80:83], 0
    v_cmp_eq_u32 vcc, 3, v78
    s_nop 1
    v_cndmask_b32 v180, v180, v183, vcc
    v_mfma_f32_16x16x32_bf16 v[24:27], a[72:75], v[80:83], 0
    s_cmp_le_i32 s9, 36
    s_cselect_b32 s61, s7, s3
    v_mfma_f32_16x16x32_bf16 v[28:31], a[76:79], v[80:83], 0
    s_add_u32 s61, s61, 36
    s_mul_i32 s60, s61, 5120
    v_mfma_f32_16x16x32_bf16 v[32:35], a[80:83], v[80:83], 0
    s_add_u32 s60, s60, s8
    s_waitcnt vmcnt(54)
    v_mfma_f32_16x16x32_bf16 v[36:39], a[84:87], v[100:103], v[36:39]
    buffer_load_dwordx4 a[36:39], v1, s[16:19], s60 offen sc1
    v_mfma_f32_16x16x32_bf16 v[40:43], a[96:99], v[100:103], v[40:43]
    ds_bpermute_b32 v180, v79, v180
    v_mul_f32 v253, s50, v184
    v_mfma_f32_16x16x32_bf16 v[44:47], a[100:103], v[100:103], v[44:47]
    buffer_load_dwordx4 a[40:43], v1, s[16:19], s60 offen offset:1024 sc1
    v_mfma_f32_16x16x32_bf16 v[48:51], a[104:107], v[100:103], v[48:51]
    buffer_load_dwordx4 a[44:47], v1, s[16:19], s60 offen offset:2048 sc1
    v_mfma_f32_16x16x32_bf16 v[52:55], a[108:111], v[100:103], v[52:55]
    buffer_load_dwordx4 a[48:51], v1, s[16:19], s60 offen offset:3072 sc1
    v_mfma_f32_16x16x32_bf16 v[56:59], a[84:87], v[104:107], v[56:59]
    v_fma_f32 v253, -v253, v253, v254
    s_waitcnt lgkmcnt(0)
    v_mfma_f32_16x16x32_bf16 v[60:63], a[96:99], v[104:107], v[60:63]
    s_add_u32 s60, s60, 4096
    v_fma_f32 v180, v180, s50, v253
    v_mfma_f32_16x16x32_bf16 v[64:67], a[100:103], v[104:107], v[64:67]
    buffer_load_dwordx4 a[52:55], v1, s[16:19], s60 offen sc1
    v_mfma_f32_16x16x32_bf16 v[68:71], a[104:107], v[104:107], v[68:71]
    s_cmp_le_i32 s9, 40
    s_cselect_b32 s61, s7, s3
    v_mfma_f32_16x16x32_bf16 v[72:75], a[108:111], v[104:107], v[72:75]
    s_add_u32 s61, s61, 40
    v_max_f32 v180, v254, v180
    v_mfma_f32_16x16x32_bf16 v[160:163], a[84:87], v[108:111], v[160:163]
    s_mul_i32 s60, s61, 5120
    v_mfma_f32_16x16x32_bf16 v[164:167], a[96:99], v[108:111], v[164:167]
    s_add_u32 s60, s60, s8
    v_mfma_f32_16x16x32_bf16 v[168:171], a[100:103], v[108:111], v[168:171]
    buffer_load_dwordx4 a[24:27], v1, s[16:19], s60 offen sc1
    v_mfma_f32_16x16x32_bf16 v[172:175], a[104:107], v[108:111], v[172:175]
    buffer_load_dwordx4 a[28:31], v1, s[16:19], s60 offen offset:1024 sc1
    v_mfma_f32_16x16x32_bf16 v[176:179], a[108:111], v[108:111], v[176:179]
    buffer_load_dwordx4 a[56:59], v1, s[16:19], s60 offen offset:2048 sc1
    v_mfma_f32_16x16x32_bf16 v[16:19], a[84:87], v[96:99], v[16:19]
    v_rsq_f32 v242, v180
    v_mfma_f32_16x16x32_bf16 v[20:23], a[96:99], v[96:99], v[20:23]
    buffer_load_dwordx4 a[60:63], v1, s[16:19], s60 offen offset:3072 sc1
    v_mfma_f32_16x16x32_bf16 v[24:27], a[100:103], v[96:99], v[24:27]
    s_add_u32 s60, s60, 4096
    v_mfma_f32_16x16x32_bf16 v[28:31], a[104:107], v[96:99], v[28:31]
    buffer_load_dwordx4 v[192:195], v1, s[16:19], s60 offen sc1
    v_mfma_f32_16x16x32_bf16 v[32:35], a[108:111], v[96:99], v[32:35]
    buffer_load_dwordx2 v[250:251], v4, s[16:19], 0 offen sc1
    s_mov_b32 s55, 0
    s_add_u32 s54, s47, 2
    s_waitcnt vmcnt(0)
ploop_m_45:
    v_subrev_u32 v250, s54, v250
    v_xor_b32 v251, s46, v251
    v_lshl_or_b32 v250, v251, 3, v250
    v_and_b32 v251, -8, v251
    v_or_b32 v250, v250, v251
    v_cmp_le_u32 vcc, 6, v250
    s_add_u32 s55, s55, 1
    s_cmp_ge_u32 s55, 200000
    s_cbranch_scc1 pok_m_44
    s_nop 2
    s_cbranch_vccz pok_m_44
    s_sleep 1
    buffer_load_dwordx2 v[250:251], v4, s[16:19], 0 offen sc1
    s_waitcnt vmcnt(0)
    s_branch ploop_m_45
pok_m_44:
    s_cmp_le_i32 s9, 0
    s_cselect_b32 s49, s7, s3
    s_lshl_b32 s48, s49, 10
    buffer_load_dwordx4 v[116:119], v7, s[16:19], s48 offen sc1
    buffer_load_dwordx4 v[120:123], v8, s[16:19], s48 offen sc1
    buffer_load_dwordx4 v[124:127], v9, s[16:19], s48 offen sc1
    buffer_load_dwordx4 v[112:115], v6, s[16:19], s48 offen sc1
    s_cmp_le_i32 s9, 4
    s_cselect_b32 s49, s7, s3
    s_add_u32 s49, s49, 4
    s_lshl_b32 s48, s49, 10
    buffer_load_dwordx4 v[132:135], v7, s[16:19], s48 offen sc1
    buffer_load_dwordx4 v[136:139], v8, s[16:19], s48 offen sc1
    buffer_load_dwordx4 v[140:143], v9, s[16:19], s48 offen sc1
    buffer_load_dwordx4 v[128:131], v6, s[16:19], s48 offen sc1
    s_cmp_le_i32 s9, 8
    s_cselect_b32 s49, s7, s3
    s_add_u32 s49, s49, 8
    s_lshl_b32 s48, s49, 10
    buffer_load_dwordx4 v[148:151], v7, s[16:19], s48 offen sc1
    buffer_load_dwordx4 v[152:155], v8, s[16:19], s48 offen sc1
    buffer_load_dwordx4 v[156:159], v9, s[16:19], s48 offen sc1
    buffer_load_dwordx4 v[144:147], v6, s[16:19], s48 offen sc1
    s_cmp_le_i32 s9, 12
    s_cselect_b32 s49, s7, s3
    s_add_u32 s49, s49, 12
    s_lshl_b32 s48, s49, 10
    buffer_load_dwordx4 v[84:87], v7, s[16:19], s48 offen sc1
    buffer_load_dwordx4 v[88:91], v8, s[16:19], s48 offen sc1
    buffer_load_dwordx4 v[92:95], v9, s[16:19], s48 offen sc1
    buffer_load_dwordx4 v[80:83], v6, s[16:19], s48 offen sc1
    s_waitcnt vmcnt(15)
    v_mfma_f32_16x16x32_bf16 v[36:39], a[112:115], v[116:119], v[36:39]
    s_cmp_le_i32 s9, 16
    s_cselect_b32 s49, s7, s3
    v_mfma_f32_16x16x32_bf16 v[40:43], a[116:119], v[116:119], v[40:43]
    s_cmp_le_i32 s9, 44
    s_cselect_b32 s61, s7, s3
    v_mfma_f32_16x16x32_bf16 v[44:47], a[88:91], v[116:119], v[44:47]
    s_add_u32 s61, s61, 44
    v_mfma_f32_16x16x32_bf16 v[48:51], a[92:95], v[116:119], v[48:51]
    s_add_u32 s49, s49, 16
    s_mul_i32 s60, s61, 5120
    v_mfma_f32_16x16x32_bf16 v[52:55], a[120:123], v[116:119], v[52:55]
    s_add_u32 s60, s60, s8
    s_waitcnt vmcnt(14)
    v_mfma_f32_16x16x32_bf16 v[56:59], a[112:115], v[120:123], v[56:59]
    s_lshl_b32 s48, s49, 10
    v_mfma_f32_16x16x32_bf16 v[60:63], a[116:119], v[120:123], v[60:63]
    s_cmp_ge_u32 s61, 54
    s_cselect_b32 s60, 1073741824, s60
    v_mfma_f32_16x16x32_bf16 v[64:67], a[88:91], v[120:123], v[64:67]
    buffer_load_dwordx4 v[100:103], v7, s[16:19], s48 offen sc1
    v_mfma_f32_16x16x32_bf16 v[68:71], a[92:95], v[120:123], v[68:71]
    buffer_load_dwordx4 v[196:199], v1, s[16:19], s60 offen sc1
    v_mfma_f32_16x16x32_bf16 v[72:75], a[120:123], v[120:123], v[72:75]
    s_waitcnt vmcnt(15)
    v_mfma_f32_16x16x32_bf16 v[160:163], a[112:115], v[124:127], v[160:163]
    buffer_load_dwordx4 v[104:107], v8, s[16:19], s48 offen sc1
    v_mfma_f32_16x16x32_bf16 v[164:167], a[116:119], v[124:127], v[164:167]
    buffer_load_dwordx4 v[200:203], v1, s[16:19], s60 offen offset:1024 sc1
    v_mfma_f32_16x16x32_bf16 v[168:171], a[88:91], v[124:127], v[168:171]
    buffer_load_dwordx4 v[204:207], v1, s[16:19], s60 offen offset:2048 sc1
    v_mfma_f32_16x16x32_bf16 v[172:175], a[92:95], v[124:127], v[172:175]
    buffer_load_dwordx4 v[108:111], v9, s[16:19], s48 offen sc1
    v_mfma_f32_16x16x32_bf16 v[176:179], a[120:123], v[124:127], v[176:179]
    s_waitcnt vmcnt(18)
    v_mfma_f32_16x16x32_bf16 v[16:19], a[112:115], v[112:115], v[16:19]
    buffer_load_dwordx4 v[208:211], v1, s[16:19], s60 offen offset:3072 sc1
    v_mfma_f32_16x16x32_bf16 v[20:23], a[116:119], v[112:115], v[20:23]
    buffer_load_dwordx4 v[96:99], v6, s[16:19], s48 offen sc1
    v_mfma_f32_16x16x32_bf16 v[24:27], a[88:91], v[112:115], v[24:27]
    s_add_u32 s60, s60, 4096
    v_mfma_f32_16x16x32_bf16 v[28:31], a[92:95], v[112:115], v[28:31]
    buffer_load_dwordx4 v[212:215], v1, s[16:19], s60 offen sc1
    v_mfma_f32_16x16x32_bf16 v[32:35], a[120:123], v[112:115], v[32:35]
    s_waitcnt vmcnt(20)
    v_mfma_f32_16x16x32_bf16 v[36:39], a[124:127], v[132:135], v[36:39]
    s_cmp_le_i32 s9, 20
    s_cselect_b32 s49, s7, s3
    v_mfma_f32_16x16x32_bf16 v[40:43], a[128:131], v[132:135], v[40:43]
    s_barrier
    v_mfma_f32_16x16x32_bf16 v[44:47], a[132:135], v[132:135], v[44:47]
    v_mfma_f32_16x16x32_bf16 v[48:51], a[136:139], v[132:135], v[48:51]
    s_add_u32 s49, s49, 20
    v_mfma_f32_16x16x32_bf16 v[52:55], a[140:143], v[132:135], v[52:55]
    s_waitcnt vmcnt(19)
    v_mfma_f32_16x16x32_bf16 v[56:59], a[124:127], v[136:139], v[56:59]
    s_lshl_b32 s48, s49, 10
    v_mfma_f32_16x16x32_bf16 v[60:63], a[128:131], v[136:139], v[60:63]
    buffer_load_dwordx4 v[116:119], v7, s[16:19], s48 offen sc1
    v_mfma_f32_16x16x32_bf16 v[64:67], a[132:135], v[136:139], v[64:67]
    v_mfma_f32_16x16x32_bf16 v[68:71], a[136:139], v[136:139], v[68:71]
    v_mfma_f32_16x16x32_bf16 v[72:75], a[140:143], v[136:139], v[72:75]
    s_waitcnt vmcnt(19)
    v_mfma_f32_16x16x32_bf16 v[160:163], a[124:127], v[140:143], v[160:163]
    buffer_load_dwordx4 v[120:123], v8, s[16:19], s48 offen sc1
    v_mfma_f32_16x16x32_bf16 v[164:167], a[128:131], v[140:143], v[164:167]
    v_mfma_f32_16x16x32_bf16 v[168:171], a[132:135], v[140:143], v[168:171]
    v_mfma_f32_16x16x32_bf16 v[172:175], a[136:139], v[140:143], v[172:175]
    buffer_load_dwordx4 v[124:127], v9, s[16:19], s48 offen sc1
    v_mfma_f32_16x16x32_bf16 v[176:179], a[140:143], v[140:143], v[176:179]
    s_waitcnt vmcnt(20)
    v_mfma_f32_16x16x32_bf16 v[16:19], a[124:127], v[128:131], v[16:19]
    v_mfma_f32_16x16x32_bf16 v[20:23], a[128:131], v[128:131], v[20:23]
    buffer_load_dwordx4 v[112:115], v6, s[16:19], s48 offen sc1
    v_mfma_f32_16x16x32_bf16 v[24:27], a[132:135], v[128:131], v[24:27]
    v_mfma_f32_16x16x32_bf16 v[28:31], a[136:139], v[128:131], v[28:31]
    v_mfma_f32_16x16x32_bf16 v[32:35], a[140:143], v[128:131], v[32:35]
    s_waitcnt vmcnt(20)
    v_mfma_f32_16x16x32_bf16 v[36:39], a[144:147], v[148:151], v[36:39]
    s_cmp_le_i32 s9, 24
    s_cselect_b32 s49, s7, s3
    v_mfma_f32_16x16x32_bf16 v[40:43], a[148:151], v[148:151], v[40:43]
    v_mfma_f32_16x16x32_bf16 v[44:47], a[160:163], v[148:151], v[44:47]
    v_mfma_f32_16x16x32_bf16 v[48:51], a[164:167], v[148:151], v[48:51]
    s_add_u32 s49, s49, 24
    v_mfma_f32_16x16x32_bf16 v[52:55], a[168:171], v[148:151], v[52:55]
    s_waitcnt vmcnt(19)
    v_mfma_f32_16x16x32_bf16 v[56:59], a[144:147], v[152:155], v[56:59]
    s_lshl_b32 s48, s49, 10
    v_mfma_f32_16x16x32_bf16 v[60:63], a[148:151], v[152:155], v[60:63]
    buffer_load_dwordx4 v[132:135], v7, s[16:19], s48 offen sc1
    v_mfma_f32_16x16x32_bf16 v[64:67], a[160:163], v[152:155], v[64:67]
    v_mfma_f32_16x16x32_bf16 v[68:71], a[164:167], v[152:155], v[68:71]
    v_mfma_f32_16x16x32_bf16 v[72:75], a[168:171], v[152:155], v[72:75]
    s_waitcnt vmcnt(19)
    v_mfma_f32_16x16x32_bf16 v[160:163], a[144:147], v[156:159], v[160:163]
    buffer_load_dwordx4 v[136:139], v8, s[16:19], s48 offen sc1
    v_mfma_f32_16x16x32_bf16 v[164:167], a[148:151], v[156:159], v[164:167]
    v_mfma_f32_16x16x32_bf16 v[168:171], a[160:163], v[156:159], v[168:171]
    v_mfma_f32_16x16x32_bf16 v[172:175], a[164:167], v[156:159], v[172:175]
    buffer_load_dwordx4 v[140:143], v9, s[16:19], s48 offen sc1
    v_mfma_f32_16x16x32_bf16 v[176:179], a[168:171], v[156:159], v[176:179]
    s_waitcnt vmcnt(20)
    v_mfma_f32_16x16x32_bf16 v[16:19], a[144:147], v[144:147], v[16:19]
    v_mfma_f32_16x16x32_bf16 v[20:23], a[148:151], v[144:147], v[20:23]
    buffer_load_dwordx4 v[128:131], v6, s[16:19], s48 offen sc1
    v_mfma_f32_16x16x32_bf16 v[24:27], a[160:163], v[144:147], v[24:27]
    v_mfma_f32_16x16x32_bf16 v[28:31], a[164:167], v[144:147], v[28:31]
    v_mfma_f32_16x16x32_bf16 v[32:35], a[168:171], v[144:147], v[32:35]
    s_waitcnt vmcnt(20)
    v_mfma_f32_16x16x32_bf16 v[36:39], a[172:175], v[84:87], v[36:39]
    s_cmp_le_i32 s9, 28
    s_cselect_b32 s49, s7, s3
    v_mfma_f32_16x16x32_bf16 v[40:43], a[176:179], v[84:87], v[40:43]
    v_mfma_f32_16x16x32_bf16 v[44:47], a[180:183], v[84:87], v[44:47]
    v_mfma_f32_16x16x32_bf16 v[48:51], a[152:155], v[84:87], v[48:51]
    s_add_u32 s49, s49, 28
    v_mfma_f32_16x16x32_bf16 v[52:55], a[156:159], v[84:87], v[52:55]
    s_waitcnt vmcnt(19)
    v_mfma_f32_16x16x32_bf16 v[56:59], a[172:175], v[88:91], v[56:59]
    s_lshl_b32 s48, s49, 10
    v_mfma_f32_16x16x32_bf16 v[60:63], a[176:179], v[88:91], v[60:63]
    buffer_load_dwordx4 v[148:151], v7, s[16:19], s48 offen sc1
    v_mfma_f32_16x16x32_bf16 v[64:67], a[180:183], v[88:91], v[64:67]
    v_mfma_f32_16x16x32_bf16 v[68:71], a[152:155], v[88:91], v[68:71]
    v_mfma_f32_16x16x32_bf16 v[72:75], a[156:159], v[88:91], v[72:75]
    s_waitcnt vmcnt(19)
    v_mfma_f32_16x16x32_bf16 v[160:163], a[172:175], v[92:95], v[160:163]
    buffer_load_dwordx4 v[152:155], v8, s[16:19], s48 offen sc1
    v_mfma_f32_16x16x32_bf16 v[164:167], a[176:179], v[92:95], v[164:167]
    v_mfma_f32_16x16x32_bf16 v[168:171], a[180:183], v[92:95], v[168:171]
    v_mfma_f32_16x16x32_bf16 v[172:175], a[152:155], v[92:95], v[172:175]
    buffer_load_dwordx4 v[156:159], v9, s[16:19], s48 offen sc1
    v_mfma_f32_16x16x32_bf16 v[176:179], a[156:159], v[92:95], v[176:179]
    s_waitcnt vmcnt(20)
    v_mfma_f32_16x16x32_bf16 v[16:19], a[172:175], v[80:83], v[16:19]
    v_mfma_f32_16x16x32_bf16 v[20:23], a[176:179], v[80:83], v[20:23]
    buffer_load_dwordx4 v[144:147], v6, s[16:19], s48 offen sc1
    v_mfma_f32_16x16x32_bf16 v[24:27], a[180:183], v[80:83], v[24:27]
    v_mfma_f32_16x16x32_bf16 v[28:31], a[152:155], v[80:83], v[28:31]
    v_mfma_f32_16x16x32_bf16 v[32:35], a[156:159], v[80:83], v[32:35]
    s_waitcnt vmcnt(20)
    v_mfma_f32_16x16x32_bf16 v[36:39], a[184:187], v[100:103], v[36:39]
    s_cmp_le_i32 s9, 32
    s_cselect_b32 s49, s7, s3
    v_mfma_f32_16x16x32_bf16 v[40:43], a[188:191], v[100:103], v[40:43]
    v_mfma_f32_16x16x32_bf16 v[44:47], a[192:195], v[100:103], v[44:47]
    v_mfma_f32_16x16x32_bf16 v[48:51], a[196:199], v[100:103], v[48:51]
    s_add_u32 s49, s49, 32
    v_mfma_f32_16x16x32_bf16 v[52:55], a[200:203], v[100:103], v[52:55]
    s_waitcnt vmcnt(18)
    v_mfma_f32_16x16x32_bf16 v[56:59], a[184:187], v[104:107], v[56:59]
    s_lshl_b32 s48, s49, 10
    v_mfma_f32_16x16x32_bf16 v[60:63], a[188:191], v[104:107], v[60:63]
    buffer_load_dwordx4 v[84:87], v7, s[16:19], s48 offen sc1
    v_mfma_f32_16x16x32_bf16 v[64:67], a[192:195], v[104:107], v[64:67]
    v_mfma_f32_16x16x32_bf16 v[68:71], a[196:199], v[104:107], v[68:71]
    v_mfma_f32_16x16x32_bf16 v[72:75], a[200:203], v[104:107], v[72:75]
    s_waitcnt vmcnt(16)
    v_mfma_f32_16x16x32_bf16 v[160:163], a[184:187], v[108:111], v[160:163]
    buffer_load_dwordx4 v[88:91], v8, s[16:19], s48 offen sc1
    v_mfma_f32_16x16x32_bf16 v[164:167], a[188:191], v[108:111], v[164:167]
    v_mfma_f32_16x16x32_bf16 v[168:171], a[192:195], v[108:111], v[168:171]
    v_mfma_f32_16x16x32_bf16 v[172:175], a[196:199], v[108:111], v[172:175]
    buffer_load_dwordx4 v[92:95], v9, s[16:19], s48 offen sc1
    v_mfma_f32_16x16x32_bf16 v[176:179], a[200:203], v[108:111], v[176:179]
    s_waitcnt vmcnt(16)
    v_mfma_f32_16x16x32_bf16 v[16:19], a[184:187], v[96:99], v[16:19]
    v_mfma_f32_16x16x32_bf16 v[20:23], a[188:191], v[96:99], v[20:23]
    buffer_load_dwordx4 v[80:83], v6, s[16:19], s48 offen sc1
    v_mfma_f32_16x16x32_bf16 v[24:27], a[192:195], v[96:99], v[24:27]
    v_mfma_f32_16x16x32_bf16 v[28:31], a[196:199], v[96:99], v[28:31]
    v_mfma_f32_16x16x32_bf16 v[32:35], a[200:203], v[96:99], v[32:35]
    s_waitcnt vmcnt(15)
    v_mfma_f32_16x16x32_bf16 v[36:39], a[204:207], v[116:119], v[36:39]
    s_cmp_le_i32 s9, 36
    s_cselect_b32 s49, s7, s3
    v_mfma_f32_16x16x32_bf16 v[40:43], a[208:211], v[116:119], v[40:43]
    v_mfma_f32_16x16x32_bf16 v[44:47], a[212:215], v[116:119], v[44:47]
    v_mfma_f32_16x16x32_bf16 v[48:51], a[224:227], v[116:119], v[48:51]
    s_add_u32 s49, s49, 36
    v_mfma_f32_16x16x32_bf16 v[52:55], a[228:231], v[116:119], v[52:55]
    s_waitcnt vmcnt(14)
    v_mfma_f32_16x16x32_bf16 v[56:59], a[204:207], v[120:123], v[56:59]
    s_lshl_b32 s48, s49, 10
    v_mfma_f32_16x16x32_bf16 v[60:63], a[208:211], v[120:123], v[60:63]
    buffer_load_dwordx4 v[100:103], v7, s[16:19], s48 offen sc1
    v_mfma_f32_16x16x32_bf16 v[64:67], a[212:215], v[120:123], v[64:67]
    v_mfma_f32_16x16x32_bf16 v[68:71], a[224:227], v[120:123], v[68:71]
    v_mfma_f32_16x16x32_bf16 v[72:75], a[228:231], v[120:123], v[72:75]
    s_waitcnt vmcnt(14)
    v_mfma_f32_16x16x32_bf16 v[160:163], a[204:207], v[124:127], v[160:163]
    buffer_load_dwordx4 v[104:107], v8, s[16:19], s48 offen sc1
    v_mfma_f32_16x16x32_bf16 v[164:167], a[208:211], v[124:127], v[164:167]
    v_mfma_f32_16x16x32_bf16 v[168:171], a[212:215], v[124:127], v[168:171]
    v_mfma_f32_16x16x32_bf16 v[172:175], a[224:227], v[124:127], v[172:175]
    buffer_load_dwordx4 v[108:111], v9, s[16:19], s48 offen sc1
    v_mfma_f32_16x16x32_bf16 v[176:179], a[228:231], v[124:127], v[176:179]
    s_waitcnt vmcnt(15)
    v_mfma_f32_16x16x32_bf16 v[16:19], a[204:207], v[112:115], v[16:19]
    v_mfma_f32_16x16x32_bf16 v[20:23], a[208:211], v[112:115], v[20:23]
    buffer_load_dwordx4 v[96:99], v6, s[16:19], s48 offen sc1
    v_mfma_f32_16x16x32_bf16 v[24:27], a[212:215], v[112:115], v[24:27]
    v_mfma_f32_16x16x32_bf16 v[28:31], a[224:227], v[112:115], v[28:31]
    v_mfma_f32_16x16x32_bf16 v[32:35], a[228:231], v[112:115], v[32:35]
    s_waitcnt vmcnt(15)
    v_mfma_f32_16x16x32_bf16 v[36:39], a[232:235], v[132:135], v[36:39]
    s_cmp_le_i32 s9, 40
    s_cselect_b32 s49, s7, s3
    v_mfma_f32_16x16x32_bf16 v[40:43], a[236:239], v[132:135], v[40:43]
    v_mfma_f32_16x16x32_bf16 v[44:47], a[240:243], v[132:135], v[44:47]
    v_mfma_f32_16x16x32_bf16 v[48:51], a[244:247], v[132:135], v[48:51]
    s_add_u32 s49, s49, 40
    v_mfma_f32_16x16x32_bf16 v[52:55], a[216:219], v[132:135], v[52:55]
    s_waitcnt vmcnt(14)
    v_mfma_f32_16x16x32_bf16 v[56:59], a[232:235], v[136:139], v[56:59]
    s_lshl_b32 s48, s49, 10
    v_mfma_f32_16x16x32_bf16 v[60:63], a[236:239], v[136:139], v[60:63]
    buffer_load_dwordx4 v[116:119], v7, s[16:19], s48 offen sc1
    v_mfma_f32_16x16x32_bf16 v[64:67], a[240:243], v[136:139], v[64:67]
    v_mfma_f32_16x16x32_bf16 v[68:71], a[244:247], v[136:139], v[68:71]
    v_mfma_f32_16x16x32_bf16 v[72:75], a[216:219], v[136:139], v[72:75]
    s_waitcnt vmcnt(14)
    v_mfma_f32_16x16x32_bf16 v[160:163], a[232:235], v[140:143], v[160:163]
    buffer_load_dwordx4 v[120:123], v8, s[16:19], s48 offen sc1
    v_mfma_f32_16x16x32_bf16 v[164:167], a[236:239], v[140:143], v[164:167]
    v_mfma_f32_16x16x32_bf16 v[168:171], a[240:243], v[140:143], v[168:171]
    v_mfma_f32_16x16x32_bf16 v[172:175], a[244:247], v[140:143], v[172:175]
    buffer_load_dwordx4 v[124:127], v9, s[16:19], s48 offen sc1
    v_mfma_f32_16x16x32_bf16 v[176:179], a[216:219], v[140:143], v[176:179]
    s_waitcnt vmcnt(15)
    v_mfma_f32_16x16x32_bf16 v[16:19], a[232:235], v[128:131], v[16:19]
    v_mfma_f32_16x16x32_bf16 v[20:23], a[236:239], v[128:131], v[20:23]
    buffer_load_dwordx4 v[112:115], v6, s[16:19], s48 offen sc1
    v_mfma_f32_16x16x32_bf16 v[24:27], a[240:243], v[128:131], v[24:27]
    v_mfma_f32_16x16x32_bf16 v[28:31], a[244:247], v[128:131], v[28:31]
    v_mfma_f32_16x16x32_bf16 v[32:35], a[216:219], v[128:131], v[32:35]
    s_waitcnt vmcnt(15)
    v_mfma_f32_16x16x32_bf16 v[36:39], a[220:223], v[148:151], v[36:39]
    s_cmp_le_i32 s9, 44
    s_cselect_b32 s49, s7, s3
    v_mfma_f32_16x16x32_bf16 v[40:43], a[248:251], v[148:151], v[40:43]
    v_mfma_f32_16x16x32_bf16 v[44:47], a[252:255], v[148:151], v[44:47]
    s_add_u32 s49, s49, 44
    v_mfma_f32_16x16x32_bf16 v[48:51], a[0:3], v[148:151], v[48:51]
    v_mfma_f32_16x16x32_bf16 v[52:55], a[4:7], v[148:151], v[52:55]
    s_lshl_b32 s48, s49, 10
    s_waitcnt vmcnt(14)
    v_mfma_f32_16x16x32_bf16 v[56:59], a[220:223], v[152:155], v[56:59]
    s_cmp_ge_u32 s49, 54
    s_cselect_b32 s48, 1073741824, s48
    v_mfma_f32_16x16x32_bf16 v[60:63], a[248:251], v[152:155], v[60:63]
    v_mfma_f32_16x16x32_bf16 v[64:67], a[252:255], v[152:155], v[64:67]
    v_mfma_f32_16x16x32_bf16 v[68:71], a[0:3], v[152:155], v[68:71]
    buffer_load_dwordx4 v[132:135], v7, s[16:19], s48 offen sc1
    v_mfma_f32_16x16x32_bf16 v[72:75], a[4:7], v[152:155], v[72:75]
    s_waitcnt vmcnt(14)
    v_mfma_f32_16x16x32_bf16 v[160:163], a[220:223], v[156:159], v[160:163]
    v_mfma_f32_16x16x32_bf16 v[164:167], a[248:251], v[156:159], v[164:167]
    buffer_load_dwordx4 v[136:139], v8, s[16:19], s48 offen sc1
    v_mfma_f32_16x16x32_bf16 v[168:171], a[252:255], v[156:159], v[168:171]
    v_mfma_f32_16x16x32_bf16 v[172:175], a[0:3], v[156:159], v[172:175]
    v_mfma_f32_16x16x32_bf16 v[176:179], a[4:7], v[156:159], v[176:179]
    s_waitcnt vmcnt(14)
    v_mfma_f32_16x16x32_bf16 v[16:19], a[220:223], v[144:147], v[16:19]
    buffer_load_dwordx4 v[140:143], v9, s[16:19], s48 offen sc1
    v_mfma_f32_16x16x32_bf16 v[20:23], a[248:251], v[144:147], v[20:23]
    v_mfma_f32_16x16x32_bf16 v[24:27], a[252:255], v[144:147], v[24:27]
    buffer_load_dwordx4 v[128:131], v6, s[16:19], s48 offen sc1
    v_mfma_f32_16x16x32_bf16 v[28:31], a[0:3], v[144:147], v[28:31]
    v_mfma_f32_16x16x32_bf16 v[32:35], a[4:7], v[144:147], v[32:35]
    s_waitcnt vmcnt(15)
    v_mfma_f32_16x16x32_bf16 v[36:39], a[8:11], v[84:87], v[36:39]
    s_add_u32 s60, s44, 0
    v_mfma_f32_16x16x32_bf16 v[40:43], a[12:15], v[84:87], v[40:43]
    v_mfma_f32_16x16x32_bf16 v[44:47], a[16:19], v[84:87], v[44:47]
    buffer_load_dwordx4 a[64:67], v1, s[16:19], s60 offen sc1
    v_mfma_f32_16x16x32_bf16 v[48:51], a[20:23], v[84:87], v[48:51]
    v_mfma_f32_16x16x32_bf16 v[52:55], a[32:35], v[84:87], v[52:55]
    s_waitcnt vmcnt(15)
    v_mfma_f32_16x16x32_bf16 v[56:59], a[8:11], v[88:91], v[56:59]
    v_mfma_f32_16x16x32_bf16 v[60:63], a[12:15], v[88:91], v[60:63]
    buffer_load_dwordx4 a[68:71], v1, s[16:19], s60 offen offset:1024 sc1
    v_mfma_f32_16x16x32_bf16 v[64:67], a[16:19], v[88:91], v[64:67]
    v_mfma_f32_16x16x32_bf16 v[68:71], a[20:23], v[88:91], v[68:71]
    v_mfma_f32_16x16x32_bf16 v[72:75], a[32:35], v[88:91], v[72:75]
    s_waitcnt vmcnt(15)
    v_mfma_f32_16x16x32_bf16 v[160:163], a[8:11], v[92:95], v[160:163]
    v_mfma_f32_16x16x32_bf16 v[164:167], a[12:15], v[92:95], v[164:167]
    buffer_load_dwordx4 a[72:75], v1, s[16:19], s60 offen offset:2048 sc1
    v_mfma_f32_16x16x32_bf16 v[168:171], a[16:19], v[92:95], v[168:171]
    v_mfma_f32_16x16x32_bf16 v[172:175], a[20:23], v[92:95], v[172:175]
    v_mfma_f32_16x16x32_bf16 v[176:179], a[32:35], v[92:95], v[176:179]
    s_waitcnt vmcnt(15)
    v_mfma_f32_16x16x32_bf16 v[16:19], a[8:11], v[80:83], v[16:19]
    buffer_load_dwordx4 a[76:79], v1, s[16:19], s60 offen offset:3072 sc1
    v_mfma_f32_16x16x32_bf16 v[20:23], a[12:15], v[80:83], v[20:23]
    v_mfma_f32_16x16x32_bf16 v[24:27], a[16:19], v[80:83], v[24:27]
    v_mfma_f32_16x16x32_bf16 v[28:31], a[20:23], v[80:83], v[28:31]
    v_mfma_f32_16x16x32_bf16 v[32:35], a[32:35], v[80:83], v[32:35]
    s_waitcnt vmcnt(15)
    v_mfma_f32_16x16x32_bf16 v[36:39], a[36:39], v[100:103], v[36:39]
    s_mul_i32 s51, s59, 20
    s_add_u32 s60, s44, 36864
    v_mfma_f32_16x16x32_bf16 v[40:43], a[40:43], v[100:103], v[40:43]
    s_add_u32 s48, s51, s56
    s_lshl_b32 s48, s48, 10
    v_mfma_f32_16x16x32_bf16 v[44:47], a[44:47], v[100:103], v[44:47]
    buffer_load_dwordx4 a[80:83], v1, s[16:19], s60 offen sc1
    v_mfma_f32_16x16x32_bf16 v[48:51], a[48:51], v[100:103], v[48:51]
    s_add_u32 s48, s48, 2621440
    s_add_u32 s49, s48, 1024
    v_mfma_f32_16x16x32_bf16 v[52:55], a[52:55], v[100:103], v[52:55]
    s_add_u32 s50, s51, s57
    s_waitcnt vmcnt(12)
    v_mfma_f32_16x16x32_bf16 v[36:39], a[24:27], v[116:119], v[36:39]
    s_lshl_b32 s50, s50, 10
    s_lshl_b32 s51, s58, 9
    v_mfma_f32_16x16x32_bf16 v[40:43], a[28:31], v[116:119], v[40:43]
    buffer_load_dwordx4 a[84:87], v1, s[16:19], s60 offen offset:1024 sc1
    v_mfma_f32_16x16x32_bf16 v[44:47], a[56:59], v[116:119], v[44:47]
    s_add_u32 s50, s50, s51
    s_add_u32 s50, s50, 2621440
    v_mfma_f32_16x16x32_bf16 v[48:51], a[60:63], v[116:119], v[48:51]
    v_mov_b32 v76, v1
    v_lshrrev_b32 v77, 1, v3
    v_mfma_f32_16x16x32_bf16 v[52:55], v[192:195], v[116:119], v[52:55]
    v_lshlrev_b32 v77, 6, v77
    s_waitcnt vmcnt(9)
    v_mfma_f32_16x16x32_bf16 v[36:39], v[196:199], v[132:135], v[36:39]
    buffer_load_dwordx4 a[96:99], v1, s[16:19], s60 offen offset:2048 sc1
    v_mfma_f32_16x16x32_bf16 v[40:43], v[200:203], v[132:135], v[40:43]
    v_lshl_add_u32 v77, v2, 2, v77
    v_lshl_add_u32 v77, v15, 30, v77
    v_mfma_f32_16x16x32_bf16 v[44:47], v[204:207], v[132:135], v[44:47]
    buffer_load_dwordx4 a[100:103], v1, s[16:19], s60 offen offset:3072 sc1
    v_mfma_f32_16x16x32_bf16 v[48:51], v[208:211], v[132:135], v[48:51]
    s_lshl_b32 s52, s59, 3
    s_add_u32 s52, s52, s31
    v_mfma_f32_16x16x32_bf16 v[52:55], v[212:215], v[132:135], v[52:55]
    s_lshl_b32 s52, s52, 7
    s_add_u32 s52, s52, 29065216
    s_waitcnt vmcnt(18)
    v_mfma_f32_16x16x32_bf16 v[56:59], a[36:39], v[104:107], v[56:59]
    v_mfma_f32_16x16x32_bf16 v[60:63], a[40:43], v[104:107], v[60:63]
    v_mfma_f32_16x16x32_bf16 v[64:67], a[44:47], v[104:107], v[64:67]
    v_mfma_f32_16x16x32_bf16 v[68:71], a[48:51], v[104:107], v[68:71]
    s_add_u32 s60, s45, 0
    v_mfma_f32_16x16x32_bf16 v[72:75], a[52:55], v[104:107], v[72:75]
    s_waitcnt vmcnt(14)
    v_mfma_f32_16x16x32_bf16 v[56:59], a[24:27], v[120:123], v[56:59]
    buffer_load_dwordx4 a[104:107], v1, s[16:19], s60 offen sc1
    v_mfma_f32_16x16x32_bf16 v[60:63], a[28:31], v[120:123], v[60:63]
    ds_write_b128 v11, v[36:39] offset:0
    v_mfma_f32_16x16x32_bf16 v[64:67], a[56:59], v[120:123], v[64:67]
    buffer_load_dwordx4 a[108:111], v1, s[16:19], s60 offen offset:1024 sc1
    v_mfma_f32_16x16x32_bf16 v[68:71], a[60:63], v[120:123], v[68:71]
    ds_write_b128 v11, v[40:43] offset:1024
    v_mfma_f32_16x16x32_bf16 v[72:75], v[192:195], v[120:123], v[72:75]
    s_waitcnt vmcnt(12)
    v_mfma_f32_16x16x32_bf16 v[56:59], v[196:199], v[136:139], v[56:59]
    ds_write_b128 v11, v[44:47] offset:2048
    v_mfma_f32_16x16x32_bf16 v[60:63], v[200:203], v[136:139], v[60:63]
    buffer_load_dwordx4 a[112:115], v1, s[16:19], s60 offen offset:2048 sc1
    v_mfma_f32_16x16x32_bf16 v[64:67], v[204:207], v[136:139], v[64:67]
    ds_write_b128 v11, v[48:51] offset:3072
    v_mfma_f32_16x16x32_bf16 v[68:71], v[208:211], v[136:139], v[68:71]
    buffer_load_dwordx4 a[116:119], v1, s[16:19], s60 offen offset:3072 sc1
    v_mfma_f32_16x16x32_bf16 v[72:75], v[212:215], v[136:139], v[72:75]
    ds_write_b128 v11, v[52:55] offset:4096
    s_waitcnt vmcnt(21)
    v_mfma_f32_16x16x32_bf16 v[160:163], a[36:39], v[108:111], v[160:163]
    v_mfma_f32_16x16x32_bf16 v[164:167], a[40:43], v[108:111], v[164:167]
    v_mfma_f32_16x16x32_bf16 v[168:171], a[44:47], v[108:111], v[168:171]
    v_mfma_f32_16x16x32_bf16 v[172:175], a[48:51], v[108:111], v[172:175]
    s_add_u32 s60, s45, 36864
    v_mfma_f32_16x16x32_bf16 v[176:179], a[52:55], v[108:111], v[176:179]
    s_waitcnt vmcnt(17)
    v_mfma_f32_16x16x32_bf16 v[160:163], a[24:27], v[124:127], v[160:163]
    buffer_load_dwordx4 a[88:91], v1, s[16:19], s60 offen sc1
    v_mfma_f32_16x16x32_bf16 v[164:167], a[28:31], v[124:127], v[164:167]
    ds_write_b128 v12, v[56:59] offset:0
    v_mfma_f32_16x16x32_bf16 v[168:171], a[56:59], v[124:127], v[168:171]
    buffer_load_dwordx4 a[92:95], v1, s[16:19], s60 offen offset:1024 sc1
    v_mfma_f32_16x16x32_bf16 v[172:175], a[60:63], v[124:127], v[172:175]
    ds_write_b128 v12, v[60:63] offset:1024
    v_mfma_f32_16x16x32_bf16 v[176:179], v[192:195], v[124:127], v[176:179]
    s_waitcnt vmcnt(15)
    v_mfma_f32_16x16x32_bf16 v[160:163], v[196:199], v[140:143], v[160:163]
    ds_write_b128 v12, v[64:67] offset:2048
    v_mfma_f32_16x16x32_bf16 v[164:167], v[200:203], v[140:143], v[164:167]
    buffer_load_dwordx4 a[120:123], v1, s[16:19], s60 offen offset:2048 sc1
    v_mfma_f32_16x16x32_bf16 v[168:171], v[204:207], v[140:143], v[168:171]
    ds_write_b128 v12, v[68:71] offset:3072
    v_mfma_f32_16x16x32_bf16 v[172:175], v[208:211], v[140:143], v[172:175]
    buffer_load_dwordx4 a[124:127], v1, s[16:19], s60 offen offset:3072 sc1
    v_mfma_f32_16x16x32_bf16 v[176:179], v[212:215], v[140:143], v[176:179]
    ds_write_b128 v12, v[72:75] offset:4096
    s_waitcnt vmcnt(24)
    v_mfma_f32_16x16x32_bf16 v[16:19], a[36:39], v[96:99], v[16:19]
    v_mfma_f32_16x16x32_bf16 v[20:23], a[40:43], v[96:99], v[20:23]
    v_mfma_f32_16x16x32_bf16 v[24:27], a[44:47], v[96:99], v[24:27]
    v_mfma_f32_16x16x32_bf16 v[28:31], a[48:51], v[96:99], v[28:31]
    v_mfma_f32_16x16x32_bf16 v[32:35], a[52:55], v[96:99], v[32:35]
    s_waitcnt vmcnt(20)
    v_mfma_f32_16x16x32_bf16 v[16:19], a[24:27], v[112:115], v[16:19]
    v_mfma_f32_16x16x32_bf16 v[20:23], a[28:31], v[112:115], v[20:23]
    ds_write_b128 v14, v[160:163] offset:0
    v_mfma_f32_16x16x32_bf16 v[24:27], a[56:59], v[112:115], v[24:27]
    v_mfma_f32_16x16x32_bf16 v[28:31], a[60:63], v[112:115], v[28:31]
    ds_write_b128 v14, v[164:167] offset:1024
    v_mfma_f32_16x16x32_bf16 v[32:35], v[192:195], v[112:115], v[32:35]
    s_waitcnt vmcnt(16)
    v_mfma_f32_16x16x32_bf16 v[16:19], v[196:199], v[128:131], v[16:19]
    ds_write_b128 v14, v[168:171] offset:2048
    v_mfma_f32_16x16x32_bf16 v[20:23], v[200:203], v[128:131], v[20:23]
    v_mfma_f32_16x16x32_bf16 v[24:27], v[204:207], v[128:131], v[24:27]
    ds_write_b128 v14, v[172:175] offset:3072
    v_mfma_f32_16x16x32_bf16 v[28:31], v[208:211], v[128:131], v[28:31]
    v_mfma_f32_16x16x32_bf16 v[32:35], v[212:215], v[128:131], v[32:35]
    ds_write_b128 v14, v[176:179] offset:4096
    v_lshlrev_b32 v192, 16, v232
    v_and_b32 v193, s10, v232
    v_lshlrev_b32 v194, 16, v233
    v_and_b32 v195, s10, v233
    v_lshlrev_b32 v196, 16, v234
    v_and_b32 v197, s10, v234
    v_lshlrev_b32 v198, 16, v235
    v_and_b32 v199, s10, v235
    v_lshlrev_b32 v200, 16, v236
    v_and_b32 v201, s10, v236
    v_lshlrev_b32 v202, 16, v237
    v_and_b32 v203, s10, v237
    v_lshlrev_b32 v204, 16, v238
    v_and_b32 v205, s10, v238
    v_lshlrev_b32 v206, 16, v239
    v_and_b32 v207, s10, v239
    v_lshlrev_b32 v208, 16, v240
    v_and_b32 v209, s10, v240
    v_lshlrev_b32 v210, 16, v241
    v_and_b32 v211, s10, v241
    s_waitcnt lgkmcnt(0)
    s_barrier
    ds_read_b128 v[80:83], v10 offset:0
    ds_read_b128 v[84:87], v10 offset:5120
    ds_read_b128 v[88:91], v10 offset:10240
    ds_read_b128 v[92:95], v10 offset:1024
    ds_read_b128 v[96:99], v10 offset:6144
    ds_read_b128 v[100:103], v10 offset:11264
    ds_read_b128 v[104:107], v10 offset:2048
    ds_read_b128 v[108:111], v10 offset:7168
    ds_read_b128 v[112:115], v10 offset:12288
    ds_read_b128 v[116:119], v10 offset:3072
    ds_read_b128 v[120:123], v10 offset:8192
    ds_read_b128 v[124:127], v10 offset:13312
    ds_read_b128 v[128:131], v10 offset:4096
    ds_read_b128 v[132:135], v10 offset:9216
    ds_read_b128 v[136:139], v10 offset:14336
    s_waitcnt lgkmcnt(12)
    v_pk_add_f32 v[80:81], v[80:81], v[84:85]
    v_pk_add_f32 v[16:17], v[16:17], v[88:89]
    v_pk_add_f32 v[82:83], v[82:83], v[86:87]
    v_pk_add_f32 v[18:19], v[18:19], v[90:91]
    v_pk_add_f32 v[16:17], v[16:17], v[80:81]
    v_pk_add_f32 v[18:19], v[18:19], v[82:83]
    v_fmac_f32 v192, v242, v16
    v_fmac_f32 v193, v242, v17
    v_fmac_f32 v194, v242, v18
    v_fmac_f32 v195, v242, v19
    v_cvt_pk_bf16_f32 v36, v192, v193
    v_cvt_pk_bf16_f32 v37, v194, v195
    s_waitcnt lgkmcnt(9)
    v_pk_add_f32 v[92:93], v[92:93], v[96:97]
    v_pk_add_f32 v[20:21], v[20:21], v[100:101]
    v_pk_add_f32 v[94:95], v[94:95], v[98:99]
    v_pk_add_f32 v[22:23], v[22:23], v[102:103]
    v_pk_add_f32 v[20:21], v[20:21], v[92:93]
    v_pk_add_f32 v[22:23], v[22:23], v[94:95]
    v_fmac_f32 v196, v242, v20
    v_fmac_f32 v197, v242, v21
    v_fmac_f32 v198, v242, v22
    v_fmac_f32 v199, v242, v23
    v_cvt_pk_bf16_f32 v38, v196, v197
    v_cvt_pk_bf16_f32 v39, v198, v199
    buffer_store_dwordx4 v[36:39], v76, s[16:19], s48 offen sc1
    s_waitcnt lgkmcnt(6)
    v_pk_add_f32 v[104:105], v[104:105], v[108:109]
    v_pk_add_f32 v[24:25], v[24:25], v[112:113]
    v_pk_add_f32 v[106:107], v[106:107], v[110:111]
    v_pk_add_f32 v[26:27], v[26:27], v[114:115]
    v_pk_add_f32 v[24:25], v[24:25], v[104:105]
    v_pk_add_f32 v[26:27], v[26:27], v[106:107]
    v_fmac_f32 v200, v242, v24
    v_fmac_f32 v201, v242, v25
    v_fmac_f32 v202, v242, v26
    v_fmac_f32 v203, v242, v27
    v_cvt_pk_bf16_f32 v40, v200, v201
    v_cvt_pk_bf16_f32 v41, v202, v203
    s_waitcnt lgkmcnt(3)
    v_pk_add_f32 v[116:117], v[116:117], v[120:121]
    v_pk_add_f32 v[28:29], v[28:29], v[124:125]
    v_pk_add_f32 v[118:119], v[118:119], v[122:123]
    v_pk_add_f32 v[30:31], v[30:31], v[126:127]
    v_pk_add_f32 v[28:29], v[28:29], v[116:117]
    v_pk_add_f32 v[30:31], v[30:31], v[118:119]
    v_fmac_f32 v204, v242, v28
    v_fmac_f32 v205, v242, v29
    v_fmac_f32 v206, v242, v30
    v_fmac_f32 v207, v242, v31
    v_cvt_pk_bf16_f32 v42, v204, v205
    v_cvt_pk_bf16_f32 v43, v206, v207
    buffer_store_dwordx4 v[40:43], v76, s[16:19], s49 offen sc1
    s_waitcnt lgkmcnt(0)
    v_pk_add_f32 v[128:129], v[128:129], v[132:133]
    v_pk_add_f32 v[32:33], v[32:33], v[136:137]
    v_pk_add_f32 v[130:131], v[130:131], v[134:135]
    v_pk_add_f32 v[34:35], v[34:35], v[138:139]
    v_pk_add_f32 v[32:33], v[32:33], v[128:129]
    v_pk_add_f32 v[34:35], v[34:35], v[130:131]
    v_fmac_f32 v208, v242, v32
    v_fmac_f32 v209, v242, v33
    v_fmac_f32 v210, v242, v34
    v_fmac_f32 v211, v242, v35
    v_cvt_pk_bf16_f32 v44, v208, v209
    v_cvt_pk_bf16_f32 v45, v210, v211
    v_mov_b32 v46, v44
    v_mov_b32 v47, v45
    v_mov_b32 v48, v44
    v_mov_b32 v49, v45
    s_nop 0
    v_permlane16_swap_b32 v48, v46
    v_permlane16_swap_b32 v49, v47
    buffer_store_dwordx4 v[44:47], v252, s[16:19], s50 offen sc1
    v_pk_mul_f32 v[82:83], v[192:193], v[192:193]
    v_pk_add_f32 v[80:81], v[192:193], v[194:195]
    v_pk_fma_f32 v[82:83], v[194:195], v[194:195], v[82:83]
    v_pk_add_f32 v[80:81], v[80:81], v[196:197]
    v_pk_fma_f32 v[82:83], v[196:197], v[196:197], v[82:83]
    v_pk_add_f32 v[80:81], v[80:81], v[198:199]
    v_pk_fma_f32 v[82:83], v[198:199], v[198:199], v[82:83]
    v_pk_add_f32 v[80:81], v[80:81], v[200:201]
    v_pk_fma_f32 v[82:83], v[200:201], v[200:201], v[82:83]
    v_pk_add_f32 v[80:81], v[80:81], v[202:203]
    v_pk_fma_f32 v[82:83], v[202:203], v[202:203], v[82:83]
    v_pk_add_f32 v[80:81], v[80:81], v[204:205]
    v_pk_fma_f32 v[82:83], v[204:205], v[204:205], v[82:83]
    v_pk_add_f32 v[80:81], v[80:81], v[206:207]
    v_pk_fma_f32 v[82:83], v[206:207], v[206:207], v[82:83]
    v_pk_add_f32 v[80:81], v[80:81], v[208:209]
    v_pk_fma_f32 v[82:83], v[208:209], v[208:209], v[82:83]
    v_pk_add_f32 v[80:81], v[80:81], v[210:211]
    v_pk_fma_f32 v[82:83], v[210:211], v[210:211], v[82:83]
    v_add_f32 v80, v80, v81
    v_add_f32 v82, v82, v83
    s_nop 1
    v_permlane32_swap_b32 v80, v82
    v_add_f32 v80, v80, v82
    v_mov_b32 v81, v80
    s_nop 1
    v_permlane16_swap_b32 v80, v81
    v_add_f32 v80, v80, v81
    buffer_store_dword v80, v77, s[16:19], s52 offen sc1
    s_getpc_b64 s[12:13]
Lpc_m_46:
    s_mov_b32 s14, Lcodeend_m-Lpc_m_46
    s_lshl_b32 s54, s11, 2
    s_add_u32 s54, s54, s3
    s_lshl_b32 s54, s54, 8
    v_lshlrev_b32 v254, 2, v0
    buffer_load_dword v255, v254, s[12:15], s54 offen
    v_add_u32 v14, 81920, v1
    v_lshlrev_b32 v15, 31, v2
    v_mov_b32 v20, 0x3f803f80
    v_mov_b32 v21, 0x3f803f80
    s_add_u32 s60, s44, 4096
    v_mov_b32 v22, 0x3f803f80
    v_mov_b32 v23, 0x3f803f80
    v_and_b32 v253, 31, v0
    v_lshlrev_b32 v253, 10, v253
    buffer_load_dwordx4 a[128:131], v1, s[16:19], s60 offen sc1
    s_lshl_b32 s48, s28, 7
    s_add_u32 s48, s48, 29229056
    v_add_u32 v253, s48, v253
    buffer_load_dwordx4 a[132:135], v1, s[16:19], s60 offen offset:1024 sc1
    v_cvt_f32_u32 v24, v2
    v_mul_f32 v24, 0x3d800000, v24
    v_lshlrev_b32 v25, 2, v3
    v_cvt_f32_u32 v25, v25
    buffer_load_dwordx4 a[136:139], v1, s[16:19], s60 offen offset:2048 sc1
    v_mul_f32 v25, v25, v24
    v_cos_f32 v184, v25
    v_sin_f32 v188, v25
    buffer_load_dwordx4 a[140:143], v1, s[16:19], s60 offen offset:3072 sc1
    v_add_f32 v25, v25, v24
    v_cos_f32 v185, v25
    v_sin_f32 v189, v25
    v_add_f32 v25, v25, v24
    s_add_u32 s60, s44, 32768
    v_cos_f32 v186, v25
    v_sin_f32 v190, v25
    v_add_f32 v25, v25, v24
    v_cos_f32 v187, v25
    buffer_load_dwordx4 a[144:147], v1, s[16:19], s60 offen sc1
    v_sin_f32 v191, v25
    s_lshl_b32 s63, s3, 2
    v_lshrrev_b32 v24, 1, v2
    buffer_load_dwordx4 a[148:151], v1, s[16:19], s60 offen offset:1024 sc1
    v_lshlrev_b32 v24, 4, v24
    v_add_u32 v24, s63, v24
    v_cvt_f32_u32 v24, v24
    v_lshlrev_b32 v26, 5, v3
    buffer_load_dwordx4 a[160:163], v1, s[16:19], s60 offen offset:2048 sc1
    v_add_u32 v26, s32, v26
    v_cvt_f32_u32 v26, v26
    v_mul_f32 v26, 0x3a000000, v26
    buffer_load_dwordx4 a[164:167], v1, s[16:19], s60 offen offset:3072 sc1
    s_add_u32 s55, s47, 4
    v_mov_b32 v248, s55
    v_mov_b32 v249, s46
    v_lshlrev_b32 v250, 25, v0
    s_waitcnt vmcnt(9)
    s_barrier
    buffer_store_dwordx2 v[248:249], v250, s[16:19], s43 offen sc0 sc1
    v_add_f32 v27, 0x3c000000, v26
    v_and_b32 v25, 1, v2
    v_cvt_f32_u32 v25, v25
    v_mul_f32 v25, 0x3e800000, v25
    s_add_u32 s60, s45, 4096
    v_fma_f32 v28, v24, v26, v25
    v_fma_f32 v29, v24, v27, v25
    v_cos_f32 v30, v28
    v_sin_f32 v31, v28
    buffer_load_dwordx4 a[168:171], v1, s[16:19], s60 offen sc1
    v_cvt_pk_bf16_f32 v192, v30, v31
    v_cos_f32 v30, v29
    v_sin_f32 v31, v29
    buffer_load_dwordx4 a[172:175], v1, s[16:19], s60 offen offset:1024 sc1
    v_cvt_pk_bf16_f32 v193, v30, v31
    v_add_f32 v28, v28, v26
    v_cos_f32 v30, v28
    v_sin_f32 v31, v28
    buffer_load_dwordx4 a[176:179], v1, s[16:19], s60 offen offset:2048 sc1
    v_cvt_pk_bf16_f32 v194, v30, v31
    v_add_f32 v29, v29, v27
    v_cos_f32 v30, v29
    buffer_load_dwordx4 a[180:183], v1, s[16:19], s60 offen offset:3072 sc1
    v_sin_f32 v31, v29
    s_nop 0
    v_cvt_pk_bf16_f32 v195, v30, v31
    v_add_f32 v28, v28, v26
    v_cos_f32 v30, v28
    s_add_u32 s60, s45, 32768
    v_sin_f32 v31, v28
    s_nop 0
    v_cvt_pk_bf16_f32 v196, v30, v31
    v_add_f32 v29, v29, v27
    v_cos_f32 v30, v29
    buffer_load_dwordx4 a[152:155], v1, s[16:19], s60 offen sc1
    v_sin_f32 v31, v29
    s_nop 0
    v_cvt_pk_bf16_f32 v197, v30, v31
    v_add_f32 v28, v28, v26
    buffer_load_dwordx4 a[156:159], v1, s[16:19], s60 offen offset:1024 sc1
    v_cos_f32 v30, v28
    v_sin_f32 v31, v28
    s_nop 0
    v_cvt_pk_bf16_f32 v198, v30, v31
    v_add_f32 v29, v29, v27
    buffer_load_dwordx4 a[184:187], v1, s[16:19], s60 offen offset:2048 sc1
    v_cos_f32 v30, v29
    v_sin_f32 v31, v29
    s_nop 0
    v_cvt_pk_bf16_f32 v199, v30, v31
    buffer_load_dwordx4 a[188:191], v1, s[16:19], s60 offen offset:3072 sc1
    buffer_load_dwordx2 v[248:249], v253, s[16:19], 0 offen sc1
    s_mov_b32 s55, 0
    s_add_u32 s54, s47, 4
    s_waitcnt vmcnt(0)
ploop_m_48:
    v_subrev_u32 v248, s54, v248
    v_xor_b32 v249, s46, v249
    v_lshl_or_b32 v248, v249, 3, v248
    v_and_b32 v249, -8, v249
    v_or_b32 v248, v248, v249
    v_cmp_le_u32 vcc, 4, v248
    s_add_u32 s55, s55, 1
    s_cmp_ge_u32 s55, 200000
    s_cbranch_scc1 pok_m_47
    s_nop 2
    s_cbranch_vccz pok_m_47
    s_sleep 1
    buffer_load_dwordx2 v[248:249], v253, s[16:19], 0 offen sc1
    s_waitcnt vmcnt(0)
    s_branch ploop_m_48
pok_m_47:
    s_cmp_ge_u32 s2, 160
    s_cbranch_scc1 nop1_m_6
    s_lshl_b32 s56, s3, 5
    s_add_u32 s56, s56, s32
    s_mul_i32 s58, s56, 20480
    s_add_u32 s58, s58, 2621440
    s_add_u32 s48, s6, 5
    s_cmp_ge_u32 s48, 10
    s_cselect_b32 s51, 10, 0
    s_sub_u32 s48, s48, s51
    s_lshl_b32 s48, s48, 11
    s_add_u32 s48, s48, s58
    s_add_u32 s49, s48, 327680
    buffer_load_dwordx4 v[112:115], v1, s[16:19], s48 offen sc1
    buffer_load_dwordx4 v[116:119], v1, s[16:19], s49 offen sc1
    buffer_load_dwordx4 v[120:123], v1, s[16:19], s48 offen offset:1024 sc1
    buffer_load_dwordx4 v[124:127], v1, s[16:19], s49 offen offset:1024 sc1
    v_and_b32 v16, 7, v2
    v_lshlrev_b32 v16, 7, v16
    v_lshrrev_b32 v17, 3, v2
    v_lshl_add_u32 v16, v17, 6, v16
    v_lshl_add_u32 v16, v3, 4, v16
    s_lshl_b32 s48, s56, 10
    s_add_u32 s48, s48, 29065216
    s_add_u32 s49, s48, 16384
    buffer_load_dwordx4 v[64:67], v16, s[16:19], s48 offen sc1
    buffer_load_dwordx4 v[68:71], v16, s[16:19], s49 offen sc1
    s_add_u32 s48, s6, 6
    s_cmp_ge_u32 s48, 10
    s_cselect_b32 s51, 10, 0
    s_sub_u32 s48, s48, s51
    s_lshl_b32 s48, s48, 11
    s_add_u32 s48, s48, s58
    s_add_u32 s49, s48, 327680
    buffer_load_dwordx4 v[128:131], v1, s[16:19], s48 offen sc1
    buffer_load_dwordx4 v[132:135], v1, s[16:19], s49 offen sc1
    buffer_load_dwordx4 v[136:139], v1, s[16:19], s48 offen offset:1024 sc1
    buffer_load_dwordx4 v[140:143], v1, s[16:19], s49 offen offset:1024 sc1
    s_add_u32 s48, s6, 7
    s_cmp_ge_u32 s48, 10
    s_cselect_b32 s51, 10, 0
    s_sub_u32 s48, s48, s51
    s_lshl_b32 s48, s48, 11
    s_add_u32 s48, s48, s58
    s_add_u32 s49, s48, 327680
    buffer_load_dwordx4 v[144:147], v1, s[16:19], s48 offen sc1
    buffer_load_dwordx4 v[148:151], v1, s[16:19], s49 offen sc1
    buffer_load_dwordx4 v[152:155], v1, s[16:19], s48 offen offset:1024 sc1
    buffer_load_dwordx4 v[156:159], v1, s[16:19], s49 offen offset:1024 sc1
    ds_read_b128 v[80:83], v14 offset:0
    ds_read_b128 v[84:87], v14 offset:1024
    ds_read_b128 v[88:91], v14 offset:2048
    ds_read_b128 v[92:95], v14 offset:3072
    ds_read_b128 v[96:99], v14 offset:4096
    ds_read_b128 v[100:103], v14 offset:5120
    ds_read_b128 v[104:107], v14 offset:6144
    ds_read_b128 v[108:111], v14 offset:7168
    s_waitcnt vmcnt(10) lgkmcnt(4)
    v_mfma_f32_16x16x32_bf16 v[32:35], v[112:115], v[80:83], 0
    ds_read_b128 v[212:215], v14 offset:8192
    s_add_u32 s48, s6, 8
    v_mfma_f32_16x16x32_bf16 v[36:39], v[112:115], v[84:87], 0
    s_cmp_ge_u32 s48, 10
    s_cselect_b32 s51, 10, 0
    v_mfma_f32_16x16x32_bf16 v[40:43], v[112:115], v[88:91], 0
    s_sub_u32 s48, s48, s51
    ds_read_b128 v[216:219], v14 offset:9216
    v_mfma_f32_16x16x32_bf16 v[44:47], v[112:115], v[92:95], 0
    s_lshl_b32 s48, s48, 11
    s_add_u32 s48, s48, s58
    v_mfma_f32_16x16x32_bf16 v[48:51], v[116:119], v[80:83], 0
    s_add_u32 s49, s48, 327680
    ds_read_b128 v[220:223], v14 offset:10240
    v_mfma_f32_16x16x32_bf16 v[52:55], v[116:119], v[84:87], 0
    buffer_load_dwordx4 v[160:163], v1, s[16:19], s48 offen sc1
    v_mfma_f32_16x16x32_bf16 v[56:59], v[116:119], v[88:91], 0
    buffer_load_dwordx4 v[164:167], v1, s[16:19], s49 offen sc1
    v_mfma_f32_16x16x32_bf16 v[60:63], v[116:119], v[92:95], 0
    buffer_load_dwordx4 v[168:171], v1, s[16:19], s48 offen offset:1024 sc1
    ds_read_b128 v[224:227], v14 offset:11264
    buffer_load_dwordx4 v[172:175], v1, s[16:19], s49 offen offset:1024 sc1
    s_waitcnt lgkmcnt(4)
    v_mfma_f32_16x16x32_bf16 v[32:35], v[120:123], v[96:99], v[32:35]
    ds_read_b128 v[228:231], v14 offset:12288
    ds_read_b128 v[232:235], v14 offset:13312
    v_mfma_f32_16x16x32_bf16 v[36:39], v[120:123], v[100:103], v[36:39]
    s_bitcmp1_b32 s3, 0
    s_cselect_b32 s53, s37, s36
    s_cselect_b32 s62, s39, s38
    v_mfma_f32_16x16x32_bf16 v[40:43], v[120:123], v[104:107], v[40:43]
    s_bitcmp1_b32 s3, 1
    s_cselect_b32 s62, s62, s53
    s_xor_b32 s52, s3, 1
    s_lshr_b32 s53, s3, 1
    v_mfma_f32_16x16x32_bf16 v[44:47], v[120:123], v[108:111], v[44:47]
    s_or_b32 s53, s53, s36
    s_cmp_eq_u32 s53, 0
    s_cselect_b32 s52, s3, s52
    v_mfma_f32_16x16x32_bf16 v[48:51], v[124:127], v[96:99], v[48:51]
    s_bitcmp1_b32 s52, 0
    s_cselect_b32 s53, s37, s36
    s_cselect_b32 s63, s39, s38
    s_bitcmp1_b32 s52, 1
    s_cselect_b32 s63, s63, s53
    v_mfma_f32_16x16x32_bf16 v[52:55], v[124:127], v[100:103], v[52:55]
    ds_read_b128 v[236:239], v14 offset:14336
    s_mul_i32 s62, s62, 20480
    s_add_u32 s62, s62, 2621440
    s_mul_i32 s63, s63, 20480
    v_mfma_f32_16x16x32_bf16 v[56:59], v[124:127], v[104:107], v[56:59]
    s_add_u32 s63, s63, 2621440
    ds_read_b128 v[240:243], v14 offset:15360
    s_lshl_b32 s53, s3, 10
    s_lshl_b32 s52, s52, 10
    v_mfma_f32_16x16x32_bf16 v[60:63], v[124:127], v[108:111], v[60:63]
    s_add_u32 m0, s53, 0
    s_add_u32 s61, s62, 0
    buffer_load_dwordx4 v1, s[16:19], s61 offen sc1 lds
    s_add_u32 m0, s53, 4096
    s_add_u32 s61, s62, 1024
    buffer_load_dwordx4 v1, s[16:19], s61 offen sc1 lds
    s_waitcnt vmcnt(10) lgkmcnt(4)
    v_mfma_f32_16x16x32_bf16 v[32:35], v[128:131], v[212:215], v[32:35]
    ds_read_b128 v[80:83], v14 offset:16384
    s_add_u32 s48, s6, 9
    v_mfma_f32_16x16x32_bf16 v[36:39], v[128:131], v[216:219], v[36:39]
    s_waitcnt vmcnt(14)
    v_add_f32_dpp v64, v64, v64 quad_perm:[1,0,3,2] row_mask:0xf bank_mask:0xf
    v_mfma_f32_16x16x32_bf16 v[40:43], v[128:131], v[220:223], v[40:43]
    s_cmp_ge_u32 s48, 10
    s_cselect_b32 s51, 10, 0
    v_mfma_f32_16x16x32_bf16 v[44:47], v[128:131], v[224:227], v[44:47]
    ds_read_b128 v[84:87], v14 offset:17408
    s_sub_u32 s48, s48, s51
    v_mfma_f32_16x16x32_bf16 v[48:51], v[132:135], v[212:215], v[48:51]
    v_add_f32_dpp v65, v65, v65 quad_perm:[1,0,3,2] row_mask:0xf bank_mask:0xf
    s_lshl_b32 s48, s48, 11
    s_add_u32 s48, s48, s58
    v_mfma_f32_16x16x32_bf16 v[52:55], v[132:135], v[216:219], v[52:55]
    v_add_f32_dpp v66, v66, v66 quad_perm:[1,0,3,2] row_mask:0xf bank_mask:0xf
    s_add_u32 s49, s48, 327680
    v_mfma_f32_16x16x32_bf16 v[56:59], v[132:135], v[220:223], v[56:59]
    ds_read_b128 v[88:91], v14 offset:18432
    buffer_load_dwordx4 v[112:115], v1, s[16:19], s48 offen sc1
    v_mfma_f32_16x16x32_bf16 v[60:63], v[132:135], v[224:227], v[60:63]
    v_add_f32_dpp v67, v67, v67 quad_perm:[1,0,3,2] row_mask:0xf bank_mask:0xf
    buffer_load_dwordx4 v[116:119], v1, s[16:19], s49 offen sc1
    ds_read_b128 v[92:95], v14 offset:19456
    buffer_load_dwordx4 v[120:123], v1, s[16:19], s48 offen offset:1024 sc1
    buffer_load_dwordx4 v[124:127], v1, s[16:19], s49 offen offset:1024 sc1
    v_add_f32_dpp v68, v68, v68 quad_perm:[1,0,3,2] row_mask:0xf bank_mask:0xf
    v_add_f32_dpp v69, v69, v69 quad_perm:[1,0,3,2] row_mask:0xf bank_mask:0xf
    v_add_f32_dpp v70, v70, v70 quad_perm:[1,0,3,2] row_mask:0xf bank_mask:0xf
    s_waitcnt lgkmcnt(4)
    v_mfma_f32_16x16x32_bf16 v[32:35], v[136:139], v[228:231], v[32:35]
    ds_read_b128 v[96:99], v14 offset:20480
    v_add_f32_dpp v71, v71, v71 quad_perm:[1,0,3,2] row_mask:0xf bank_mask:0xf
    v_mfma_f32_16x16x32_bf16 v[36:39], v[136:139], v[232:235], v[36:39]
    v_add_f32_dpp v64, v64, v64 quad_perm:[2,3,0,1] row_mask:0xf bank_mask:0xf
    ds_read_b128 v[100:103], v14 offset:21504
    v_mfma_f32_16x16x32_bf16 v[40:43], v[136:139], v[236:239], v[40:43]
    v_add_f32_dpp v65, v65, v65 quad_perm:[2,3,0,1] row_mask:0xf bank_mask:0xf
    v_add_f32_dpp v66, v66, v66 quad_perm:[2,3,0,1] row_mask:0xf bank_mask:0xf
    v_mfma_f32_16x16x32_bf16 v[44:47], v[136:139], v[240:243], v[44:47]
    ds_read_b128 v[104:107], v14 offset:22528
    v_add_f32_dpp v67, v67, v67 quad_perm:[2,3,0,1] row_mask:0xf bank_mask:0xf
    v_mfma_f32_16x16x32_bf16 v[48:51], v[140:143], v[228:231], v[48:51]
    v_add_f32_dpp v68, v68, v68 quad_perm:[2,3,0,1] row_mask:0xf bank_mask:0xf
    ds_read_b128 v[108:111], v14 offset:23552
    v_mfma_f32_16x16x32_bf16 v[52:55], v[140:143], v[232:235], v[52:55]
    v_add_f32_dpp v69, v69, v69 quad_perm:[2,3,0,1] row_mask:0xf bank_mask:0xf
    v_add_f32_dpp v70, v70, v70 quad_perm:[2,3,0,1] row_mask:0xf bank_mask:0xf
    v_mfma_f32_16x16x32_bf16 v[56:59], v[140:143], v[236:239], v[56:59]
    s_add_u32 m0, s52, 73728
    s_add_u32 s61, s63, 18432
    buffer_load_dwordx4 v1, s[16:19], s61 offen sc1 lds
    v_mfma_f32_16x16x32_bf16 v[60:63], v[140:143], v[240:243], v[60:63]
    s_add_u32 m0, s52, 77824
    s_add_u32 s61, s63, 19456
    buffer_load_dwordx4 v1, s[16:19], s61 offen sc1 lds
    s_waitcnt vmcnt(12) lgkmcnt(4)
    v_mfma_f32_16x16x32_bf16 v[32:35], v[144:147], v[80:83], v[32:35]
    ds_read_b128 v[212:215], v14 offset:24576
    s_add_u32 s48, s6, 0
    v_mfma_f32_16x16x32_bf16 v[36:39], v[144:147], v[84:87], v[36:39]
    v_add_f32_dpp v71, v71, v71 quad_perm:[2,3,0,1] row_mask:0xf bank_mask:0xf
    v_add_f32_dpp v64, v64, v64 row_half_mirror row_mask:0xf bank_mask:0xf
    v_mfma_f32_16x16x32_bf16 v[40:43], v[144:147], v[88:91], v[40:43]
    s_cmp_ge_u32 s48, 10
    s_cselect_b32 s51, 10, 0
    v_mfma_f32_16x16x32_bf16 v[44:47], v[144:147], v[92:95], v[44:47]
    ds_read_b128 v[216:219], v14 offset:25600
    s_sub_u32 s48, s48, s51
    v_mfma_f32_16x16x32_bf16 v[48:51], v[148:151], v[80:83], v[48:51]
    v_add_f32_dpp v65, v65, v65 row_half_mirror row_mask:0xf bank_mask:0xf
    s_lshl_b32 s48, s48, 11
    s_add_u32 s48, s48, s58
    v_mfma_f32_16x16x32_bf16 v[52:55], v[148:151], v[84:87], v[52:55]
    v_add_f32_dpp v66, v66, v66 row_half_mirror row_mask:0xf bank_mask:0xf
    s_add_u32 s49, s48, 327680
    v_mfma_f32_16x16x32_bf16 v[56:59], v[148:151], v[88:91], v[56:59]
    ds_read_b128 v[220:223], v14 offset:26624
    buffer_load_dwordx4 v[128:131], v1, s[16:19], s48 offen sc1
    v_mfma_f32_16x16x32_bf16 v[60:63], v[148:151], v[92:95], v[60:63]
    v_add_f32_dpp v67, v67, v67 row_half_mirror row_mask:0xf bank_mask:0xf
    buffer_load_dwordx4 v[132:135], v1, s[16:19], s49 offen sc1
    ds_read_b128 v[224:227], v14 offset:27648
    buffer_load_dwordx4 v[136:139], v1, s[16:19], s48 offen offset:1024 sc1
    buffer_load_dwordx4 v[140:143], v1, s[16:19], s49 offen offset:1024 sc1
    v_add_f32_dpp v68, v68, v68 row_half_mirror row_mask:0xf bank_mask:0xf
    v_add_f32_dpp v69, v69, v69 row_half_mirror row_mask:0xf bank_mask:0xf
    v_add_f32_dpp v70, v70, v70 row_half_mirror row_mask:0xf bank_mask:0xf
    s_waitcnt lgkmcnt(4)
    v_mfma_f32_16x16x32_bf16 v[32:35], v[152:155], v[96:99], v[32:35]
    ds_read_b128 v[228:231], v14 offset:28672
    v_add_f32_dpp v71, v71, v71 row_half_mirror row_mask:0xf bank_mask:0xf
    v_mfma_f32_16x16x32_bf16 v[36:39], v[152:155], v[100:103], v[36:39]
    v_mov_b32_dpp v72, v64 row_newbcast:0 row_mask:0xf bank_mask:0xf
    ds_read_b128 v[232:235], v14 offset:29696
    v_mfma_f32_16x16x32_bf16 v[40:43], v[152:155], v[104:107], v[40:43]
    v_mov_b32_dpp v73, v65 row_newbcast:0 row_mask:0xf bank_mask:0xf
    v_mov_b32_dpp v74, v66 row_newbcast:0 row_mask:0xf bank_mask:0xf
    v_mfma_f32_16x16x32_bf16 v[44:47], v[152:155], v[108:111], v[44:47]
    ds_read_b128 v[236:239], v14 offset:30720
    v_mov_b32_dpp v75, v67 row_newbcast:0 row_mask:0xf bank_mask:0xf
    v_mfma_f32_16x16x32_bf16 v[48:51], v[156:159], v[96:99], v[48:51]
    v_mov_b32_dpp v76, v68 row_newbcast:0 row_mask:0xf bank_mask:0xf
    ds_read_b128 v[240:243], v14 offset:31744
    v_mfma_f32_16x16x32_bf16 v[52:55], v[156:159], v[100:103], v[52:55]
    v_mov_b32_dpp v77, v69 row_newbcast:0 row_mask:0xf bank_mask:0xf
    v_mov_b32_dpp v78, v70 row_newbcast:0 row_mask:0xf bank_mask:0xf
    v_mfma_f32_16x16x32_bf16 v[56:59], v[156:159], v[104:107], v[56:59]
    s_add_u32 m0, s53, 8192
    s_add_u32 s61, s62, 2048
    buffer_load_dwordx4 v1, s[16:19], s61 offen sc1 lds
    v_mfma_f32_16x16x32_bf16 v[60:63], v[156:159], v[108:111], v[60:63]
    s_add_u32 m0, s53, 12288
    s_add_u32 s61, s62, 3072
    buffer_load_dwordx4 v1, s[16:19], s61 offen sc1 lds
    s_waitcnt vmcnt(14) lgkmcnt(4)
    v_mfma_f32_16x16x32_bf16 v[32:35], v[160:163], v[212:215], v[32:35]
    ds_read_b128 v[80:83], v14 offset:32768
    s_add_u32 s48, s6, 1
    v_mfma_f32_16x16x32_bf16 v[36:39], v[160:163], v[216:219], v[36:39]
    v_mov_b32_dpp v79, v71 row_newbcast:0 row_mask:0xf bank_mask:0xf
    v_mov_b32_dpp v64, v64 row_newbcast:8 row_mask:0xf bank_mask:0xf
    v_mfma_f32_16x16x32_bf16 v[40:43], v[160:163], v[220:223], v[40:43]
    s_cmp_ge_u32 s48, 10
    s_cselect_b32 s51, 10, 0
    v_mfma_f32_16x16x32_bf16 v[44:47], v[160:163], v[224:227], v[44:47]
    ds_read_b128 v[84:87], v14 offset:33792
    s_sub_u32 s48, s48, s51
    v_mfma_f32_16x16x32_bf16 v[48:51], v[164:167], v[212:215], v[48:51]
    v_mov_b32_dpp v65, v65 row_newbcast:8 row_mask:0xf bank_mask:0xf
    s_lshl_b32 s48, s48, 11
    s_add_u32 s48, s48, s58
    v_mfma_f32_16x16x32_bf16 v[52:55], v[164:167], v[216:219], v[52:55]
    v_mov_b32_dpp v66, v66 row_newbcast:8 row_mask:0xf bank_mask:0xf
    s_add_u32 s49, s48, 327680
    v_mfma_f32_16x16x32_bf16 v[56:59], v[164:167], v[220:223], v[56:59]
    ds_read_b128 v[88:91], v14 offset:34816
    buffer_load_dwordx4 v[144:147], v1, s[16:19], s48 offen sc1
    v_mfma_f32_16x16x32_bf16 v[60:63], v[164:167], v[224:227], v[60:63]
    v_mov_b32_dpp v67, v67 row_newbcast:8 row_mask:0xf bank_mask:0xf
    buffer_load_dwordx4 v[148:151], v1, s[16:19], s49 offen sc1
    ds_read_b128 v[92:95], v14 offset:35840
    buffer_load_dwordx4 v[152:155], v1, s[16:19], s48 offen offset:1024 sc1
    buffer_load_dwordx4 v[156:159], v1, s[16:19], s49 offen offset:1024 sc1
    v_mov_b32_dpp v68, v68 row_newbcast:8 row_mask:0xf bank_mask:0xf
    v_mov_b32_dpp v69, v69 row_newbcast:8 row_mask:0xf bank_mask:0xf
    v_mov_b32_dpp v70, v70 row_newbcast:8 row_mask:0xf bank_mask:0xf
    s_waitcnt lgkmcnt(4)
    v_mfma_f32_16x16x32_bf16 v[32:35], v[168:171], v[228:231], v[32:35]
    ds_read_b128 v[96:99], v14 offset:36864
    v_mov_b32_dpp v71, v71 row_newbcast:8 row_mask:0xf bank_mask:0xf
    v_mfma_f32_16x16x32_bf16 v[36:39], v[168:171], v[232:235], v[36:39]
    s_mov_b32 s50, 0x3acccccd
    ds_read_b128 v[100:103], v14 offset:37888
    v_mfma_f32_16x16x32_bf16 v[40:43], v[168:171], v[236:239], v[40:43]
    v_mov_b32 v25, 0x3727c5ac
    v_mul_f32 v72, s50, v72
    v_mfma_f32_16x16x32_bf16 v[44:47], v[168:171], v[240:243], v[44:47]
    ds_read_b128 v[104:107], v14 offset:38912
    v_mul_f32 v73, s50, v73
    v_mfma_f32_16x16x32_bf16 v[48:51], v[172:175], v[228:231], v[48:51]
    v_mul_f32 v74, s50, v74
    ds_read_b128 v[108:111], v14 offset:39936
    v_mfma_f32_16x16x32_bf16 v[52:55], v[172:175], v[232:235], v[52:55]
    v_mul_f32 v75, s50, v75
    v_mul_f32 v76, s50, v76
    v_mfma_f32_16x16x32_bf16 v[56:59], v[172:175], v[236:239], v[56:59]
    s_add_u32 m0, s52, 65536
    s_add_u32 s61, s63, 16384
    buffer_load_dwordx4 v1, s[16:19], s61 offen sc1 lds
    v_mfma_f32_16x16x32_bf16 v[60:63], v[172:175], v[240:243], v[60:63]
    s_add_u32 m0, s52, 69632
    s_add_u32 s61, s63, 17408
    buffer_load_dwordx4 v1, s[16:19], s61 offen sc1 lds
    s_waitcnt vmcnt(14) lgkmcnt(4)
    v_mfma_f32_16x16x32_bf16 v[32:35], v[112:115], v[80:83], v[32:35]
    ds_read_b128 v[212:215], v14 offset:0
    s_add_u32 s48, s6, 2
    v_mfma_f32_16x16x32_bf16 v[36:39], v[112:115], v[84:87], v[36:39]
    v_mul_f32 v77, s50, v77
    v_mul_f32 v78, s50, v78
    v_mfma_f32_16x16x32_bf16 v[40:43], v[112:115], v[88:91], v[40:43]
    s_cmp_ge_u32 s48, 10
    s_cselect_b32 s51, 10, 0
    v_mfma_f32_16x16x32_bf16 v[44:47], v[112:115], v[92:95], v[44:47]
    ds_read_b128 v[216:219], v14 offset:1024
    s_sub_u32 s48, s48, s51
    v_mfma_f32_16x16x32_bf16 v[48:51], v[116:119], v[80:83], v[48:51]
    s_lshl_b32 s48, s48, 11
    v_mul_f32 v79, s50, v79
    s_add_u32 s48, s48, s58
    v_mfma_f32_16x16x32_bf16 v[52:55], v[116:119], v[84:87], v[52:55]
    s_add_u32 s49, s48, 327680
    ds_read_b128 v[220:223], v14 offset:2048
    v_mfma_f32_16x16x32_bf16 v[56:59], v[116:119], v[88:91], v[56:59]
    v_fma_f32 v72, -v72, v72, v25
    buffer_load_dwordx4 v[160:163], v1, s[16:19], s48 offen sc1
    v_mfma_f32_16x16x32_bf16 v[60:63], v[116:119], v[92:95], v[60:63]
    v_fma_f32 v73, -v73, v73, v25
    buffer_load_dwordx4 v[164:167], v1, s[16:19], s49 offen sc1
    ds_read_b128 v[224:227], v14 offset:3072
    buffer_load_dwordx4 v[168:171], v1, s[16:19], s48 offen offset:1024 sc1
    buffer_load_dwordx4 v[172:175], v1, s[16:19], s49 offen offset:1024 sc1
    v_fma_f32 v74, -v74, v74, v25
    v_fma_f32 v75, -v75, v75, v25
    s_waitcnt lgkmcnt(4)
    v_mfma_f32_16x16x32_bf16 v[32:35], v[120:123], v[96:99], v[32:35]
    ds_read_b128 v[228:231], v14 offset:4096
    v_fma_f32 v76, -v76, v76, v25
    v_mfma_f32_16x16x32_bf16 v[36:39], v[120:123], v[100:103], v[36:39]
    v_fma_f32 v77, -v77, v77, v25
    ds_read_b128 v[232:235], v14 offset:5120
    v_mfma_f32_16x16x32_bf16 v[40:43], v[120:123], v[104:107], v[40:43]
    v_fma_f32 v78, -v78, v78, v25
    v_fma_f32 v79, -v79, v79, v25
    v_mfma_f32_16x16x32_bf16 v[44:47], v[120:123], v[108:111], v[44:47]
    ds_read_b128 v[236:239], v14 offset:6144
    v_fma_f32 v64, v64, s50, v72
    v_mfma_f32_16x16x32_bf16 v[48:51], v[124:127], v[96:99], v[48:51]
    ds_read_b128 v[240:243], v14 offset:7168
    v_fma_f32 v65, v65, s50, v73
    v_mfma_f32_16x16x32_bf16 v[52:55], v[124:127], v[100:103], v[52:55]
    v_fma_f32 v66, v66, s50, v74
    v_mfma_f32_16x16x32_bf16 v[56:59], v[124:127], v[104:107], v[56:59]
    s_add_u32 m0, s53, 16384
    s_add_u32 s61, s62, 4096
    buffer_load_dwordx4 v1, s[16:19], s61 offen sc1 lds
    v_xor_b32 v32, v15, v32
    v_xor_b32 v33, v15, v33
    v_xor_b32 v34, v15, v34
    v_xor_b32 v35, v15, v35
    v_xor_b32 v36, v15, v36
    v_mfma_f32_16x16x32_bf16 v[60:63], v[124:127], v[108:111], v[60:63]
    v_xor_b32 v37, v15, v37
    v_xor_b32 v38, v15, v38
    v_xor_b32 v39, v15, v39
    v_xor_b32 v40, v15, v40
    v_xor_b32 v41, v15, v41
    v_xor_b32 v42, v15, v42
    v_xor_b32 v43, v15, v43
    v_xor_b32 v44, v15, v44
    v_xor_b32 v45, v15, v45
    v_xor_b32 v46, v15, v46
    v_xor_b32 v47, v15, v47
    s_add_u32 m0, s53, 20480
    s_add_u32 s61, s62, 5120
    buffer_load_dwordx4 v1, s[16:19], s61 offen sc1 lds
    s_waitcnt vmcnt(14) lgkmcnt(4)
    v_mfma_f32_16x16x32_bf16 v[32:35], v[128:131], v[212:215], v[32:35]
    ds_read_b128 v[80:83], v14 offset:8192
    s_add_u32 s48, s6, 3
    v_mfma_f32_16x16x32_bf16 v[36:39], v[128:131], v[216:219], v[36:39]
    v_xor_b32 v48, v15, v48
    v_xor_b32 v49, v15, v49
    v_mfma_f32_16x16x32_bf16 v[40:43], v[128:131], v[220:223], v[40:43]
    v_xor_b32 v50, v15, v50
    v_xor_b32 v51, v15, v51
    v_xor_b32 v52, v15, v52
    v_xor_b32 v53, v15, v53
    v_xor_b32 v54, v15, v54
    v_mfma_f32_16x16x32_bf16 v[44:47], v[128:131], v[224:227], v[44:47]
    s_cmp_ge_u32 s48, 10
    s_cselect_b32 s51, 10, 0
    s_sub_u32 s48, s48, s51
    v_xor_b32 v55, v15, v55
    v_xor_b32 v56, v15, v56
    v_xor_b32 v57, v15, v57
    v_xor_b32 v58, v15, v58
    v_xor_b32 v59, v15, v59
    v_xor_b32 v60, v15, v60
    v_xor_b32 v61, v15, v61
    v_xor_b32 v62, v15, v62
    v_xor_b32 v63, v15, v63
    v_mfma_f32_16x16x32_bf16 v[48:51], v[132:135], v[212:215], v[48:51]
    v_fma_f32 v67, v67, s50, v75
    v_fma_f32 v68, v68, s50, v76
    s_lshl_b32 s48, s48, 11
    s_add_u32 s48, s48, s58
    v_mfma_f32_16x16x32_bf16 v[52:55], v[132:135], v[216:219], v[52:55]
    ds_read_b128 v[84:87], v14 offset:9216
    v_fma_f32 v69, v69, s50, v77
    s_add_u32 s49, s48, 327680
    v_mfma_f32_16x16x32_bf16 v[56:59], v[132:135], v[220:223], v[56:59]
    ds_read_b128 v[88:91], v14 offset:10240
    v_fma_f32 v70, v70, s50, v78
    buffer_load_dwordx4 v[112:115], v1, s[16:19], s48 offen sc1
    v_mfma_f32_16x16x32_bf16 v[60:63], v[132:135], v[224:227], v[60:63]
    v_fma_f32 v71, v71, s50, v79
    buffer_load_dwordx4 v[116:119], v1, s[16:19], s49 offen sc1
    ds_read_b128 v[92:95], v14 offset:11264
    buffer_load_dwordx4 v[120:123], v1, s[16:19], s48 offen offset:1024 sc1
    buffer_load_dwordx4 v[124:127], v1, s[16:19], s49 offen offset:1024 sc1
    v_max_f32 v64, v25, v64
    v_max_f32 v65, v25, v65
    s_waitcnt lgkmcnt(4)
    v_mfma_f32_16x16x32_bf16 v[32:35], v[136:139], v[228:231], v[32:35]
    ds_read_b128 v[96:99], v14 offset:12288
    v_max_f32 v66, v25, v66
    v_mfma_f32_16x16x32_bf16 v[36:39], v[136:139], v[232:235], v[36:39]
    v_max_f32 v67, v25, v67
    ds_read_b128 v[100:103], v14 offset:13312
    v_mfma_f32_16x16x32_bf16 v[40:43], v[136:139], v[236:239], v[40:43]
    v_max_f32 v68, v25, v68
    v_max_f32 v69, v25, v69
    v_mfma_f32_16x16x32_bf16 v[44:47], v[136:139], v[240:243], v[44:47]
    ds_read_b128 v[104:107], v14 offset:14336
    v_max_f32 v70, v25, v70
    v_mfma_f32_16x16x32_bf16 v[48:51], v[140:143], v[228:231], v[48:51]
    v_max_f32 v71, v25, v71
    ds_read_b128 v[108:111], v14 offset:15360
    v_mfma_f32_16x16x32_bf16 v[52:55], v[140:143], v[232:235], v[52:55]
    v_rsq_f32 v64, v64
    v_mfma_f32_16x16x32_bf16 v[56:59], v[140:143], v[236:239], v[56:59]
    s_add_u32 m0, s52, 57344
    s_add_u32 s61, s63, 14336
    buffer_load_dwordx4 v1, s[16:19], s61 offen sc1 lds
    v_mfma_f32_16x16x32_bf16 v[60:63], v[140:143], v[240:243], v[60:63]
    s_add_u32 m0, s52, 61440
    s_add_u32 s61, s63, 15360
    buffer_load_dwordx4 v1, s[16:19], s61 offen sc1 lds
    s_waitcnt vmcnt(14) lgkmcnt(4)
    v_mfma_f32_16x16x32_bf16 v[32:35], v[144:147], v[80:83], v[32:35]
    ds_read_b128 v[212:215], v14 offset:16384
    s_add_u32 s48, s6, 4
    v_mfma_f32_16x16x32_bf16 v[36:39], v[144:147], v[84:87], v[36:39]
    v_rsq_f32 v65, v65
    v_mfma_f32_16x16x32_bf16 v[40:43], v[144:147], v[88:91], v[40:43]
    s_cmp_ge_u32 s48, 10
    s_cselect_b32 s51, 10, 0
    v_mfma_f32_16x16x32_bf16 v[44:47], v[144:147], v[92:95], v[44:47]
    v_rsq_f32 v66, v66
    s_sub_u32 s48, s48, s51
    v_mfma_f32_16x16x32_bf16 v[48:51], v[148:151], v[80:83], v[48:51]
    ds_read_b128 v[216:219], v14 offset:17408
    s_lshl_b32 s48, s48, 11
    s_add_u32 s48, s48, s58
    v_mfma_f32_16x16x32_bf16 v[52:55], v[148:151], v[84:87], v[52:55]
    v_rsq_f32 v67, v67
    s_add_u32 s49, s48, 327680
    v_mfma_f32_16x16x32_bf16 v[56:59], v[148:151], v[88:91], v[56:59]
    ds_read_b128 v[220:223], v14 offset:18432
    v_rsq_f32 v68, v68
    buffer_load_dwordx4 v[128:131], v1, s[16:19], s48 offen sc1
    v_mfma_f32_16x16x32_bf16 v[60:63], v[148:151], v[92:95], v[60:63]
    v_rsq_f32 v69, v69
    buffer_load_dwordx4 v[132:135], v1, s[16:19], s49 offen sc1
    ds_read_b128 v[224:227], v14 offset:19456
    buffer_load_dwordx4 v[136:139], v1, s[16:19], s48 offen offset:1024 sc1
    buffer_load_dwordx4 v[140:143], v1, s[16:19], s49 offen offset:1024 sc1
    v_rsq_f32 v70, v70
    v_rsq_f32 v71, v71
    s_waitcnt lgkmcnt(4)
    v_mfma_f32_16x16x32_bf16 v[32:35], v[152:155], v[96:99], v[32:35]
    ds_read_b128 v[228:231], v14 offset:20480
    v_mul_f32 v72, v184, v64
    v_mfma_f32_16x16x32_bf16 v[36:39], v[152:155], v[100:103], v[36:39]
    v_mul_f32 v73, v185, v65
    ds_read_b128 v[232:235], v14 offset:21504
    v_mfma_f32_16x16x32_bf16 v[40:43], v[152:155], v[104:107], v[40:43]
    v_mul_f32 v74, v186, v66
    v_mul_f32 v75, v187, v67
    v_mfma_f32_16x16x32_bf16 v[44:47], v[152:155], v[108:111], v[44:47]
    ds_read_b128 v[236:239], v14 offset:22528
    v_mul_f32 v76, v188, v64
    v_mfma_f32_16x16x32_bf16 v[48:51], v[156:159], v[96:99], v[48:51]
    ds_read_b128 v[240:243], v14 offset:23552
    v_mul_f32 v77, v189, v65
    v_mfma_f32_16x16x32_bf16 v[52:55], v[156:159], v[100:103], v[52:55]
    v_mul_f32 v78, v190, v66
    v_mfma_f32_16x16x32_bf16 v[56:59], v[156:159], v[104:107], v[56:59]
    s_add_u32 m0, s53, 24576
    s_add_u32 s61, s62, 6144
    buffer_load_dwordx4 v1, s[16:19], s61 offen sc1 lds
    v_mfma_f32_16x16x32_bf16 v[60:63], v[156:159], v[108:111], v[60:63]
    s_add_u32 m0, s53, 28672
    s_add_u32 s61, s62, 7168
    buffer_load_dwordx4 v1, s[16:19], s61 offen sc1 lds
    s_waitcnt vmcnt(14) lgkmcnt(4)
    v_mfma_f32_16x16x32_bf16 v[32:35], v[160:163], v[212:215], v[32:35]
    ds_read_b128 v[80:83], v14 offset:24576
    v_mul_f32 v79, v191, v67
    v_mfma_f32_16x16x32_bf16 v[36:39], v[160:163], v[216:219], v[36:39]
    v_cvt_pk_bf16_f32 v200, -v76, -v77
    ds_read_b128 v[84:87], v14 offset:25600
    v_mfma_f32_16x16x32_bf16 v[40:43], v[160:163], v[220:223], v[40:43]
    v_cvt_pk_bf16_f32 v201, -v78, -v79
    v_cvt_pk_bf16_f32 v202, v72, v73
    v_mfma_f32_16x16x32_bf16 v[44:47], v[160:163], v[224:227], v[44:47]
    ds_read_b128 v[88:91], v14 offset:26624
    v_cvt_pk_bf16_f32 v203, v74, v75
    v_mfma_f32_16x16x32_bf16 v[48:51], v[164:167], v[212:215], v[48:51]
    ds_read_b128 v[92:95], v14 offset:27648
    v_cvt_pk_bf16_f32 v204, v76, v77
    v_mfma_f32_16x16x32_bf16 v[52:55], v[164:167], v[216:219], v[52:55]
    v_cvt_pk_bf16_f32 v205, v78, v79
    v_mfma_f32_16x16x32_bf16 v[56:59], v[164:167], v[220:223], v[56:59]
    s_add_u32 m0, s52, 49152
    s_add_u32 s61, s63, 12288
    buffer_load_dwordx4 v1, s[16:19], s61 offen sc1 lds
    v_mfma_f32_16x16x32_bf16 v[60:63], v[164:167], v[224:227], v[60:63]
    s_add_u32 m0, s52, 53248
    s_add_u32 s61, s63, 13312
    buffer_load_dwordx4 v1, s[16:19], s61 offen sc1 lds
    s_waitcnt lgkmcnt(4)
    v_mfma_f32_16x16x32_bf16 v[32:35], v[168:171], v[228:231], v[32:35]
    ds_read_b128 v[96:99], v14 offset:28672
    v_mul_f32 v72, v184, v68
    v_mfma_f32_16x16x32_bf16 v[36:39], v[168:171], v[232:235], v[36:39]
    v_mul_f32 v73, v185, v69
    ds_read_b128 v[100:103], v14 offset:29696
    v_mfma_f32_16x16x32_bf16 v[40:43], v[168:171], v[236:239], v[40:43]
    v_mul_f32 v74, v186, v70
    v_mul_f32 v75, v187, v71
    v_mfma_f32_16x16x32_bf16 v[44:47], v[168:171], v[240:243], v[44:47]
    ds_read_b128 v[104:107], v14 offset:30720
    v_mul_f32 v76, v188, v68
    v_mfma_f32_16x16x32_bf16 v[48:51], v[172:175], v[228:231], v[48:51]
    ds_read_b128 v[108:111], v14 offset:31744
    v_mul_f32 v77, v189, v69
    v_mfma_f32_16x16x32_bf16 v[52:55], v[172:175], v[232:235], v[52:55]
    v_mul_f32 v78, v190, v70
    v_mfma_f32_16x16x32_bf16 v[56:59], v[172:175], v[236:239], v[56:59]
    s_add_u32 m0, s53, 32768
    s_add_u32 s61, s62, 8192
    buffer_load_dwordx4 v1, s[16:19], s61 offen sc1 lds
    v_mfma_f32_16x16x32_bf16 v[60:63], v[172:175], v[240:243], v[60:63]
    s_add_u32 m0, s53, 36864
    s_add_u32 s61, s62, 9216
    buffer_load_dwordx4 v1, s[16:19], s61 offen sc1 lds
    s_waitcnt vmcnt(12) lgkmcnt(4)
    v_mfma_f32_16x16x32_bf16 v[32:35], v[112:115], v[80:83], v[32:35]
    ds_read_b128 v[212:215], v14 offset:32768
    v_mul_f32 v79, v191, v71
    v_mfma_f32_16x16x32_bf16 v[36:39], v[112:115], v[84:87], v[36:39]
    v_cvt_pk_bf16_f32 v206, -v76, -v77
    ds_read_b128 v[216:219], v14 offset:33792
    v_mfma_f32_16x16x32_bf16 v[40:43], v[112:115], v[88:91], v[40:43]
    v_cvt_pk_bf16_f32 v207, -v78, -v79
    v_cvt_pk_bf16_f32 v208, v72, v73
    v_mfma_f32_16x16x32_bf16 v[44:47], v[112:115], v[92:95], v[44:47]
    ds_read_b128 v[220:223], v14 offset:34816
    v_cvt_pk_bf16_f32 v209, v74, v75
    v_mfma_f32_16x16x32_bf16 v[48:51], v[116:119], v[80:83], v[48:51]
    ds_read_b128 v[224:227], v14 offset:35840
    v_cvt_pk_bf16_f32 v210, v76, v77
    v_mfma_f32_16x16x32_bf16 v[52:55], v[116:119], v[84:87], v[52:55]
    v_cvt_pk_bf16_f32 v211, v78, v79
    v_mfma_f32_16x16x32_bf16 v[56:59], v[116:119], v[88:91], v[56:59]
    s_add_u32 m0, s52, 40960
    s_add_u32 s61, s63, 10240
    buffer_load_dwordx4 v1, s[16:19], s61 offen sc1 lds
    v_mfma_f32_16x16x32_bf16 v[60:63], v[116:119], v[92:95], v[60:63]
    s_add_u32 m0, s52, 45056
    s_add_u32 s61, s63, 11264
    buffer_load_dwordx4 v1, s[16:19], s61 offen sc1 lds
    s_waitcnt lgkmcnt(4)
    v_mfma_f32_16x16x32_bf16 v[32:35], v[120:123], v[96:99], v[32:35]
    ds_read_b128 v[228:231], v14 offset:36864
    v_and_b32 v24, 48, v0
    v_mfma_f32_16x16x32_bf16 v[36:39], v[120:123], v[100:103], v[36:39]
    v_lshl_add_u32 v24, v3, 2, v24
    v_lshlrev_b32 v24, 2, v24
    s_mov_b32 s50, 0x3acccccd
    v_mov_b32 v25, 0x3727c5ac
    v_mfma_f32_16x16x32_bf16 v[40:43], v[120:123], v[104:107], v[40:43]
    s_lshl_b32 s49, s3, 8
    s_add_u32 s49, s49, 126976
    v_lshlrev_b32 v26, 10, v3
    v_lshl_add_u32 v26, v2, 4, v26
    v_add_u32 v26, s49, v26
    v_mfma_f32_16x16x32_bf16 v[44:47], v[120:123], v[108:111], v[44:47]
    ds_read_b128 v[232:235], v14 offset:37888
    s_lshl_b32 s49, s3, 10
    s_add_u32 s49, s49, 126976
    v_add_u32 v27, s49, v1
    s_lshl_b32 s49, s3, 12
    v_mfma_f32_16x16x32_bf16 v[48:51], v[124:127], v[96:99], v[48:51]
    s_add_u32 s49, s49, 143360
    v_lshlrev_b32 v28, 8, v3
    v_lshl_add_u32 v28, v2, 2, v28
    v_add_u32 v28, s49, v28
    v_mfma_f32_16x16x32_bf16 v[52:55], v[124:127], v[100:103], v[52:55]
    ds_read_b128 v[236:239], v14 offset:38912
    v_add_u32 v29, s49, v1
    v_lshrrev_b32 v30, 3, v0
    v_and_b32 v31, 7, v0
    v_mul_u32_u24 v30, 327680, v30
    v_lshl_add_u32 v31, v31, 4, v30
    v_mfma_f32_16x16x32_bf16 v[56:59], v[124:127], v[104:107], v[56:59]
    ds_read_b128 v[240:243], v14 offset:39936
    s_mul_i32 s48, s32, 1280
    s_lshl_b32 s49, s33, 7
    s_add_u32 s48, s48, s49
    s_mul_i32 s49, s3, 81920
    v_mfma_f32_16x16x32_bf16 v[60:63], v[124:127], v[108:111], v[60:63]
    s_add_u32 s48, s48, s49
    s_add_u32 s48, s48, 7864320
    s_add_u32 s55, s47, 5
    v_mov_b32 v250, s55
    v_mov_b32 v251, s46
    v_lshlrev_b32 v252, 25, v0
    buffer_store_dwordx2 v[250:251], v252, s[16:19], s40 offen sc0 sc1
    s_waitcnt vmcnt(9) lgkmcnt(0)
    v_mfma_f32_16x16x32_bf16 v[32:35], v[128:131], v[212:215], v[32:35]
    v_mfma_f32_16x16x32_bf16 v[48:51], v[132:135], v[212:215], v[48:51]
    v_mfma_f32_16x16x32_bf16 v[32:35], v[136:139], v[228:231], v[32:35]
    v_mfma_f32_16x16x32_bf16 v[48:51], v[140:143], v[228:231], v[48:51]
    v_mfma_f32_16x16x32_bf16 v[40:43], v[128:131], v[220:223], v[40:43]
    v_mfma_f32_16x16x32_bf16 v[56:59], v[132:135], v[220:223], v[56:59]
    v_mfma_f32_16x16x32_bf16 v[40:43], v[136:139], v[236:239], v[40:43]
    v_mfma_f32_16x16x32_bf16 v[56:59], v[140:143], v[236:239], v[56:59]
    v_mfma_f32_16x16x32_bf16 v[36:39], v[128:131], v[216:219], v[36:39]
    v_mfma_f32_16x16x32_bf16 v[52:55], v[132:135], v[216:219], v[52:55]
    v_mfma_f32_16x16x32_bf16 v[36:39], v[136:139], v[232:235], v[36:39]
    v_mfma_f32_16x16x32_bf16 v[52:55], v[140:143], v[232:235], v[52:55]
    v_mfma_f32_16x16x32_bf16 v[44:47], v[128:131], v[224:227], v[44:47]
    v_mfma_f32_16x16x32_bf16 v[60:63], v[132:135], v[224:227], v[60:63]
    v_mfma_f32_16x16x32_bf16 v[44:47], v[136:139], v[240:243], v[44:47]
    v_mfma_f32_16x16x32_bf16 v[60:63], v[140:143], v[240:243], v[60:63]
    v_cvt_pk_bf16_f32 v112, v32, v33
    v_cvt_pk_bf16_f32 v113, v34, v35
    v_cvt_pk_bf16_f32 v114, v40, v41
    v_cvt_pk_bf16_f32 v115, v42, v43
    v_cvt_pk_bf16_f32 v116, v48, v49
    v_cvt_pk_bf16_f32 v117, v50, v51
    v_cvt_pk_bf16_f32 v118, v56, v57
    v_cvt_pk_bf16_f32 v119, v58, v59
    v_mfma_f32_16x16x32_bf16 v[128:131], v[202:205], v[112:115], 0
    v_mfma_f32_16x16x32_bf16 v[132:135], v[200:203], v[112:115], 0
    v_mfma_f32_16x16x32_bf16 v[136:139], v[208:211], v[116:119], 0
    v_mfma_f32_16x16x32_bf16 v[140:143], v[206:209], v[116:119], 0
    v_cvt_pk_bf16_f32 v120, v36, v37
    v_cvt_pk_bf16_f32 v121, v38, v39
    v_cvt_pk_bf16_f32 v122, v44, v45
    v_cvt_pk_bf16_f32 v123, v46, v47
    v_cvt_pk_bf16_f32 v124, v52, v53
    v_cvt_pk_bf16_f32 v125, v54, v55
    v_cvt_pk_bf16_f32 v126, v60, v61
    v_cvt_pk_bf16_f32 v127, v62, v63
    v_mfma_f32_16x16x32_bf16 v[144:147], v[202:205], v[120:123], 0
    v_mfma_f32_16x16x32_bf16 v[148:151], v[200:203], v[120:123], 0
    v_mfma_f32_16x16x32_bf16 v[152:155], v[208:211], v[124:127], 0
    v_mfma_f32_16x16x32_bf16 v[156:159], v[206:209], v[124:127], 0
    v_cvt_pk_bf16_f32 v80, v128, v132
    v_cvt_pk_bf16_f32 v81, v136, v140
    v_cvt_pk_bf16_f32 v82, v129, v133
    v_cvt_pk_bf16_f32 v83, v137, v141
    ds_write_b128 v26, v[80:83] offset:0
    v_cvt_pk_bf16_f32 v84, v130, v134
    v_cvt_pk_bf16_f32 v85, v138, v142
    v_cvt_pk_bf16_f32 v86, v131, v135
    v_cvt_pk_bf16_f32 v87, v139, v143
    ds_write_b128 v26, v[84:87] offset:4096
    v_cvt_pk_bf16_f32 v88, v144, v148
    v_cvt_pk_bf16_f32 v89, v152, v156
    v_cvt_pk_bf16_f32 v90, v145, v149
    v_cvt_pk_bf16_f32 v91, v153, v157
    ds_write_b128 v26, v[88:91] offset:8192
    v_cvt_pk_bf16_f32 v92, v146, v150
    v_cvt_pk_bf16_f32 v93, v154, v158
    v_cvt_pk_bf16_f32 v94, v147, v151
    v_cvt_pk_bf16_f32 v95, v155, v159
    ds_write_b128 v26, v[92:95] offset:12288
    s_waitcnt lgkmcnt(0)
    s_barrier
    ds_read_b128 v[96:99], v27 offset:0
    ds_read_b128 v[104:107], v27 offset:8192
    ds_read_b128 v[100:103], v27 offset:4096
    ds_read_b128 v[108:111], v27 offset:12288
    s_waitcnt lgkmcnt(3)
    v_mfma_f32_16x16x16_bf16 v[32:35], v[192:193], v[96:97], 0
    v_mfma_f32_16x16x16_bf16 v[40:43], v[194:195], v[98:99], 0
    s_waitcnt lgkmcnt(2)
    v_mfma_f32_16x16x16_bf16 v[36:39], v[192:193], v[104:105], 0
    v_mfma_f32_16x16x16_bf16 v[44:47], v[194:195], v[106:107], 0
    s_waitcnt lgkmcnt(1)
    v_mfma_f32_16x16x16_bf16 v[48:51], v[196:197], v[100:101], 0
    v_mfma_f32_16x16x16_bf16 v[56:59], v[198:199], v[102:103], 0
    s_waitcnt lgkmcnt(0)
    v_mfma_f32_16x16x16_bf16 v[52:55], v[196:197], v[108:109], 0
    v_mfma_f32_16x16x16_bf16 v[60:63], v[198:199], v[110:111], 0
    v_cvt_pk_bf16_f32 v64, v32, v33
    v_cvt_pk_bf16_f32 v65, v34, v35
    ds_write2_b32 v28, v64, v65 offset0:0 offset1:32
    v_cvt_pk_bf16_f32 v66, v36, v37
    v_cvt_pk_bf16_f32 v67, v38, v39
    ds_write2_b32 v28, v66, v67 offset0:16 offset1:48
    v_add_u32 v28, 1024, v28
    v_cvt_pk_bf16_f32 v68, v40, v41
    v_cvt_pk_bf16_f32 v69, v42, v43
    ds_write2_b32 v28, v68, v69 offset0:0 offset1:32
    v_cvt_pk_bf16_f32 v70, v44, v45
    v_cvt_pk_bf16_f32 v71, v46, v47
    ds_write2_b32 v28, v70, v71 offset0:16 offset1:48
    v_add_u32 v28, 1024, v28
    v_cvt_pk_bf16_f32 v72, v48, v49
    v_cvt_pk_bf16_f32 v73, v50, v51
    ds_write2_b32 v28, v72, v73 offset0:0 offset1:32
    v_cvt_pk_bf16_f32 v74, v52, v53
    v_cvt_pk_bf16_f32 v75, v54, v55
    ds_write2_b32 v28, v74, v75 offset0:16 offset1:48
    v_add_u32 v28, 1024, v28
    v_cvt_pk_bf16_f32 v76, v56, v57
    v_cvt_pk_bf16_f32 v77, v58, v59
    ds_write2_b32 v28, v76, v77 offset0:0 offset1:32
    v_cvt_pk_bf16_f32 v78, v60, v61
    v_cvt_pk_bf16_f32 v79, v62, v63
    ds_write2_b32 v28, v78, v79 offset0:16 offset1:48
    s_waitcnt lgkmcnt(6)
    ds_read_b128 v[112:115], v29 offset:0
    s_waitcnt lgkmcnt(5)
    ds_read_b128 v[116:119], v29 offset:1024
    s_waitcnt lgkmcnt(4)
    ds_read_b128 v[120:123], v29 offset:2048
    s_waitcnt lgkmcnt(3)
    ds_read_b128 v[124:127], v29 offset:3072
    s_waitcnt lgkmcnt(3)
    buffer_store_dwordx4 v[112:115], v31, s[16:19], s48 offen sc1
    s_add_u32 s48, s48, 20480
    s_waitcnt lgkmcnt(2)
    buffer_store_dwordx4 v[116:119], v31, s[16:19], s48 offen sc1
    s_add_u32 s48, s48, 20480
    s_waitcnt lgkmcnt(1)
    buffer_store_dwordx4 v[120:123], v31, s[16:19], s48 offen sc1
    s_add_u32 s48, s48, 20480
    s_waitcnt lgkmcnt(0)
    buffer_store_dwordx4 v[124:127], v31, s[16:19], s48 offen sc1
    s_bitcmp1_b32 s3, 0
    s_cselect_b32 s48, s37, s36
    s_cselect_b32 s56, s39, s38
    s_bitcmp1_b32 s3, 1
    s_cselect_b32 s56, s56, s48
    s_xor_b32 s57, s3, 1
    s_lshr_b32 s48, s3, 1
    s_or_b32 s48, s48, s36
    s_cmp_eq_u32 s48, 0
    s_cselect_b32 s57, s3, s57
    v_mul_u32_u24 v4, 5120, v3
    v_lshl_add_u32 v4, v2, 4, v4
    v_xor_b32 v5, 768, v1
    v_and_b32 v7, 3, v2
    v_lshl_add_u32 v7, v3, 2, v7
    v_mul_u32_u24 v7, 1280, v7
    v_lshrrev_b32 v6, 2, v2
    v_add_u32 v6, 1, v6
    v_lshl_add_u32 v6, v6, 8, v7
    v_cvt_f32_u32 v10, v2
    v_mul_f32 v10, 0x3d800000, v10
    s_cmp_eq_u32 s56, 0
    s_cselect_b32 s48, 0x3f800000, 0x3f700000
    v_sub_f32 v11, s48, v10
    v_lshlrev_b32 v12, 2, v3
    v_cvt_f32_u32 v12, v12
    v_add_f32 v13, 0, v12
    v_mul_f32 v14, v13, v10
    v_cos_f32 v15, v14
    v_sin_f32 v14, v14
    s_nop 0
    v_cvt_pk_bf16_f32 v16, v15, v14
    v_mul_f32 v14, v13, v11
    v_cos_f32 v15, v14
    v_sin_f32 v14, v14
    s_nop 0
    v_cvt_pk_bf16_f32 v20, v15, v14
    v_add_f32 v13, 1.0, v12
    v_mul_f32 v14, v13, v10
    v_cos_f32 v15, v14
    v_sin_f32 v14, v14
    s_nop 0
    v_cvt_pk_bf16_f32 v17, v15, v14
    v_mul_f32 v14, v13, v11
    v_cos_f32 v15, v14
    v_sin_f32 v14, v14
    s_nop 0
    v_cvt_pk_bf16_f32 v21, v15, v14
    v_add_f32 v13, 2.0, v12
    v_mul_f32 v14, v13, v10
    v_cos_f32 v15, v14
    v_sin_f32 v14, v14
    s_nop 0
    v_cvt_pk_bf16_f32 v18, v15, v14
    v_mul_f32 v14, v13, v11
    v_cos_f32 v15, v14
    v_sin_f32 v14, v14
    s_nop 0
    v_cvt_pk_bf16_f32 v22, v15, v14
    v_add_f32 v13, 0x40400000, v12
    v_mul_f32 v14, v13, v10
    v_cos_f32 v15, v14
    v_sin_f32 v14, v14
    s_nop 0
    v_cvt_pk_bf16_f32 v19, v15, v14
    v_mul_f32 v14, v13, v11
    v_cos_f32 v15, v14
    v_sin_f32 v14, v14
    s_nop 0
    v_cvt_pk_bf16_f32 v23, v15, v14
    v_cmp_eq_u32 vcc, 0, v2
    s_nop 1
    v_cndmask_b32 v10, -1, 0, vcc
    s_lshl_b32 s48, s3, 10
    v_add_u32 v11, s48, v1
    s_lshl_b32 s48, s57, 10
    s_add_u32 s48, s48, 40960
    v_add_u32 v12, s48, v5
    v_mov_b32 v5, v1
    v_add_u32 v13, 40960, v1
    s_mul_i32 s59, s56, 20480
    s_add_u32 s59, s59, 7864320
    s_branch layer_m_4
nop1_m_6:
    s_bitcmp1_b32 s3, 0
    s_cselect_b32 s53, s37, s36
    s_cselect_b32 s62, s39, s38
    s_bitcmp1_b32 s3, 1
    s_cselect_b32 s62, s62, s53
    s_xor_b32 s52, s3, 1
    s_lshr_b32 s53, s3, 1
    s_or_b32 s53, s53, s36
    s_cmp_eq_u32 s53, 0
    s_cselect_b32 s52, s3, s52
    s_bitcmp1_b32 s52, 0
    s_cselect_b32 s53, s37, s36
    s_cselect_b32 s63, s39, s38
    s_bitcmp1_b32 s52, 1
    s_cselect_b32 s63, s63, s53
    s_mul_i32 s62, s62, 20480
    s_add_u32 s62, s62, 2621440
    s_mul_i32 s63, s63, 20480
    s_add_u32 s63, s63, 2621440
    s_lshl_b32 s53, s3, 10
    s_lshl_b32 s52, s52, 10
    s_add_u32 m0, s53, 0
    s_add_u32 s61, s62, 0
    buffer_load_dwordx4 v1, s[16:19], s61 offen sc1 lds
    s_add_u32 m0, s53, 4096
    s_add_u32 s61, s62, 1024
    buffer_load_dwordx4 v1, s[16:19], s61 offen sc1 lds
    s_add_u32 m0, s52, 73728
    s_add_u32 s61, s63, 18432
    buffer_load_dwordx4 v1, s[16:19], s61 offen sc1 lds
    s_add_u32 m0, s52, 77824
    s_add_u32 s61, s63, 19456
    buffer_load_dwordx4 v1, s[16:19], s61 offen sc1 lds
    s_add_u32 m0, s53, 8192
    s_add_u32 s61, s62, 2048
    buffer_load_dwordx4 v1, s[16:19], s61 offen sc1 lds
    s_add_u32 m0, s53, 12288
    s_add_u32 s61, s62, 3072
    buffer_load_dwordx4 v1, s[16:19], s61 offen sc1 lds
    s_add_u32 m0, s52, 65536
    s_add_u32 s61, s63, 16384
    buffer_load_dwordx4 v1, s[16:19], s61 offen sc1 lds
    s_add_u32 m0, s52, 69632
    s_add_u32 s61, s63, 17408
    buffer_load_dwordx4 v1, s[16:19], s61 offen sc1 lds
    s_add_u32 m0, s53, 16384
    s_add_u32 s61, s62, 4096
    buffer_load_dwordx4 v1, s[16:19], s61 offen sc1 lds
    s_add_u32 m0, s53, 20480
    s_add_u32 s61, s62, 5120
    buffer_load_dwordx4 v1, s[16:19], s61 offen sc1 lds
    s_add_u32 m0, s52, 57344
    s_add_u32 s61, s63, 14336
    buffer_load_dwordx4 v1, s[16:19], s61 offen sc1 lds
    s_add_u32 m0, s52, 61440
    s_add_u32 s61, s63, 15360
    buffer_load_dwordx4 v1, s[16:19], s61 offen sc1 lds
    s_add_u32 m0, s53, 24576
    s_add_u32 s61, s62, 6144
    buffer_load_dwordx4 v1, s[16:19], s61 offen sc1 lds
    s_add_u32 m0, s53, 28672
    s_add_u32 s61, s62, 7168
    buffer_load_dwordx4 v1, s[16:19], s61 offen sc1 lds
    s_add_u32 m0, s52, 49152
    s_add_u32 s61, s63, 12288
    buffer_load_dwordx4 v1, s[16:19], s61 offen sc1 lds
    s_add_u32 m0, s52, 53248
    s_add_u32 s61, s63, 13312
    buffer_load_dwordx4 v1, s[16:19], s61 offen sc1 lds
    s_add_u32 m0, s53, 32768
    s_add_u32 s61, s62, 8192
    buffer_load_dwordx4 v1, s[16:19], s61 offen sc1 lds
    s_add_u32 m0, s53, 36864
    s_add_u32 s61, s62, 9216
    buffer_load_dwordx4 v1, s[16:19], s61 offen sc1 lds
    s_add_u32 m0, s52, 40960
    s_add_u32 s61, s63, 10240
    buffer_load_dwordx4 v1, s[16:19], s61 offen sc1 lds
    s_add_u32 m0, s52, 45056
    s_add_u32 s61, s63, 11264
    buffer_load_dwordx4 v1, s[16:19], s61 offen sc1 lds
    s_sub_u32 s48, s29, 20
    s_lshl_b32 s48, s48, 2
    s_add_u32 s48, s48, s3
    s_mul_i32 s48, s48, 46080
    s_add_u32 s48, s48, 26853376
    buffer_load_dwordx4 v[192:195], v1, s[16:19], s48 offen sc1
    buffer_load_dwordx4 v[196:199], v1, s[16:19], s48 offen offset:1024 sc1
    buffer_load_dwordx4 v[200:203], v1, s[16:19], s48 offen offset:2048 sc1
    buffer_load_dwordx4 v[204:207], v1, s[16:19], s48 offen offset:3072 sc1
    s_add_u32 s48, s48, 4096
    buffer_load_dwordx4 v[208:211], v1, s[16:19], s48 offen sc1
    buffer_load_dwordx4 v[212:215], v1, s[16:19], s48 offen offset:1024 sc1
    buffer_load_dwordx4 v[216:219], v1, s[16:19], s48 offen offset:2048 sc1
    buffer_load_dwordx4 v[220:223], v1, s[16:19], s48 offen offset:3072 sc1
    s_add_u32 s48, s48, 4096
    buffer_load_dwordx4 v[224:227], v1, s[16:19], s48 offen sc1
    buffer_load_dwordx4 v[228:231], v1, s[16:19], s48 offen offset:1024 sc1
    buffer_load_dwordx4 v[232:235], v1, s[16:19], s48 offen offset:2048 sc1
    buffer_load_dwordx4 v[236:239], v1, s[16:19], s48 offen offset:3072 sc1
    s_add_u32 s48, s48, 4096
    buffer_load_dwordx4 v[192:195], v1, s[16:19], s48 offen sc1
    buffer_load_dwordx4 v[196:199], v1, s[16:19], s48 offen offset:1024 sc1
    buffer_load_dwordx4 v[200:203], v1, s[16:19], s48 offen offset:2048 sc1
    buffer_load_dwordx4 v[204:207], v1, s[16:19], s48 offen offset:3072 sc1
    s_add_u32 s48, s48, 4096
    buffer_load_dwordx4 v[208:211], v1, s[16:19], s48 offen sc1
    buffer_load_dwordx4 v[212:215], v1, s[16:19], s48 offen offset:1024 sc1
    buffer_load_dwordx4 v[216:219], v1, s[16:19], s48 offen offset:2048 sc1
    buffer_load_dwordx4 v[220:223], v1, s[16:19], s48 offen offset:3072 sc1
    s_add_u32 s48, s48, 4096
    buffer_load_dwordx4 v[224:227], v1, s[16:19], s48 offen sc1
    buffer_load_dwordx4 v[228:231], v1, s[16:19], s48 offen offset:1024 sc1
    buffer_load_dwordx4 v[232:235], v1, s[16:19], s48 offen offset:2048 sc1
    buffer_load_dwordx4 v[236:239], v1, s[16:19], s48 offen offset:3072 sc1
    s_add_u32 s48, s48, 4096
    buffer_load_dwordx4 v[192:195], v1, s[16:19], s48 offen sc1
    buffer_load_dwordx4 v[196:199], v1, s[16:19], s48 offen offset:1024 sc1
    buffer_load_dwordx4 v[200:203], v1, s[16:19], s48 offen offset:2048 sc1
    buffer_load_dwordx4 v[204:207], v1, s[16:19], s48 offen offset:3072 sc1
    s_add_u32 s48, s48, 4096
    buffer_load_dwordx4 v[208:211], v1, s[16:19], s48 offen sc1
    buffer_load_dwordx4 v[212:215], v1, s[16:19], s48 offen offset:1024 sc1
    buffer_load_dwordx4 v[216:219], v1, s[16:19], s48 offen offset:2048 sc1
    buffer_load_dwordx4 v[220:223], v1, s[16:19], s48 offen offset:3072 sc1
    s_add_u32 s48, s48, 4096
    buffer_load_dwordx4 v[224:227], v1, s[16:19], s48 offen sc1
    buffer_load_dwordx4 v[228:231], v1, s[16:19], s48 offen offset:1024 sc1
    buffer_load_dwordx4 v[232:235], v1, s[16:19], s48 offen offset:2048 sc1
    buffer_load_dwordx4 v[236:239], v1, s[16:19], s48 offen offset:3072 sc1
    s_add_u32 s48, s48, 4096
    buffer_load_dwordx4 v[192:195], v1, s[16:19], s48 offen sc1
    buffer_load_dwordx4 v[196:199], v1, s[16:19], s48 offen offset:1024 sc1
    buffer_load_dwordx4 v[200:203], v1, s[16:19], s48 offen offset:2048 sc1
    buffer_load_dwordx4 v[204:207], v1, s[16:19], s48 offen offset:3072 sc1
    s_add_u32 s48, s48, 4096
    buffer_load_dwordx4 v[208:211], v1, s[16:19], s48 offen sc1
    buffer_load_dwordx4 v[212:215], v1, s[16:19], s48 offen offset:1024 sc1
    buffer_load_dwordx4 v[216:219], v1, s[16:19], s48 offen offset:2048 sc1
    buffer_load_dwordx4 v[220:223], v1, s[16:19], s48 offen offset:3072 sc1
    s_add_u32 s48, s48, 4096
    buffer_load_dwordx4 v[224:227], v1, s[16:19], s48 offen sc1
    s_bitcmp1_b32 s3, 0
    s_cselect_b32 s48, s37, s36
    s_cselect_b32 s56, s39, s38
    s_bitcmp1_b32 s3, 1
    s_cselect_b32 s56, s56, s48
    s_xor_b32 s57, s3, 1
    s_lshr_b32 s48, s3, 1
    s_or_b32 s48, s48, s36
    s_cmp_eq_u32 s48, 0
    s_cselect_b32 s57, s3, s57
    v_mul_u32_u24 v4, 5120, v3
    v_lshl_add_u32 v4, v2, 4, v4
    v_xor_b32 v5, 768, v1
    v_and_b32 v7, 3, v2
    v_lshl_add_u32 v7, v3, 2, v7
    v_mul_u32_u24 v7, 1280, v7
    v_lshrrev_b32 v6, 2, v2
    v_add_u32 v6, 1, v6
    v_lshl_add_u32 v6, v6, 8, v7
    v_cvt_f32_u32 v10, v2
    v_mul_f32 v10, 0x3d800000, v10
    s_cmp_eq_u32 s56, 0
    s_cselect_b32 s48, 0x3f800000, 0x3f700000
    v_sub_f32 v11, s48, v10
    v_lshlrev_b32 v12, 2, v3
    v_cvt_f32_u32 v12, v12
    v_add_f32 v13, 0, v12
    v_mul_f32 v14, v13, v10
    v_cos_f32 v15, v14
    v_sin_f32 v14, v14
    s_nop 0
    v_cvt_pk_bf16_f32 v16, v15, v14
    v_mul_f32 v14, v13, v11
    v_cos_f32 v15, v14
    v_sin_f32 v14, v14
    s_nop 0
    v_cvt_pk_bf16_f32 v20, v15, v14
    v_add_f32 v13, 1.0, v12
    v_mul_f32 v14, v13, v10
    v_cos_f32 v15, v14
    v_sin_f32 v14, v14
    s_nop 0
    v_cvt_pk_bf16_f32 v17, v15, v14
    v_mul_f32 v14, v13, v11
    v_cos_f32 v15, v14
    v_sin_f32 v14, v14
    s_nop 0
    v_cvt_pk_bf16_f32 v21, v15, v14
    v_add_f32 v13, 2.0, v12
    v_mul_f32 v14, v13, v10
    v_cos_f32 v15, v14
    v_sin_f32 v14, v14
    s_nop 0
    v_cvt_pk_bf16_f32 v18, v15, v14
    v_mul_f32 v14, v13, v11
    v_cos_f32 v15, v14
    v_sin_f32 v14, v14
    s_nop 0
    v_cvt_pk_bf16_f32 v22, v15, v14
    v_add_f32 v13, 0x40400000, v12
    v_mul_f32 v14, v13, v10
    v_cos_f32 v15, v14
    v_sin_f32 v14, v14
    s_nop 0
    v_cvt_pk_bf16_f32 v19, v15, v14
    v_mul_f32 v14, v13, v11
    v_cos_f32 v15, v14
    v_sin_f32 v14, v14
    s_nop 0
    v_cvt_pk_bf16_f32 v23, v15, v14
    v_cmp_eq_u32 vcc, 0, v2
    s_nop 1
    v_cndmask_b32 v10, -1, 0, vcc
    s_lshl_b32 s48, s3, 10
    v_add_u32 v11, s48, v1
    s_lshl_b32 s48, s57, 10
    s_add_u32 s48, s48, 40960
    v_add_u32 v12, s48, v5
    v_mov_b32 v5, v1
    v_add_u32 v13, 40960, v1
    s_mul_i32 s59, s56, 20480
    s_add_u32 s59, s59, 7864320
layer_m_4:
    s_waitcnt vmcnt(0)
    ds_read_b128 v[112:115], v11 offset:0
    ds_read_b128 v[116:119], v11 offset:4096
    ds_read_b128 v[120:123], v12 offset:32768
    ds_read_b128 v[124:127], v12 offset:36864
    s_waitcnt lgkmcnt(0)
    v_lshlrev_b32 v128, 16, v112
    v_lshlrev_b32 v129, 16, v114
    v_lshlrev_b32 v130, 16, v116
    v_lshlrev_b32 v131, 16, v118
    v_and_b32 v132, s10, v112
    v_and_b32 v133, s10, v114
    v_and_b32 v134, s10, v116
    v_and_b32 v135, s10, v118
    v_lshlrev_b32 v136, 16, v113
    v_lshlrev_b32 v137, 16, v115
    v_lshlrev_b32 v138, 16, v117
    v_lshlrev_b32 v139, 16, v119
    v_and_b32 v140, s10, v113
    v_and_b32 v141, s10, v115
    v_and_b32 v142, s10, v117
    v_and_b32 v143, s10, v119
    v_and_b32 v144, s10, v127
    v_and_b32 v145, s10, v125
    v_and_b32 v146, s10, v123
    v_and_b32 v147, s10, v121
    v_lshlrev_b32 v148, 16, v127
    v_lshlrev_b32 v149, 16, v125
    v_lshlrev_b32 v150, 16, v123
    v_lshlrev_b32 v151, 16, v121
    v_and_b32 v152, s10, v126
    v_and_b32 v153, s10, v124
    v_and_b32 v154, s10, v122
    v_and_b32 v155, s10, v120
    v_lshlrev_b32 v156, 16, v126
    v_lshlrev_b32 v157, 16, v124
    v_lshlrev_b32 v158, 16, v122
    v_lshlrev_b32 v159, 16, v120
    s_mul_i32 s48, s3, 5120
    v_min_u32 v246, 39, v0
    v_lshlrev_b32 v246, 7, v246
    s_add_u32 s48, s48, 29196288
    v_add_u32 v246, s48, v246
    s_waitcnt lgkmcnt(0)
    buffer_load_dwordx2 v[250:251], v246, s[16:19], 0 offen sc1
    s_mov_b32 s55, 0
    s_add_u32 s54, s47, 5
    s_waitcnt vmcnt(0)
ploop_m_50:
    v_subrev_u32 v250, s54, v250
    v_xor_b32 v251, s46, v251
    v_lshl_or_b32 v250, v251, 3, v250
    v_and_b32 v251, -8, v251
    v_or_b32 v250, v250, v251
    v_cmp_le_u32 vcc, 3, v250
    s_add_u32 s55, s55, 1
    s_cmp_ge_u32 s55, 200000
    s_cbranch_scc1 pok_m_49
    s_nop 2
    s_cbranch_vccz pok_m_49
    s_sleep 1
    buffer_load_dwordx2 v[250:251], v246, s[16:19], 0 offen sc1
    s_waitcnt vmcnt(0)
    s_branch ploop_m_50
pok_m_49:
    s_barrier
    buffer_load_dwordx4 v[32:35], v4, s[16:19], s59 offen sc1
    buffer_load_dwordx4 v[36:39], v4, s[16:19], s59 offen offset:1280 sc1
    buffer_load_dwordx4 v[40:43], v4, s[16:19], s59 offen offset:2560 sc1
    buffer_load_dwordx4 v[44:47], v4, s[16:19], s59 offen offset:3840 sc1
    buffer_load_dword v8, v6, s[16:19], s59 offen sc1
    s_add_u32 s48, s59, 256
    buffer_load_dwordx4 v[48:51], v4, s[16:19], s48 offen sc1
    buffer_load_dwordx4 v[52:55], v4, s[16:19], s48 offen offset:1280 sc1
    buffer_load_dwordx4 v[56:59], v4, s[16:19], s48 offen offset:2560 sc1
    buffer_load_dwordx4 v[60:63], v4, s[16:19], s48 offen offset:3840 sc1
    s_waitcnt vmcnt(4)
    v_max3_u32 v28, v32, v36, v40
    v_max3_u32 v28, v28, v44, v8
    v_cmp_eq_u32 vcc, -1, v28
    s_nop 3
    s_cbranch_vccnz vrt_m_51
vbk_m_52:
    v_mov_b32_dpp v28, v8 row_shr:15 row_mask:0xf bank_mask:0xf
    v_mov_b32_dpp v29, v8 row_shr:14 row_mask:0xf bank_mask:0xf
    v_mov_b32_dpp v30, v8 row_shr:13 row_mask:0xf bank_mask:0xf
    v_mov_b32_dpp v31, v8 row_shr:12 row_mask:0xf bank_mask:0xf
    v_mov_b32_dpp v28, v32 row_shl:1 row_mask:0xf bank_mask:0xf
    v_mov_b32_dpp v29, v36 row_shl:1 row_mask:0xf bank_mask:0xf
    v_mov_b32_dpp v30, v40 row_shl:1 row_mask:0xf bank_mask:0xf
    v_mov_b32_dpp v31, v44 row_shl:1 row_mask:0xf bank_mask:0xf
    v_swap_b32 v33, v36
    v_swap_b32 v34, v40
    v_swap_b32 v35, v44
    v_swap_b32 v38, v41
    v_swap_b32 v39, v45
    v_swap_b32 v43, v46
    v_and_b32 v32, v10, v32
    v_and_b32 v33, v10, v33
    v_and_b32 v34, v10, v34
    v_and_b32 v35, v10, v35
    v_mfma_f32_16x16x32_bf16 v[156:159], v[28:31], v[20:23], v[156:159]
    s_nop 0
    v_mfma_f32_16x16x32_bf16 v[128:131], v[32:35], v[16:19], v[128:131]
    v_mfma_f32_16x16x32_bf16 v[132:135], v[36:39], v[16:19], v[132:135]
    v_mfma_f32_16x16x32_bf16 v[136:139], v[40:43], v[16:19], v[136:139]
    v_mfma_f32_16x16x32_bf16 v[140:143], v[44:47], v[16:19], v[140:143]
    v_mfma_f32_16x16x32_bf16 v[144:147], v[36:39], v[20:23], v[144:147]
    v_mfma_f32_16x16x32_bf16 v[148:151], v[40:43], v[20:23], v[148:151]
    v_mfma_f32_16x16x32_bf16 v[152:155], v[44:47], v[20:23], v[152:155]
    ds_read_b128 v[32:35], v11 offset:8192
    ds_read_b128 v[36:39], v11 offset:12288
    ds_read_b128 v[40:43], v12 offset:24576
    ds_read_b128 v[44:47], v12 offset:28672
    v_cvt_pk_bf16_f32 v112, v128, v132
    v_cvt_pk_bf16_f32 v113, v136, v140
    v_cvt_pk_bf16_f32 v114, v129, v133
    v_cvt_pk_bf16_f32 v115, v137, v141
    ds_write_b128 v11, v[112:115] offset:0
    v_cvt_pk_bf16_f32 v116, v130, v134
    v_cvt_pk_bf16_f32 v117, v138, v142
    v_cvt_pk_bf16_f32 v118, v131, v135
    v_cvt_pk_bf16_f32 v119, v139, v143
    ds_write_b128 v11, v[116:119] offset:4096
    v_cvt_pk_bf16_f32 v120, v159, v155
    v_cvt_pk_bf16_f32 v121, v151, v147
    v_cvt_pk_bf16_f32 v122, v158, v154
    v_cvt_pk_bf16_f32 v123, v150, v146
    ds_write_b128 v12, v[120:123] offset:32768
    v_cvt_pk_bf16_f32 v124, v157, v153
    v_cvt_pk_bf16_f32 v125, v149, v145
    v_cvt_pk_bf16_f32 v126, v156, v152
    v_cvt_pk_bf16_f32 v127, v148, v144
    ds_write_b128 v12, v[124:127] offset:36864
    s_waitcnt lgkmcnt(0)
    s_barrier
    ds_read_b128 v[160:163], v5 offset:0
    ds_read_b128 v[164:167], v5 offset:1024
    ds_read_b128 v[168:171], v5 offset:2048
    ds_read_b128 v[172:175], v5 offset:3072
    s_waitcnt lgkmcnt(8)
    s_add_u32 s48, s59, 512
    v_lshlrev_b32 v128, 16, v32
    v_lshlrev_b32 v129, 16, v34
    v_lshlrev_b32 v130, 16, v36
    v_lshlrev_b32 v131, 16, v38
    buffer_load_dwordx4 v[64:67], v4, s[16:19], s48 offen sc1
    v_and_b32 v132, s10, v32
    v_and_b32 v133, s10, v34
    v_and_b32 v134, s10, v36
    v_and_b32 v135, s10, v38
    v_lshlrev_b32 v136, 16, v33
    v_lshlrev_b32 v137, 16, v35
    v_lshlrev_b32 v138, 16, v37
    v_lshlrev_b32 v139, 16, v39
    s_waitcnt lgkmcnt(0)
    v_mfma_f32_16x16x32_bf16 v[192:195], a[64:67], v[160:163], 0
    v_and_b32 v140, s10, v33
    v_and_b32 v141, s10, v35
    v_mfma_f32_16x16x32_bf16 v[200:203], a[64:67], v[164:167], 0
    v_and_b32 v142, s10, v37
    ds_read_b128 v[176:179], v5 offset:4096
    v_mfma_f32_16x16x32_bf16 v[208:211], a[64:67], v[168:171], 0
    v_and_b32 v143, s10, v39
    v_and_b32 v144, s10, v47
    v_mfma_f32_16x16x32_bf16 v[216:219], a[64:67], v[172:175], 0
    v_and_b32 v145, s10, v45
    ds_read_b128 v[180:183], v5 offset:5120
    v_mfma_f32_16x16x32_bf16 v[196:199], a[68:71], v[160:163], 0
    buffer_load_dwordx4 v[68:71], v4, s[16:19], s48 offen offset:1280 sc1
    v_mfma_f32_16x16x32_bf16 v[204:207], a[68:71], v[164:167], 0
    v_and_b32 v146, s10, v43
    ds_read_b128 v[184:187], v5 offset:6144
    v_mfma_f32_16x16x32_bf16 v[212:215], a[68:71], v[168:171], 0
    v_and_b32 v147, s10, v41
    v_lshlrev_b32 v148, 16, v47
    v_mfma_f32_16x16x32_bf16 v[220:223], a[68:71], v[172:175], 0
    v_lshlrev_b32 v149, 16, v45
    ds_read_b128 v[188:191], v5 offset:7168
    v_mfma_f32_16x16x32_bf16 v[224:227], a[104:107], v[160:163], 0
    buffer_load_dwordx4 v[72:75], v4, s[16:19], s48 offen offset:2560 sc1
    v_lshlrev_b32 v150, 16, v43
    v_lshlrev_b32 v151, 16, v41
    v_mfma_f32_16x16x32_bf16 v[232:235], a[104:107], v[164:167], 0
    v_and_b32 v152, s10, v46
    v_and_b32 v153, s10, v44
    v_mfma_f32_16x16x32_bf16 v[240:243], a[104:107], v[168:171], 0
    v_and_b32 v154, s10, v42
    v_and_b32 v155, s10, v40
    v_lshlrev_b32 v156, 16, v46
    v_mfma_f32_16x16x32_bf16 v[248:251], a[104:107], v[172:175], 0
    v_lshlrev_b32 v157, 16, v44
    v_lshlrev_b32 v158, 16, v42
    v_mfma_f32_16x16x32_bf16 v[228:231], a[108:111], v[160:163], 0
    buffer_load_dwordx4 v[76:79], v4, s[16:19], s48 offen offset:3840 sc1
    v_lshlrev_b32 v159, 16, v40
    s_waitcnt vmcnt(4)
    v_max3_u32 v28, v48, v52, v56
    v_mfma_f32_16x16x32_bf16 v[236:239], a[108:111], v[164:167], 0
    v_max3_u32 v28, v28, v60, v8
    v_cmp_eq_u32 vcc, -1, v28
    s_nop 3
    s_cbranch_vccnz vrt_m_54
vbk_m_55:
    v_mfma_f32_16x16x32_bf16 v[244:247], a[108:111], v[168:171], 0
    v_mov_b32_dpp v28, v8 row_shr:11 row_mask:0xf bank_mask:0xf
    v_mov_b32_dpp v29, v8 row_shr:10 row_mask:0xf bank_mask:0xf
    v_mfma_f32_16x16x32_bf16 v[252:255], a[108:111], v[172:175], 0
    v_mov_b32_dpp v30, v8 row_shr:9 row_mask:0xf bank_mask:0xf
    v_mov_b32_dpp v31, v8 row_shr:8 row_mask:0xf bank_mask:0xf
    v_mov_b32_dpp v28, v48 row_shl:1 row_mask:0xf bank_mask:0xf
    s_waitcnt lgkmcnt(0)
    v_mfma_f32_16x16x32_bf16 v[192:195], a[72:75], v[176:179], v[192:195]
    s_add_u32 s48, s59, 768
    v_mov_b32_dpp v29, v52 row_shl:1 row_mask:0xf bank_mask:0xf
    v_mov_b32_dpp v30, v56 row_shl:1 row_mask:0xf bank_mask:0xf
    v_mfma_f32_16x16x32_bf16 v[200:203], a[72:75], v[180:183], v[200:203]
    v_mov_b32_dpp v31, v60 row_shl:1 row_mask:0xf bank_mask:0xf
    v_swap_b32 v49, v52
    ds_read_b128 v[160:163], v13 offset:32768
    v_mfma_f32_16x16x32_bf16 v[208:211], a[72:75], v[184:187], v[208:211]
    buffer_load_dwordx4 v[80:83], v4, s[16:19], s48 offen sc1
    v_swap_b32 v50, v56
    v_mfma_f32_16x16x32_bf16 v[216:219], a[72:75], v[188:191], v[216:219]
    v_swap_b32 v51, v60
    ds_read_b128 v[164:167], v13 offset:33792
    v_mfma_f32_16x16x32_bf16 v[196:199], a[76:79], v[176:179], v[196:199]
    v_swap_b32 v54, v57
    v_swap_b32 v55, v61
    v_mfma_f32_16x16x32_bf16 v[204:207], a[76:79], v[180:183], v[204:207]
    v_swap_b32 v59, v62
    v_mfma_f32_16x16x32_bf16 v[156:159], v[28:31], v[20:23], v[156:159]
    ds_read_b128 v[168:171], v13 offset:34816
    v_mfma_f32_16x16x32_bf16 v[212:215], a[76:79], v[184:187], v[212:215]
    buffer_load_dwordx4 v[84:87], v4, s[16:19], s48 offen offset:1280 sc1
    v_mfma_f32_16x16x32_bf16 v[128:131], v[48:51], v[16:19], v[128:131]
    v_mfma_f32_16x16x32_bf16 v[132:135], v[52:55], v[16:19], v[132:135]
    buffer_load_dwordx4 v[88:91], v4, s[16:19], s48 offen offset:2560 sc1
    v_mfma_f32_16x16x32_bf16 v[136:139], v[56:59], v[16:19], v[136:139]
    v_mfma_f32_16x16x32_bf16 v[140:143], v[60:63], v[16:19], v[140:143]
    v_mfma_f32_16x16x32_bf16 v[144:147], v[52:55], v[20:23], v[144:147]
    v_mfma_f32_16x16x32_bf16 v[148:151], v[56:59], v[20:23], v[148:151]
    v_mfma_f32_16x16x32_bf16 v[152:155], v[60:63], v[20:23], v[152:155]
    ds_read_b128 v[48:51], v11 offset:16384
    ds_read_b128 v[52:55], v11 offset:20480
    v_mfma_f32_16x16x32_bf16 v[220:223], a[76:79], v[188:191], v[220:223]
    ds_read_b128 v[56:59], v12 offset:16384
    ds_read_b128 v[172:175], v13 offset:35840
    v_mfma_f32_16x16x32_bf16 v[224:227], a[112:115], v[176:179], v[224:227]
    ds_read_b128 v[60:63], v12 offset:20480
    v_cvt_pk_bf16_f32 v32, v128, v132
    v_mfma_f32_16x16x32_bf16 v[232:235], a[112:115], v[180:183], v[232:235]
    buffer_load_dwordx4 v[92:95], v4, s[16:19], s48 offen offset:3840 sc1
    v_mfma_f32_16x16x32_bf16 v[240:243], a[112:115], v[184:187], v[240:243]
    v_cvt_pk_bf16_f32 v33, v136, v140
    v_cvt_pk_bf16_f32 v34, v129, v133
    v_mfma_f32_16x16x32_bf16 v[248:251], a[112:115], v[188:191], v[248:251]
    v_cvt_pk_bf16_f32 v35, v137, v141
    v_mfma_f32_16x16x32_bf16 v[228:231], a[116:119], v[176:179], v[228:231]
    v_mfma_f32_16x16x32_bf16 v[236:239], a[116:119], v[180:183], v[236:239]
    buffer_load_dword v9, v7, s[16:19], s59 offen sc1
    v_mfma_f32_16x16x32_bf16 v[244:247], a[116:119], v[184:187], v[244:247]
    v_mfma_f32_16x16x32_bf16 v[252:255], a[116:119], v[188:191], v[252:255]
    s_waitcnt lgkmcnt(1)
    v_mfma_f32_16x16x32_bf16 v[192:195], a[80:83], v[160:163], v[192:195]
    s_add_u32 s48, s59, 1024
    v_mfma_f32_16x16x32_bf16 v[200:203], a[80:83], v[164:167], v[200:203]
    ds_write_b128 v11, v[32:35] offset:8192
    v_cvt_pk_bf16_f32 v36, v130, v134
    ds_read_b128 v[176:179], v13 offset:36864
    v_mfma_f32_16x16x32_bf16 v[208:211], a[80:83], v[168:171], v[208:211]
    v_cvt_pk_bf16_f32 v37, v138, v142
    v_cvt_pk_bf16_f32 v38, v131, v135
    v_mfma_f32_16x16x32_bf16 v[216:219], a[80:83], v[172:175], v[216:219]
    v_cvt_pk_bf16_f32 v39, v139, v143
    ds_read_b128 v[180:183], v13 offset:37888
    v_mfma_f32_16x16x32_bf16 v[196:199], a[84:87], v[160:163], v[196:199]
    buffer_load_dwordx4 v[96:99], v4, s[16:19], s48 offen sc1
    v_mfma_f32_16x16x32_bf16 v[204:207], a[84:87], v[164:167], v[204:207]
    ds_write_b128 v11, v[36:39] offset:12288
    v_cvt_pk_bf16_f32 v40, v159, v155
    ds_read_b128 v[184:187], v13 offset:38912
    v_mfma_f32_16x16x32_bf16 v[212:215], a[84:87], v[168:171], v[212:215]
    v_cvt_pk_bf16_f32 v41, v151, v147
    v_cvt_pk_bf16_f32 v42, v158, v154
    v_cvt_pk_bf16_f32 v43, v150, v146
    v_mfma_f32_16x16x32_bf16 v[220:223], a[84:87], v[172:175], v[220:223]
    ds_read_b128 v[188:191], v13 offset:39936
    v_mfma_f32_16x16x32_bf16 v[224:227], a[88:91], v[160:163], v[224:227]
    buffer_load_dwordx4 v[100:103], v4, s[16:19], s48 offen offset:1280 sc1
    v_mfma_f32_16x16x32_bf16 v[232:235], a[88:91], v[164:167], v[232:235]
    ds_write_b128 v12, v[40:43] offset:24576
    v_cvt_pk_bf16_f32 v44, v157, v153
    v_mfma_f32_16x16x32_bf16 v[240:243], a[88:91], v[168:171], v[240:243]
    v_cvt_pk_bf16_f32 v45, v149, v145
    v_cvt_pk_bf16_f32 v46, v156, v152
    v_cvt_pk_bf16_f32 v47, v148, v144
    v_mfma_f32_16x16x32_bf16 v[248:251], a[88:91], v[172:175], v[248:251]
    buffer_load_dwordx4 v[104:107], v4, s[16:19], s48 offen offset:2560 sc1
    v_mfma_f32_16x16x32_bf16 v[228:231], a[92:95], v[160:163], v[228:231]
    buffer_load_dwordx4 v[108:111], v4, s[16:19], s48 offen offset:3840 sc1
    v_mfma_f32_16x16x32_bf16 v[236:239], a[92:95], v[164:167], v[236:239]
    v_mfma_f32_16x16x32_bf16 v[244:247], a[92:95], v[168:171], v[244:247]
    v_mfma_f32_16x16x32_bf16 v[252:255], a[92:95], v[172:175], v[252:255]
    ds_write_b128 v12, v[44:47] offset:28672
    s_waitcnt lgkmcnt(0)
    s_barrier
    s_waitcnt lgkmcnt(2)
    v_mfma_f32_16x16x32_bf16 v[192:195], a[96:99], v[176:179], v[192:195]
    s_waitcnt lgkmcnt(8)
    s_add_u32 s60, s44, 8192
    v_mfma_f32_16x16x32_bf16 v[200:203], a[96:99], v[180:183], v[200:203]
    v_lshlrev_b32 v128, 16, v48
    ds_read_b128 v[160:163], v5 offset:8192
    v_mfma_f32_16x16x32_bf16 v[208:211], a[96:99], v[184:187], v[208:211]
    v_lshlrev_b32 v129, 16, v50
    v_lshlrev_b32 v130, 16, v52
    v_mfma_f32_16x16x32_bf16 v[216:219], a[96:99], v[188:191], v[216:219]
    v_lshlrev_b32 v131, 16, v54
    ds_read_b128 v[164:167], v5 offset:9216
    v_mfma_f32_16x16x32_bf16 v[196:199], a[100:103], v[176:179], v[196:199]
    buffer_load_dwordx4 a[192:195], v1, s[16:19], s60 offen sc1
    v_and_b32 v132, s10, v48
    v_and_b32 v133, s10, v50
    v_mfma_f32_16x16x32_bf16 v[204:207], a[100:103], v[180:183], v[204:207]
    v_and_b32 v134, s10, v52
    v_and_b32 v135, s10, v54
    ds_read_b128 v[168:171], v5 offset:10240
    v_mfma_f32_16x16x32_bf16 v[212:215], a[100:103], v[184:187], v[212:215]
    v_lshlrev_b32 v136, 16, v49
    v_lshlrev_b32 v137, 16, v51
    v_mfma_f32_16x16x32_bf16 v[220:223], a[100:103], v[188:191], v[220:223]
    v_lshlrev_b32 v138, 16, v53
    v_lshlrev_b32 v139, 16, v55
    ds_read_b128 v[172:175], v5 offset:11264
    v_mfma_f32_16x16x32_bf16 v[224:227], a[120:123], v[176:179], v[224:227]
    buffer_load_dwordx4 a[196:199], v1, s[16:19], s60 offen offset:1024 sc1
    v_and_b32 v140, s10, v49
    v_and_b32 v141, s10, v51
    v_mfma_f32_16x16x32_bf16 v[232:235], a[120:123], v[180:183], v[232:235]
    v_and_b32 v142, s10, v53
    v_and_b32 v143, s10, v55
    v_mfma_f32_16x16x32_bf16 v[240:243], a[120:123], v[184:187], v[240:243]
    v_and_b32 v144, s10, v63
    v_and_b32 v145, s10, v61
    v_mfma_f32_16x16x32_bf16 v[248:251], a[120:123], v[188:191], v[248:251]
    buffer_load_dwordx4 a[200:203], v1, s[16:19], s60 offen offset:2048 sc1
    v_and_b32 v146, s10, v59
    v_and_b32 v147, s10, v57
    v_mfma_f32_16x16x32_bf16 v[228:231], a[124:127], v[176:179], v[228:231]
    v_lshlrev_b32 v148, 16, v63
    v_lshlrev_b32 v149, 16, v61
    v_mfma_f32_16x16x32_bf16 v[236:239], a[124:127], v[180:183], v[236:239]
    v_lshlrev_b32 v150, 16, v59
    v_lshlrev_b32 v151, 16, v57
    v_mfma_f32_16x16x32_bf16 v[244:247], a[124:127], v[184:187], v[244:247]
    v_and_b32 v152, s10, v62
    v_and_b32 v153, s10, v60
    v_mfma_f32_16x16x32_bf16 v[252:255], a[124:127], v[188:191], v[252:255]
    v_and_b32 v154, s10, v58
    v_and_b32 v155, s10, v56
    s_waitcnt lgkmcnt(0)
    v_mfma_f32_16x16x32_bf16 v[192:195], a[128:131], v[160:163], v[192:195]
    buffer_load_dwordx4 a[24:27], v1, s[16:19], s60 offen offset:3072 sc1
    v_lshlrev_b32 v156, 16, v62
    v_lshlrev_b32 v157, 16, v60
    v_mfma_f32_16x16x32_bf16 v[200:203], a[128:131], v[164:167], v[200:203]
    v_lshlrev_b32 v158, 16, v58
    v_lshlrev_b32 v159, 16, v56
    ds_read_b128 v[176:179], v5 offset:12288
    v_mfma_f32_16x16x32_bf16 v[208:211], a[128:131], v[168:171], v[208:211]
    s_add_u32 s60, s44, 28672
    s_waitcnt vmcnt(13)
    v_max3_u32 v28, v64, v68, v72
    v_mfma_f32_16x16x32_bf16 v[216:219], a[128:131], v[172:175], v[216:219]
    v_max3_u32 v28, v28, v76, v8
    ds_read_b128 v[180:183], v5 offset:13312
    v_mfma_f32_16x16x32_bf16 v[196:199], a[132:135], v[160:163], v[196:199]
    v_cmp_eq_u32 vcc, -1, v28
    s_nop 3
    s_cbranch_vccnz vrt_m_57
vbk_m_58:
    v_mov_b32_dpp v28, v8 row_shr:7 row_mask:0xf bank_mask:0xf
    v_mfma_f32_16x16x32_bf16 v[204:207], a[132:135], v[164:167], v[204:207]
    v_mov_b32_dpp v29, v8 row_shr:6 row_mask:0xf bank_mask:0xf
    v_mov_b32_dpp v30, v8 row_shr:5 row_mask:0xf bank_mask:0xf
    ds_read_b128 v[184:187], v5 offset:14336
    v_mfma_f32_16x16x32_bf16 v[212:215], a[132:135], v[168:171], v[212:215]
    buffer_load_dwordx4 a[28:31], v1, s[16:19], s60 offen sc1
    v_mov_b32_dpp v31, v8 row_shr:4 row_mask:0xf bank_mask:0xf
    v_mov_b32_dpp v28, v64 row_shl:1 row_mask:0xf bank_mask:0xf
    v_mfma_f32_16x16x32_bf16 v[220:223], a[132:135], v[172:175], v[220:223]
    v_mov_b32_dpp v29, v68 row_shl:1 row_mask:0xf bank_mask:0xf
    v_mov_b32_dpp v30, v72 row_shl:1 row_mask:0xf bank_mask:0xf
    ds_read_b128 v[188:191], v5 offset:15360
    v_mfma_f32_16x16x32_bf16 v[224:227], a[168:171], v[160:163], v[224:227]
    buffer_load_dwordx4 a[56:59], v1, s[16:19], s60 offen offset:1024 sc1
    v_mov_b32_dpp v31, v76 row_shl:1 row_mask:0xf bank_mask:0xf
    v_mfma_f32_16x16x32_bf16 v[232:235], a[168:171], v[164:167], v[232:235]
    v_swap_b32 v65, v68
    v_mfma_f32_16x16x32_bf16 v[240:243], a[168:171], v[168:171], v[240:243]
    v_swap_b32 v66, v72
    v_mfma_f32_16x16x32_bf16 v[248:251], a[168:171], v[172:175], v[248:251]
    v_swap_b32 v67, v76
    v_mfma_f32_16x16x32_bf16 v[228:231], a[172:175], v[160:163], v[228:231]
    buffer_load_dwordx4 a[60:63], v1, s[16:19], s60 offen offset:2048 sc1
    v_swap_b32 v70, v73
    v_mfma_f32_16x16x32_bf16 v[236:239], a[172:175], v[164:167], v[236:239]
    v_swap_b32 v71, v77
    v_mfma_f32_16x16x32_bf16 v[244:247], a[172:175], v[168:171], v[244:247]
    v_swap_b32 v75, v78
    v_mfma_f32_16x16x32_bf16 v[156:159], v[28:31], v[20:23], v[156:159]
    buffer_load_dwordx4 a[64:67], v1, s[16:19], s60 offen offset:3072 sc1
    v_mfma_f32_16x16x32_bf16 v[128:131], v[64:67], v[16:19], v[128:131]
    v_mfma_f32_16x16x32_bf16 v[132:135], v[68:71], v[16:19], v[132:135]
    v_mfma_f32_16x16x32_bf16 v[136:139], v[72:75], v[16:19], v[136:139]
    v_mfma_f32_16x16x32_bf16 v[140:143], v[76:79], v[16:19], v[140:143]
    v_mfma_f32_16x16x32_bf16 v[144:147], v[68:71], v[20:23], v[144:147]
    v_mfma_f32_16x16x32_bf16 v[148:151], v[72:75], v[20:23], v[148:151]
    v_mfma_f32_16x16x32_bf16 v[152:155], v[76:79], v[20:23], v[152:155]
    ds_read_b128 v[64:67], v11 offset:24576
    ds_read_b128 v[68:71], v11 offset:28672
    v_mfma_f32_16x16x32_bf16 v[252:255], a[172:175], v[172:175], v[252:255]
    ds_read_b128 v[72:75], v12 offset:8192
    s_waitcnt lgkmcnt(3)
    v_mfma_f32_16x16x32_bf16 v[192:195], a[136:139], v[176:179], v[192:195]
    s_add_u32 s60, s45, 8192
    ds_read_b128 v[76:79], v12 offset:12288
    v_mfma_f32_16x16x32_bf16 v[200:203], a[136:139], v[180:183], v[200:203]
    v_cvt_pk_bf16_f32 v48, v128, v132
    ds_read_b128 v[160:163], v13 offset:24576
    v_mfma_f32_16x16x32_bf16 v[208:211], a[136:139], v[184:187], v[208:211]
    buffer_load_dwordx4 a[68:71], v1, s[16:19], s60 offen sc1
    v_mfma_f32_16x16x32_bf16 v[216:219], a[136:139], v[188:191], v[216:219]
    v_cvt_pk_bf16_f32 v49, v136, v140
    ds_read_b128 v[164:167], v13 offset:25600
    v_mfma_f32_16x16x32_bf16 v[196:199], a[140:143], v[176:179], v[196:199]
    v_cvt_pk_bf16_f32 v50, v129, v133
    v_cvt_pk_bf16_f32 v51, v137, v141
    v_mfma_f32_16x16x32_bf16 v[204:207], a[140:143], v[180:183], v[204:207]
    ds_read_b128 v[168:171], v13 offset:26624
    v_mfma_f32_16x16x32_bf16 v[212:215], a[140:143], v[184:187], v[212:215]
    buffer_load_dwordx4 a[72:75], v1, s[16:19], s60 offen offset:1024 sc1
    v_mfma_f32_16x16x32_bf16 v[220:223], a[140:143], v[188:191], v[220:223]
    ds_read_b128 v[172:175], v13 offset:27648
    v_mfma_f32_16x16x32_bf16 v[224:227], a[176:179], v[176:179], v[224:227]
    buffer_load_dwordx4 a[76:79], v1, s[16:19], s60 offen offset:2048 sc1
    v_mfma_f32_16x16x32_bf16 v[232:235], a[176:179], v[180:183], v[232:235]
    v_mfma_f32_16x16x32_bf16 v[240:243], a[176:179], v[184:187], v[240:243]
    v_mfma_f32_16x16x32_bf16 v[248:251], a[176:179], v[188:191], v[248:251]
    v_mfma_f32_16x16x32_bf16 v[228:231], a[180:183], v[176:179], v[228:231]
    buffer_load_dwordx4 a[80:83], v1, s[16:19], s60 offen offset:3072 sc1
    v_mfma_f32_16x16x32_bf16 v[236:239], a[180:183], v[180:183], v[236:239]
    ds_write_b128 v11, v[48:51] offset:16384
    v_cvt_pk_bf16_f32 v52, v130, v134
    v_mfma_f32_16x16x32_bf16 v[244:247], a[180:183], v[184:187], v[244:247]
    v_cvt_pk_bf16_f32 v53, v138, v142
    v_cvt_pk_bf16_f32 v54, v131, v135
    v_mfma_f32_16x16x32_bf16 v[252:255], a[180:183], v[188:191], v[252:255]
    v_cvt_pk_bf16_f32 v55, v139, v143
    s_waitcnt lgkmcnt(1)
    v_mfma_f32_16x16x32_bf16 v[192:195], a[144:147], v[160:163], v[192:195]
    s_add_u32 s60, s45, 28672
    v_mfma_f32_16x16x32_bf16 v[200:203], a[144:147], v[164:167], v[200:203]
    ds_read_b128 v[176:179], v13 offset:28672
    v_mfma_f32_16x16x32_bf16 v[208:211], a[144:147], v[168:171], v[208:211]
    ds_write_b128 v11, v[52:55] offset:20480
    v_cvt_pk_bf16_f32 v56, v159, v155
    v_mfma_f32_16x16x32_bf16 v[216:219], a[144:147], v[172:175], v[216:219]
    v_cvt_pk_bf16_f32 v57, v151, v147
    v_cvt_pk_bf16_f32 v58, v158, v154
    ds_read_b128 v[180:183], v13 offset:29696
    v_mfma_f32_16x16x32_bf16 v[196:199], a[148:151], v[160:163], v[196:199]
    buffer_load_dwordx4 a[84:87], v1, s[16:19], s60 offen sc1
    v_cvt_pk_bf16_f32 v59, v150, v146
    v_mfma_f32_16x16x32_bf16 v[204:207], a[148:151], v[164:167], v[204:207]
    ds_read_b128 v[184:187], v13 offset:30720
    v_mfma_f32_16x16x32_bf16 v[212:215], a[148:151], v[168:171], v[212:215]
    buffer_load_dwordx4 a[104:107], v1, s[16:19], s60 offen offset:1024 sc1
    v_mfma_f32_16x16x32_bf16 v[220:223], a[148:151], v[172:175], v[220:223]
    ds_write_b128 v12, v[56:59] offset:16384
    v_cvt_pk_bf16_f32 v60, v157, v153
    ds_read_b128 v[188:191], v13 offset:31744
    v_mfma_f32_16x16x32_bf16 v[224:227], a[152:155], v[160:163], v[224:227]
    v_cvt_pk_bf16_f32 v61, v149, v145
    v_cvt_pk_bf16_f32 v62, v156, v152
    v_mfma_f32_16x16x32_bf16 v[232:235], a[152:155], v[164:167], v[232:235]
    v_cvt_pk_bf16_f32 v63, v148, v144
    v_mfma_f32_16x16x32_bf16 v[240:243], a[152:155], v[168:171], v[240:243]
    buffer_load_dwordx4 a[108:111], v1, s[16:19], s60 offen offset:2048 sc1
    v_mfma_f32_16x16x32_bf16 v[248:251], a[152:155], v[172:175], v[248:251]
    v_mfma_f32_16x16x32_bf16 v[228:231], a[156:159], v[160:163], v[228:231]
    buffer_load_dwordx4 a[112:115], v1, s[16:19], s60 offen offset:3072 sc1
    v_mfma_f32_16x16x32_bf16 v[236:239], a[156:159], v[164:167], v[236:239]
    v_mfma_f32_16x16x32_bf16 v[244:247], a[156:159], v[168:171], v[244:247]
    v_mfma_f32_16x16x32_bf16 v[252:255], a[156:159], v[172:175], v[252:255]
    ds_write_b128 v12, v[60:63] offset:20480
    s_waitcnt lgkmcnt(0)
    s_barrier
    s_waitcnt lgkmcnt(1)
    v_mfma_f32_16x16x32_bf16 v[192:195], a[160:163], v[176:179], v[192:195]
    s_waitcnt lgkmcnt(12)
    s_add_u32 s60, s44, 12288
    v_mfma_f32_16x16x32_bf16 v[200:203], a[160:163], v[180:183], v[200:203]
    v_lshlrev_b32 v128, 16, v64
    ds_read_b128 v[160:163], v5 offset:16384
    v_mfma_f32_16x16x32_bf16 v[208:211], a[160:163], v[184:187], v[208:211]
    v_lshlrev_b32 v129, 16, v66
    v_lshlrev_b32 v130, 16, v68
    v_mfma_f32_16x16x32_bf16 v[216:219], a[160:163], v[188:191], v[216:219]
    v_lshlrev_b32 v131, 16, v70
    ds_read_b128 v[164:167], v5 offset:17408
    v_mfma_f32_16x16x32_bf16 v[196:199], a[164:167], v[176:179], v[196:199]
    buffer_load_dwordx4 a[116:119], v1, s[16:19], s60 offen sc1
    v_and_b32 v132, s10, v64
    v_and_b32 v133, s10, v66
    v_mfma_f32_16x16x32_bf16 v[204:207], a[164:167], v[180:183], v[204:207]
    v_and_b32 v134, s10, v68
    v_and_b32 v135, s10, v70
    ds_read_b128 v[168:171], v5 offset:18432
    v_mfma_f32_16x16x32_bf16 v[212:215], a[164:167], v[184:187], v[212:215]
    v_lshlrev_b32 v136, 16, v65
    v_lshlrev_b32 v137, 16, v67
    v_mfma_f32_16x16x32_bf16 v[220:223], a[164:167], v[188:191], v[220:223]
    v_lshlrev_b32 v138, 16, v69
    v_lshlrev_b32 v139, 16, v71
    ds_read_b128 v[172:175], v5 offset:19456
    v_mfma_f32_16x16x32_bf16 v[224:227], a[184:187], v[176:179], v[224:227]
    buffer_load_dwordx4 a[88:91], v1, s[16:19], s60 offen offset:1024 sc1
    v_and_b32 v140, s10, v65
    v_and_b32 v141, s10, v67
    v_mfma_f32_16x16x32_bf16 v[232:235], a[184:187], v[180:183], v[232:235]
    v_and_b32 v142, s10, v69
    v_and_b32 v143, s10, v71
    v_mfma_f32_16x16x32_bf16 v[240:243], a[184:187], v[184:187], v[240:243]
    v_and_b32 v144, s10, v79
    v_and_b32 v145, s10, v77
    v_mfma_f32_16x16x32_bf16 v[248:251], a[184:187], v[188:191], v[248:251]
    buffer_load_dwordx4 a[92:95], v1, s[16:19], s60 offen offset:2048 sc1
    v_and_b32 v146, s10, v75
    v_and_b32 v147, s10, v73
    v_mfma_f32_16x16x32_bf16 v[228:231], a[188:191], v[176:179], v[228:231]
    v_lshlrev_b32 v148, 16, v79
    v_lshlrev_b32 v149, 16, v77
    v_mfma_f32_16x16x32_bf16 v[236:239], a[188:191], v[180:183], v[236:239]
    v_lshlrev_b32 v150, 16, v75
    v_lshlrev_b32 v151, 16, v73
    v_mfma_f32_16x16x32_bf16 v[244:247], a[188:191], v[184:187], v[244:247]
    v_and_b32 v152, s10, v78
    v_and_b32 v153, s10, v76
    v_mfma_f32_16x16x32_bf16 v[252:255], a[188:191], v[188:191], v[252:255]
    v_and_b32 v154, s10, v74
    v_and_b32 v155, s10, v72
    s_waitcnt vmcnt(3) lgkmcnt(0)
    v_mfma_f32_16x16x32_bf16 v[192:195], a[192:195], v[160:163], v[192:195]
    buffer_load_dwordx4 a[96:99], v1, s[16:19], s60 offen offset:3072 sc1
    v_lshlrev_b32 v156, 16, v78
    v_lshlrev_b32 v157, 16, v76
    v_mfma_f32_16x16x32_bf16 v[200:203], a[192:195], v[164:167], v[200:203]
    v_lshlrev_b32 v158, 16, v74
    v_lshlrev_b32 v159, 16, v72
    ds_read_b128 v[176:179], v5 offset:20480
    v_mfma_f32_16x16x32_bf16 v[208:211], a[192:195], v[168:171], v[208:211]
    s_add_u32 s60, s44, 24576
    s_waitcnt vmcnt(25)
    v_max3_u32 v28, v80, v84, v88
    v_mfma_f32_16x16x32_bf16 v[216:219], a[192:195], v[172:175], v[216:219]
    v_max3_u32 v28, v28, v92, v8
    ds_read_b128 v[180:183], v5 offset:21504
    v_mfma_f32_16x16x32_bf16 v[196:199], a[196:199], v[160:163], v[196:199]
    v_cmp_eq_u32 vcc, -1, v28
    s_nop 3
    s_cbranch_vccnz vrt_m_60
vbk_m_61:
    v_mov_b32_dpp v28, v8 row_shr:3 row_mask:0xf bank_mask:0xf
    v_mfma_f32_16x16x32_bf16 v[204:207], a[196:199], v[164:167], v[204:207]
    v_mov_b32_dpp v29, v8 row_shr:2 row_mask:0xf bank_mask:0xf
    v_mov_b32_dpp v30, v8 row_shr:1 row_mask:0xf bank_mask:0xf
    ds_read_b128 v[184:187], v5 offset:22528
    v_mfma_f32_16x16x32_bf16 v[212:215], a[196:199], v[168:171], v[212:215]
    buffer_load_dwordx4 a[100:103], v1, s[16:19], s60 offen sc1
    v_mov_b32 v31, v8
    v_mov_b32_dpp v28, v80 row_shl:1 row_mask:0xf bank_mask:0xf
    v_mfma_f32_16x16x32_bf16 v[220:223], a[196:199], v[172:175], v[220:223]
    v_mov_b32_dpp v29, v84 row_shl:1 row_mask:0xf bank_mask:0xf
    v_mov_b32_dpp v30, v88 row_shl:1 row_mask:0xf bank_mask:0xf
    ds_read_b128 v[188:191], v5 offset:23552
    v_mfma_f32_16x16x32_bf16 v[224:227], a[68:71], v[160:163], v[224:227]
    buffer_load_dwordx4 a[120:123], v1, s[16:19], s60 offen offset:1024 sc1
    v_mov_b32_dpp v31, v92 row_shl:1 row_mask:0xf bank_mask:0xf
    v_mfma_f32_16x16x32_bf16 v[232:235], a[68:71], v[164:167], v[232:235]
    v_swap_b32 v81, v84
    v_mfma_f32_16x16x32_bf16 v[240:243], a[68:71], v[168:171], v[240:243]
    v_swap_b32 v82, v88
    v_mfma_f32_16x16x32_bf16 v[248:251], a[68:71], v[172:175], v[248:251]
    v_swap_b32 v83, v92
    v_mfma_f32_16x16x32_bf16 v[228:231], a[72:75], v[160:163], v[228:231]
    buffer_load_dwordx4 a[124:127], v1, s[16:19], s60 offen offset:2048 sc1
    v_swap_b32 v86, v89
    v_mfma_f32_16x16x32_bf16 v[236:239], a[72:75], v[164:167], v[236:239]
    v_swap_b32 v87, v93
    v_mfma_f32_16x16x32_bf16 v[244:247], a[72:75], v[168:171], v[244:247]
    v_swap_b32 v91, v94
    v_mfma_f32_16x16x32_bf16 v[156:159], v[28:31], v[20:23], v[156:159]
    buffer_load_dwordx4 a[128:131], v1, s[16:19], s60 offen offset:3072 sc1
    v_mfma_f32_16x16x32_bf16 v[128:131], v[80:83], v[16:19], v[128:131]
    v_mfma_f32_16x16x32_bf16 v[132:135], v[84:87], v[16:19], v[132:135]
    v_mfma_f32_16x16x32_bf16 v[136:139], v[88:91], v[16:19], v[136:139]
    v_mfma_f32_16x16x32_bf16 v[140:143], v[92:95], v[16:19], v[140:143]
    v_mfma_f32_16x16x32_bf16 v[144:147], v[84:87], v[20:23], v[144:147]
    v_mfma_f32_16x16x32_bf16 v[148:151], v[88:91], v[20:23], v[148:151]
    v_mfma_f32_16x16x32_bf16 v[152:155], v[92:95], v[20:23], v[152:155]
    ds_read_b128 v[80:83], v11 offset:32768
    ds_read_b128 v[84:87], v11 offset:36864
    v_mfma_f32_16x16x32_bf16 v[252:255], a[72:75], v[172:175], v[252:255]
    ds_read_b128 v[88:91], v12 offset:0
    s_waitcnt lgkmcnt(3)
    v_mfma_f32_16x16x32_bf16 v[192:195], a[200:203], v[176:179], v[192:195]
    s_add_u32 s60, s45, 12288
    ds_read_b128 v[92:95], v12 offset:4096
    v_mfma_f32_16x16x32_bf16 v[200:203], a[200:203], v[180:183], v[200:203]
    v_cvt_pk_bf16_f32 v64, v128, v132
    ds_read_b128 v[160:163], v13 offset:16384
    v_mfma_f32_16x16x32_bf16 v[208:211], a[200:203], v[184:187], v[208:211]
    buffer_load_dwordx4 a[132:135], v1, s[16:19], s60 offen sc1
    v_mfma_f32_16x16x32_bf16 v[216:219], a[200:203], v[188:191], v[216:219]
    v_cvt_pk_bf16_f32 v65, v136, v140
    ds_read_b128 v[164:167], v13 offset:17408
    v_mfma_f32_16x16x32_bf16 v[196:199], a[24:27], v[176:179], v[196:199]
    v_cvt_pk_bf16_f32 v66, v129, v133
    v_cvt_pk_bf16_f32 v67, v137, v141
    v_mfma_f32_16x16x32_bf16 v[204:207], a[24:27], v[180:183], v[204:207]
    ds_read_b128 v[168:171], v13 offset:18432
    v_mfma_f32_16x16x32_bf16 v[212:215], a[24:27], v[184:187], v[212:215]
    buffer_load_dwordx4 a[136:139], v1, s[16:19], s60 offen offset:1024 sc1
    v_mfma_f32_16x16x32_bf16 v[220:223], a[24:27], v[188:191], v[220:223]
    ds_read_b128 v[172:175], v13 offset:19456
    v_mfma_f32_16x16x32_bf16 v[224:227], a[76:79], v[176:179], v[224:227]
    buffer_load_dwordx4 a[140:143], v1, s[16:19], s60 offen offset:2048 sc1
    v_mfma_f32_16x16x32_bf16 v[232:235], a[76:79], v[180:183], v[232:235]
    v_mfma_f32_16x16x32_bf16 v[240:243], a[76:79], v[184:187], v[240:243]
    v_mfma_f32_16x16x32_bf16 v[248:251], a[76:79], v[188:191], v[248:251]
    v_mfma_f32_16x16x32_bf16 v[228:231], a[80:83], v[176:179], v[228:231]
    buffer_load_dwordx4 a[144:147], v1, s[16:19], s60 offen offset:3072 sc1
    v_mfma_f32_16x16x32_bf16 v[236:239], a[80:83], v[180:183], v[236:239]
    ds_write_b128 v11, v[64:67] offset:24576
    v_cvt_pk_bf16_f32 v68, v130, v134
    v_mfma_f32_16x16x32_bf16 v[244:247], a[80:83], v[184:187], v[244:247]
    v_cvt_pk_bf16_f32 v69, v138, v142
    v_cvt_pk_bf16_f32 v70, v131, v135
    v_mfma_f32_16x16x32_bf16 v[252:255], a[80:83], v[188:191], v[252:255]
    v_cvt_pk_bf16_f32 v71, v139, v143
    s_waitcnt lgkmcnt(1)
    v_mfma_f32_16x16x32_bf16 v[192:195], a[28:31], v[160:163], v[192:195]
    s_add_u32 s60, s45, 24576
    v_mfma_f32_16x16x32_bf16 v[200:203], a[28:31], v[164:167], v[200:203]
    ds_read_b128 v[176:179], v13 offset:20480
    v_mfma_f32_16x16x32_bf16 v[208:211], a[28:31], v[168:171], v[208:211]
    ds_write_b128 v11, v[68:71] offset:28672
    v_cvt_pk_bf16_f32 v72, v159, v155
    v_mfma_f32_16x16x32_bf16 v[216:219], a[28:31], v[172:175], v[216:219]
    v_cvt_pk_bf16_f32 v73, v151, v147
    v_cvt_pk_bf16_f32 v74, v158, v154
    ds_read_b128 v[180:183], v13 offset:21504
    v_mfma_f32_16x16x32_bf16 v[196:199], a[56:59], v[160:163], v[196:199]
    buffer_load_dwordx4 a[148:151], v1, s[16:19], s60 offen sc1
    v_cvt_pk_bf16_f32 v75, v150, v146
    v_mfma_f32_16x16x32_bf16 v[204:207], a[56:59], v[164:167], v[204:207]
    ds_read_b128 v[184:187], v13 offset:22528
    v_mfma_f32_16x16x32_bf16 v[212:215], a[56:59], v[168:171], v[212:215]
    buffer_load_dwordx4 a[168:171], v1, s[16:19], s60 offen offset:1024 sc1
    v_mfma_f32_16x16x32_bf16 v[220:223], a[56:59], v[172:175], v[220:223]
    ds_write_b128 v12, v[72:75] offset:8192
    v_cvt_pk_bf16_f32 v76, v157, v153
    ds_read_b128 v[188:191], v13 offset:23552
    v_mfma_f32_16x16x32_bf16 v[224:227], a[84:87], v[160:163], v[224:227]
    v_cvt_pk_bf16_f32 v77, v149, v145
    v_cvt_pk_bf16_f32 v78, v156, v152
    v_mfma_f32_16x16x32_bf16 v[232:235], a[84:87], v[164:167], v[232:235]
    v_cvt_pk_bf16_f32 v79, v148, v144
    v_mfma_f32_16x16x32_bf16 v[240:243], a[84:87], v[168:171], v[240:243]
    buffer_load_dwordx4 a[172:175], v1, s[16:19], s60 offen offset:2048 sc1
    v_mfma_f32_16x16x32_bf16 v[248:251], a[84:87], v[172:175], v[248:251]
    v_mfma_f32_16x16x32_bf16 v[228:231], a[104:107], v[160:163], v[228:231]
    buffer_load_dwordx4 a[176:179], v1, s[16:19], s60 offen offset:3072 sc1
    v_mfma_f32_16x16x32_bf16 v[236:239], a[104:107], v[164:167], v[236:239]
    v_mfma_f32_16x16x32_bf16 v[244:247], a[104:107], v[168:171], v[244:247]
    v_mfma_f32_16x16x32_bf16 v[252:255], a[104:107], v[172:175], v[252:255]
    ds_write_b128 v12, v[76:79] offset:12288
    s_waitcnt lgkmcnt(0)
    s_barrier
    s_waitcnt lgkmcnt(1)
    v_mfma_f32_16x16x32_bf16 v[192:195], a[60:63], v[176:179], v[192:195]
    s_waitcnt lgkmcnt(12)
    s_add_u32 s60, s44, 16384
    v_mfma_f32_16x16x32_bf16 v[200:203], a[60:63], v[180:183], v[200:203]
    v_lshlrev_b32 v128, 16, v80
    ds_read_b128 v[160:163], v5 offset:24576
    v_mfma_f32_16x16x32_bf16 v[208:211], a[60:63], v[184:187], v[208:211]
    v_lshlrev_b32 v129, 16, v82
    v_lshlrev_b32 v130, 16, v84
    v_mfma_f32_16x16x32_bf16 v[216:219], a[60:63], v[188:191], v[216:219]
    v_lshlrev_b32 v131, 16, v86
    ds_read_b128 v[164:167], v5 offset:25600
    v_mfma_f32_16x16x32_bf16 v[196:199], a[64:67], v[176:179], v[196:199]
    buffer_load_dwordx4 a[180:183], v1, s[16:19], s60 offen sc1
    v_and_b32 v132, s10, v80
    v_mfma_f32_16x16x32_bf16 v[204:207], a[64:67], v[180:183], v[204:207]
    v_and_b32 v133, s10, v82
    v_and_b32 v134, s10, v84
    ds_read_b128 v[168:171], v5 offset:26624
    v_mfma_f32_16x16x32_bf16 v[212:215], a[64:67], v[184:187], v[212:215]
    v_and_b32 v135, s10, v86
    v_lshlrev_b32 v136, 16, v81
    v_mfma_f32_16x16x32_bf16 v[220:223], a[64:67], v[188:191], v[220:223]
    v_lshlrev_b32 v137, 16, v83
    v_lshlrev_b32 v138, 16, v85
    ds_read_b128 v[172:175], v5 offset:27648
    v_mfma_f32_16x16x32_bf16 v[224:227], a[108:111], v[176:179], v[224:227]
    buffer_load_dwordx4 a[152:155], v1, s[16:19], s60 offen offset:1024 sc1
    v_lshlrev_b32 v139, 16, v87
    v_and_b32 v140, s10, v81
    v_mfma_f32_16x16x32_bf16 v[232:235], a[108:111], v[180:183], v[232:235]
    v_and_b32 v141, s10, v83
    v_and_b32 v142, s10, v85
    v_mfma_f32_16x16x32_bf16 v[240:243], a[108:111], v[184:187], v[240:243]
    v_and_b32 v143, s10, v87
    v_and_b32 v144, s10, v95
    v_mfma_f32_16x16x32_bf16 v[248:251], a[108:111], v[188:191], v[248:251]
    buffer_load_dwordx4 a[156:159], v1, s[16:19], s60 offen offset:2048 sc1
    v_and_b32 v145, s10, v93
    v_and_b32 v146, s10, v91
    v_mfma_f32_16x16x32_bf16 v[228:231], a[112:115], v[176:179], v[228:231]
    v_and_b32 v147, s10, v89
    v_lshlrev_b32 v148, 16, v95
    v_mfma_f32_16x16x32_bf16 v[236:239], a[112:115], v[180:183], v[236:239]
    v_lshlrev_b32 v149, 16, v93
    v_lshlrev_b32 v150, 16, v91
    v_mfma_f32_16x16x32_bf16 v[244:247], a[112:115], v[184:187], v[244:247]
    v_lshlrev_b32 v151, 16, v89
    v_and_b32 v152, s10, v94
    v_mfma_f32_16x16x32_bf16 v[252:255], a[112:115], v[188:191], v[252:255]
    v_and_b32 v153, s10, v92
    s_waitcnt vmcnt(3) lgkmcnt(0)
    v_mfma_f32_16x16x32_bf16 v[192:195], a[116:119], v[160:163], v[192:195]
    buffer_load_dwordx4 a[160:163], v1, s[16:19], s60 offen offset:3072 sc1
    v_and_b32 v154, s10, v90
    v_and_b32 v155, s10, v88
    v_mfma_f32_16x16x32_bf16 v[200:203], a[116:119], v[164:167], v[200:203]
    v_lshlrev_b32 v156, 16, v94
    v_lshlrev_b32 v157, 16, v92
    ds_read_b128 v[176:179], v5 offset:28672
    v_mfma_f32_16x16x32_bf16 v[208:211], a[116:119], v[168:171], v[208:211]
    v_lshlrev_b32 v158, 16, v90
    s_add_u32 s60, s44, 20480
    v_lshlrev_b32 v159, 16, v88
    v_mfma_f32_16x16x32_bf16 v[216:219], a[116:119], v[172:175], v[216:219]
    s_waitcnt vmcnt(36)
    v_max3_u32 v28, v96, v100, v104
    ds_read_b128 v[180:183], v5 offset:29696
    v_mfma_f32_16x16x32_bf16 v[196:199], a[88:91], v[160:163], v[196:199]
    buffer_load_dwordx4 a[164:167], v1, s[16:19], s60 offen sc1
    v_max3_u32 v28, v28, v108, v9
    v_mfma_f32_16x16x32_bf16 v[204:207], a[88:91], v[164:167], v[204:207]
    v_cmp_eq_u32 vcc, -1, v28
    s_nop 3
    s_cbranch_vccnz vrt_m_63
vbk_m_64:
    v_mov_b32_dpp v28, v9 row_shr:15 row_mask:0xf bank_mask:0xf
    ds_read_b128 v[184:187], v5 offset:30720
    v_mfma_f32_16x16x32_bf16 v[212:215], a[88:91], v[168:171], v[212:215]
    v_mov_b32_dpp v29, v9 row_shr:14 row_mask:0xf bank_mask:0xf
    v_mov_b32_dpp v30, v9 row_shr:13 row_mask:0xf bank_mask:0xf
    v_mfma_f32_16x16x32_bf16 v[220:223], a[88:91], v[172:175], v[220:223]
    v_mov_b32_dpp v31, v9 row_shr:12 row_mask:0xf bank_mask:0xf
    v_mov_b32_dpp v28, v96 row_shl:1 row_mask:0xf bank_mask:0xf
    ds_read_b128 v[188:191], v5 offset:31744
    v_mfma_f32_16x16x32_bf16 v[224:227], a[132:135], v[160:163], v[224:227]
    buffer_load_dwordx4 a[184:187], v1, s[16:19], s60 offen offset:1024 sc1
    v_mov_b32_dpp v29, v100 row_shl:1 row_mask:0xf bank_mask:0xf
    v_mov_b32_dpp v30, v104 row_shl:1 row_mask:0xf bank_mask:0xf
    v_mfma_f32_16x16x32_bf16 v[232:235], a[132:135], v[164:167], v[232:235]
    v_mov_b32_dpp v31, v108 row_shl:1 row_mask:0xf bank_mask:0xf
    v_mfma_f32_16x16x32_bf16 v[240:243], a[132:135], v[168:171], v[240:243]
    v_swap_b32 v97, v100
    v_mfma_f32_16x16x32_bf16 v[248:251], a[132:135], v[172:175], v[248:251]
    v_swap_b32 v98, v104
    v_mfma_f32_16x16x32_bf16 v[228:231], a[136:139], v[160:163], v[228:231]
    buffer_load_dwordx4 a[188:191], v1, s[16:19], s60 offen offset:2048 sc1
    v_swap_b32 v99, v108
    v_mfma_f32_16x16x32_bf16 v[236:239], a[136:139], v[164:167], v[236:239]
    v_swap_b32 v102, v105
    v_mfma_f32_16x16x32_bf16 v[244:247], a[136:139], v[168:171], v[244:247]
    v_swap_b32 v103, v109
    v_mfma_f32_16x16x32_bf16 v[252:255], a[136:139], v[172:175], v[252:255]
    v_swap_b32 v107, v110
    v_mfma_f32_16x16x32_bf16 v[156:159], v[28:31], v[20:23], v[156:159]
    s_waitcnt lgkmcnt(0)
    v_mfma_f32_16x16x32_bf16 v[192:195], a[92:95], v[176:179], v[192:195]
    buffer_load_dwordx4 a[192:195], v1, s[16:19], s60 offen offset:3072 sc1
    v_mfma_f32_16x16x32_bf16 v[128:131], v[96:99], v[16:19], v[128:131]
    v_mfma_f32_16x16x32_bf16 v[132:135], v[100:103], v[16:19], v[132:135]
    s_add_u32 s60, s45, 16384
    v_mfma_f32_16x16x32_bf16 v[200:203], a[92:95], v[180:183], v[200:203]
    ds_read_b128 v[160:163], v13 offset:8192
    v_mfma_f32_16x16x32_bf16 v[208:211], a[92:95], v[184:187], v[208:211]
    v_mfma_f32_16x16x32_bf16 v[136:139], v[104:107], v[16:19], v[136:139]
    buffer_load_dwordx4 a[196:199], v1, s[16:19], s60 offen sc1
    v_mfma_f32_16x16x32_bf16 v[140:143], v[108:111], v[16:19], v[140:143]
    v_mfma_f32_16x16x32_bf16 v[144:147], v[100:103], v[20:23], v[144:147]
    v_mfma_f32_16x16x32_bf16 v[148:151], v[104:107], v[20:23], v[148:151]
    v_mfma_f32_16x16x32_bf16 v[152:155], v[108:111], v[20:23], v[152:155]
    v_cvt_pk_bf16_f32 v80, v128, v132
    s_nop 3
    v_cvt_pk_bf16_f32 v81, v136, v140
    v_mfma_f32_16x16x32_bf16 v[216:219], a[92:95], v[188:191], v[216:219]
    v_cvt_pk_bf16_f32 v82, v129, v133
    ds_read_b128 v[164:167], v13 offset:9216
    v_mfma_f32_16x16x32_bf16 v[196:199], a[96:99], v[176:179], v[196:199]
    v_cvt_pk_bf16_f32 v83, v137, v141
    v_mfma_f32_16x16x32_bf16 v[204:207], a[96:99], v[180:183], v[204:207]
    ds_read_b128 v[168:171], v13 offset:10240
    v_mfma_f32_16x16x32_bf16 v[212:215], a[96:99], v[184:187], v[212:215]
    buffer_load_dwordx4 a[200:203], v1, s[16:19], s60 offen offset:1024 sc1
    v_mfma_f32_16x16x32_bf16 v[220:223], a[96:99], v[188:191], v[220:223]
    ds_read_b128 v[172:175], v13 offset:11264
    v_mfma_f32_16x16x32_bf16 v[224:227], a[140:143], v[176:179], v[224:227]
    buffer_load_dwordx4 a[24:27], v1, s[16:19], s60 offen offset:2048 sc1
    v_mfma_f32_16x16x32_bf16 v[232:235], a[140:143], v[180:183], v[232:235]
    v_mfma_f32_16x16x32_bf16 v[240:243], a[140:143], v[184:187], v[240:243]
    v_mfma_f32_16x16x32_bf16 v[248:251], a[140:143], v[188:191], v[248:251]
    v_mfma_f32_16x16x32_bf16 v[228:231], a[144:147], v[176:179], v[228:231]
    ds_write_b128 v11, v[80:83] offset:32768
    v_mfma_f32_16x16x32_bf16 v[236:239], a[144:147], v[180:183], v[236:239]
    v_cvt_pk_bf16_f32 v84, v130, v134
    v_cvt_pk_bf16_f32 v85, v138, v142
    v_mfma_f32_16x16x32_bf16 v[244:247], a[144:147], v[184:187], v[244:247]
    v_cvt_pk_bf16_f32 v86, v131, v135
    v_cvt_pk_bf16_f32 v87, v139, v143
    v_mfma_f32_16x16x32_bf16 v[252:255], a[144:147], v[188:191], v[252:255]
    s_waitcnt lgkmcnt(1)
    v_mfma_f32_16x16x32_bf16 v[192:195], a[100:103], v[160:163], v[192:195]
    buffer_load_dwordx4 a[28:31], v1, s[16:19], s60 offen offset:3072 sc1
    v_mfma_f32_16x16x32_bf16 v[200:203], a[100:103], v[164:167], v[200:203]
    s_add_u32 s60, s45, 20480
    ds_read_b128 v[176:179], v13 offset:12288
    v_mfma_f32_16x16x32_bf16 v[208:211], a[100:103], v[168:171], v[208:211]
    ds_write_b128 v11, v[84:87] offset:36864
    v_cvt_pk_bf16_f32 v88, v159, v155
    v_mfma_f32_16x16x32_bf16 v[216:219], a[100:103], v[172:175], v[216:219]
    v_cvt_pk_bf16_f32 v89, v151, v147
    v_cvt_pk_bf16_f32 v90, v158, v154
    ds_read_b128 v[180:183], v13 offset:13312
    v_mfma_f32_16x16x32_bf16 v[196:199], a[120:123], v[160:163], v[196:199]
    buffer_load_dwordx4 a[56:59], v1, s[16:19], s60 offen sc1
    v_cvt_pk_bf16_f32 v91, v150, v146
    v_mfma_f32_16x16x32_bf16 v[204:207], a[120:123], v[164:167], v[204:207]
    ds_read_b128 v[184:187], v13 offset:14336
    v_mfma_f32_16x16x32_bf16 v[212:215], a[120:123], v[168:171], v[212:215]
    buffer_load_dwordx4 a[68:71], v1, s[16:19], s60 offen offset:1024 sc1
    v_mfma_f32_16x16x32_bf16 v[220:223], a[120:123], v[172:175], v[220:223]
    ds_write_b128 v12, v[88:91] offset:0
    v_cvt_pk_bf16_f32 v92, v157, v153
    ds_read_b128 v[188:191], v13 offset:15360
    v_mfma_f32_16x16x32_bf16 v[224:227], a[148:151], v[160:163], v[224:227]
    v_cvt_pk_bf16_f32 v93, v149, v145
    v_cvt_pk_bf16_f32 v94, v156, v152
    v_mfma_f32_16x16x32_bf16 v[232:235], a[148:151], v[164:167], v[232:235]
    v_cvt_pk_bf16_f32 v95, v148, v144
    v_mfma_f32_16x16x32_bf16 v[240:243], a[148:151], v[168:171], v[240:243]
    buffer_load_dwordx4 a[72:75], v1, s[16:19], s60 offen offset:2048 sc1
    v_mfma_f32_16x16x32_bf16 v[248:251], a[148:151], v[172:175], v[248:251]
    v_mfma_f32_16x16x32_bf16 v[228:231], a[168:171], v[160:163], v[228:231]
    buffer_load_dwordx4 a[76:79], v1, s[16:19], s60 offen offset:3072 sc1
    v_mfma_f32_16x16x32_bf16 v[236:239], a[168:171], v[164:167], v[236:239]
    v_mfma_f32_16x16x32_bf16 v[244:247], a[168:171], v[168:171], v[244:247]
    v_mfma_f32_16x16x32_bf16 v[252:255], a[168:171], v[172:175], v[252:255]
    ds_write_b128 v12, v[92:95] offset:4096
    s_waitcnt lgkmcnt(0)
    s_barrier
    s_waitcnt lgkmcnt(1)
    v_mfma_f32_16x16x32_bf16 v[192:195], a[124:127], v[176:179], v[192:195]
    s_mul_i32 s50, s36, 55296
    s_mul_i32 s60, s41, 5
    v_mfma_f32_16x16x32_bf16 v[200:203], a[124:127], v[180:183], v[200:203]
    s_add_u32 s50, s50, 17563648
    ds_read_b128 v[160:163], v5 offset:32768
    v_mfma_f32_16x16x32_bf16 v[208:211], a[124:127], v[184:187], v[208:211]
    s_add_u32 s60, s60, s8
    v_add_u32 v28, s50, v1
    v_mfma_f32_16x16x32_bf16 v[216:219], a[124:127], v[188:191], v[216:219]
    s_mul_i32 s50, s37, 55296
    ds_read_b128 v[164:167], v5 offset:33792
    v_mfma_f32_16x16x32_bf16 v[196:199], a[128:131], v[176:179], v[196:199]
    s_cmp_eq_u32 s41, 1073741824
    s_cselect_b32 s60, 1073741824, s60
    v_mfma_f32_16x16x32_bf16 v[204:207], a[128:131], v[180:183], v[204:207]
    s_add_u32 s50, s50, 17563648
    v_add_u32 v29, s50, v1
    ds_read_b128 v[168:171], v5 offset:36864
    v_mfma_f32_16x16x32_bf16 v[212:215], a[128:131], v[184:187], v[212:215]
    s_mul_i32 s50, s38, 55296
    s_add_u32 s50, s50, 17563648
    v_mfma_f32_16x16x32_bf16 v[220:223], a[128:131], v[188:191], v[220:223]
    v_add_u32 v30, s50, v1
    ds_read_b128 v[172:175], v5 offset:37888
    v_mfma_f32_16x16x32_bf16 v[224:227], a[172:175], v[176:179], v[224:227]
    buffer_load_dwordx4 a[80:83], v1, s[16:19], s60 offen sc1
    s_mul_i32 s50, s39, 55296
    v_mfma_f32_16x16x32_bf16 v[232:235], a[172:175], v[180:183], v[232:235]
    s_add_u32 s50, s50, 17563648
    v_add_u32 v31, s50, v1
    v_mfma_f32_16x16x32_bf16 v[240:243], a[172:175], v[184:187], v[240:243]
    buffer_load_dwordx4 a[84:87], v1, s[16:19], s60 offen offset:1024 sc1
    s_mul_i32 s48, s31, 5
    v_mfma_f32_16x16x32_bf16 v[248:251], a[172:175], v[188:191], v[248:251]
    s_lshr_b32 s48, s48, 1
    s_and_b32 s58, s31, 1
    v_mfma_f32_16x16x32_bf16 v[228:231], a[176:179], v[176:179], v[228:231]
    s_add_u32 s56, s48, s58
    s_add_u32 s49, s48, 2
    v_mfma_f32_16x16x32_bf16 v[236:239], a[176:179], v[180:183], v[236:239]
    buffer_load_dwordx4 a[104:107], v1, s[16:19], s60 offen offset:2048 sc1
    v_mfma_f32_16x16x32_bf16 v[244:247], a[176:179], v[184:187], v[244:247]
    s_cmp_eq_u32 s58, 0
    s_cselect_b32 s57, s49, s48
    v_mfma_f32_16x16x32_bf16 v[252:255], a[176:179], v[188:191], v[252:255]
    s_xor_b32 s50, s3, 0
    ds_read_b128 v[176:179], v13 offset:0
    ds_read_b128 v[180:183], v13 offset:1024
    ds_read_b128 v[184:187], v13 offset:4096
    ds_read_b128 v[188:191], v13 offset:5120
    s_waitcnt vmcnt(3) lgkmcnt(7)
    v_mfma_f32_16x16x32_bf16 v[192:195], a[180:183], v[160:163], v[192:195]
    buffer_load_dwordx4 a[60:63], v1, s[16:19], s60 offen offset:3072 sc1
    v_mfma_f32_16x16x32_bf16 v[196:199], a[152:155], v[160:163], v[196:199]
    s_bitcmp1_b32 s50, 0
    s_cselect_b32 s48, s37, s36
    s_cselect_b32 s51, s39, s38
    v_mfma_f32_16x16x32_bf16 v[224:227], a[196:199], v[160:163], v[224:227]
    s_bitcmp1_b32 s50, 1
    s_cselect_b32 s51, s51, s48
    v_mfma_f32_16x16x32_bf16 v[228:231], a[200:203], v[160:163], v[228:231]
    s_mov_b32 s59, s51
    s_mul_i32 s51, s51, 55296
    ds_read_b128 v[160:163], v5 offset:34816
    s_waitcnt lgkmcnt(7)
    v_mfma_f32_16x16x32_bf16 v[200:203], a[180:183], v[164:167], v[200:203]
    s_add_u32 s60, s60, 4096
    s_add_u32 s51, s51, 17563648
    v_mfma_f32_16x16x32_bf16 v[204:207], a[152:155], v[164:167], v[204:207]
    buffer_load_dwordx4 a[64:67], v1, s[16:19], s60 offen sc1
    v_add_u32 v6, s51, v1
    s_mul_i32 s51, s50, 15360
    v_mfma_f32_16x16x32_bf16 v[232:235], a[196:199], v[164:167], v[232:235]
    s_mul_i32 s60, s42, 5
    v_add_u32 v10, s51, v1
    v_mfma_f32_16x16x32_bf16 v[236:239], a[200:203], v[164:167], v[236:239]
    s_xor_b32 s50, s3, 1
    ds_read_b128 v[164:167], v5 offset:35840
    s_waitcnt lgkmcnt(7)
    v_mfma_f32_16x16x32_bf16 v[192:195], a[156:159], v[168:171], v[192:195]
    s_add_u32 s60, s60, s8
    s_bitcmp1_b32 s50, 0
    s_cselect_b32 s48, s37, s36
    s_cselect_b32 s51, s39, s38
    v_mfma_f32_16x16x32_bf16 v[196:199], a[160:163], v[168:171], v[196:199]
    s_cmp_eq_u32 s42, 1073741824
    s_cselect_b32 s60, 1073741824, s60
    v_mfma_f32_16x16x32_bf16 v[224:227], a[24:27], v[168:171], v[224:227]
    s_bitcmp1_b32 s50, 1
    s_cselect_b32 s51, s51, s48
    s_mul_i32 s51, s51, 55296
    v_mfma_f32_16x16x32_bf16 v[228:231], a[28:31], v[168:171], v[228:231]
    s_add_u32 s51, s51, 17563648
    ds_read_b128 v[168:171], v5 offset:38912
    s_waitcnt lgkmcnt(7)
    v_mfma_f32_16x16x32_bf16 v[200:203], a[156:159], v[172:175], v[200:203]
    buffer_load_dwordx4 a[108:111], v1, s[16:19], s60 offen sc1
    v_add_u32 v7, s51, v1
    s_mul_i32 s51, s50, 15360
    v_mfma_f32_16x16x32_bf16 v[204:207], a[160:163], v[172:175], v[204:207]
    buffer_load_dwordx4 a[112:115], v1, s[16:19], s60 offen offset:1024 sc1
    v_add_u32 v11, s51, v1
    v_mfma_f32_16x16x32_bf16 v[232:235], a[24:27], v[172:175], v[232:235]
    s_xor_b32 s50, s3, 2
    v_mfma_f32_16x16x32_bf16 v[236:239], a[28:31], v[172:175], v[236:239]
    ds_read_b128 v[172:175], v5 offset:39936
    s_waitcnt lgkmcnt(7)
    v_mfma_f32_16x16x32_bf16 v[192:195], a[164:167], v[176:179], v[192:195]
    s_bitcmp1_b32 s50, 0
    s_cselect_b32 s48, s37, s36
    s_cselect_b32 s51, s39, s38
    v_mfma_f32_16x16x32_bf16 v[196:199], a[184:187], v[176:179], v[196:199]
    buffer_load_dwordx4 a[116:119], v1, s[16:19], s60 offen offset:2048 sc1
    s_bitcmp1_b32 s50, 1
    s_cselect_b32 s51, s51, s48
    v_mfma_f32_16x16x32_bf16 v[224:227], a[56:59], v[176:179], v[224:227]
    s_mul_i32 s51, s51, 55296
    s_add_u32 s51, s51, 17563648
    v_mfma_f32_16x16x32_bf16 v[228:231], a[68:71], v[176:179], v[228:231]
    v_add_u32 v8, s51, v1
    ds_read_b128 v[176:179], v13 offset:2048
    s_waitcnt lgkmcnt(7)
    v_mfma_f32_16x16x32_bf16 v[200:203], a[164:167], v[180:183], v[200:203]
    buffer_load_dwordx4 a[88:91], v1, s[16:19], s60 offen offset:3072 sc1
    s_mul_i32 s51, s50, 15360
    s_add_u32 s51, s51, 5120
    v_mfma_f32_16x16x32_bf16 v[204:207], a[184:187], v[180:183], v[204:207]
    s_add_u32 s60, s60, 4096
    v_add_u32 v12, s51, v1
    v_mfma_f32_16x16x32_bf16 v[232:235], a[56:59], v[180:183], v[232:235]
    buffer_load_dwordx4 a[92:95], v1, s[16:19], s60 offen sc1
    s_xor_b32 s50, s3, 3
    v_mfma_f32_16x16x32_bf16 v[236:239], a[68:71], v[180:183], v[236:239]
    ds_read_b128 v[180:183], v13 offset:3072
    s_waitcnt lgkmcnt(7)
    v_mfma_f32_16x16x32_bf16 v[192:195], a[188:191], v[184:187], v[192:195]
    s_bitcmp1_b32 s50, 0
    s_cselect_b32 s48, s37, s36
    s_cselect_b32 s51, s39, s38
    v_mfma_f32_16x16x32_bf16 v[196:199], a[192:195], v[184:187], v[196:199]
    s_cmp_le_i32 s9, 0
    s_cselect_b32 s61, s7, s3
    s_bitcmp1_b32 s50, 1
    s_cselect_b32 s51, s51, s48
    v_mfma_f32_16x16x32_bf16 v[224:227], a[72:75], v[184:187], v[224:227]
    s_mul_i32 s51, s51, 55296
    s_add_u32 s51, s51, 17563648
    v_mfma_f32_16x16x32_bf16 v[228:231], a[76:79], v[184:187], v[228:231]
    v_add_u32 v9, s51, v1
    ds_read_b128 v[184:187], v13 offset:6144
    s_waitcnt lgkmcnt(7)
    v_mfma_f32_16x16x32_bf16 v[200:203], a[188:191], v[188:191], v[200:203]
    s_mul_i32 s60, s61, 5120
    s_mul_i32 s51, s50, 15360
    s_add_u32 s51, s51, 10240
    v_mfma_f32_16x16x32_bf16 v[204:207], a[192:195], v[188:191], v[204:207]
    s_add_u32 s60, s60, s8
    v_add_u32 v14, s51, v1
    v_mfma_f32_16x16x32_bf16 v[232:235], a[72:75], v[188:191], v[232:235]
    buffer_load_dwordx4 a[96:99], v1, s[16:19], s60 offen sc1
    v_and_b32 v4, 7, v0
    v_lshlrev_b32 v4, 12, v4
    v_mfma_f32_16x16x32_bf16 v[236:239], a[76:79], v[188:191], v[236:239]
    s_lshl_b32 s48, s30, 3
    s_add_u32 s48, s48, s28
    ds_read_b128 v[188:191], v13 offset:7168
    s_lshl_b32 s48, s48, 7
    s_add_u32 s48, s48, 29229056
    v_add_u32 v4, s48, v4
    buffer_load_dwordx4 a[100:103], v1, s[16:19], s60 offen offset:1024 sc1
    s_waitcnt lgkmcnt(7)
    v_mfma_f32_16x16x32_bf16 v[208:211], a[180:183], v[160:163], v[208:211]
    v_mfma_f32_16x16x32_bf16 v[212:215], a[152:155], v[160:163], v[212:215]
    v_mfma_f32_16x16x32_bf16 v[240:243], a[196:199], v[160:163], v[240:243]
    v_mfma_f32_16x16x32_bf16 v[244:247], a[200:203], v[160:163], v[244:247]
    s_waitcnt lgkmcnt(6)
    v_mfma_f32_16x16x32_bf16 v[216:219], a[180:183], v[164:167], v[216:219]
    v_cvt_pk_bf16_f32 v80, v192, v193
    v_cvt_pk_bf16_f32 v81, v194, v195
    v_mfma_f32_16x16x32_bf16 v[220:223], a[152:155], v[164:167], v[220:223]
    v_cvt_pk_bf16_f32 v82, v196, v197
    v_mfma_f32_16x16x32_bf16 v[248:251], a[196:199], v[164:167], v[248:251]
    v_cvt_pk_bf16_f32 v83, v198, v199
    v_pk_max_i16 v80, v80, 0
    v_mfma_f32_16x16x32_bf16 v[252:255], a[200:203], v[164:167], v[252:255]
    v_pk_max_i16 v81, v81, 0
    s_waitcnt lgkmcnt(5)
    v_mfma_f32_16x16x32_bf16 v[208:211], a[156:159], v[168:171], v[208:211]
    v_pk_max_i16 v82, v82, 0
    v_pk_max_i16 v83, v83, 0
    v_mfma_f32_16x16x32_bf16 v[212:215], a[160:163], v[168:171], v[212:215]
    buffer_store_dwordx4 v[80:83], v28, s[16:19], s41 offen sc1
    v_mfma_f32_16x16x32_bf16 v[240:243], a[24:27], v[168:171], v[240:243]
    v_mfma_f32_16x16x32_bf16 v[244:247], a[28:31], v[168:171], v[244:247]
    v_cvt_pk_bf16_f32 v84, v200, v201
    s_waitcnt lgkmcnt(4)
    v_mfma_f32_16x16x32_bf16 v[216:219], a[156:159], v[172:175], v[216:219]
    v_cvt_pk_bf16_f32 v85, v202, v203
    v_cvt_pk_bf16_f32 v86, v204, v205
    v_mfma_f32_16x16x32_bf16 v[220:223], a[160:163], v[172:175], v[220:223]
    v_cvt_pk_bf16_f32 v87, v206, v207
    v_pk_max_i16 v84, v84, 0
    v_mfma_f32_16x16x32_bf16 v[248:251], a[24:27], v[172:175], v[248:251]
    v_pk_max_i16 v85, v85, 0
    v_mfma_f32_16x16x32_bf16 v[252:255], a[28:31], v[172:175], v[252:255]
    v_pk_max_i16 v86, v86, 0
    s_waitcnt lgkmcnt(3)
    v_mfma_f32_16x16x32_bf16 v[208:211], a[164:167], v[176:179], v[208:211]
    v_pk_max_i16 v87, v87, 0
    v_mfma_f32_16x16x32_bf16 v[212:215], a[184:187], v[176:179], v[212:215]
    buffer_store_dwordx4 v[84:87], v29, s[16:19], s41 offen sc1
    v_mfma_f32_16x16x32_bf16 v[240:243], a[56:59], v[176:179], v[240:243]
    v_cvt_pk_bf16_f32 v96, v224, v225
    v_cvt_pk_bf16_f32 v97, v226, v227
    v_mfma_f32_16x16x32_bf16 v[244:247], a[68:71], v[176:179], v[244:247]
    v_cvt_pk_bf16_f32 v98, v228, v229
    s_waitcnt lgkmcnt(2)
    v_mfma_f32_16x16x32_bf16 v[216:219], a[164:167], v[180:183], v[216:219]
    v_cvt_pk_bf16_f32 v99, v230, v231
    v_pk_max_i16 v96, v96, 0
    v_mfma_f32_16x16x32_bf16 v[220:223], a[184:187], v[180:183], v[220:223]
    v_pk_max_i16 v97, v97, 0
    v_mfma_f32_16x16x32_bf16 v[248:251], a[56:59], v[180:183], v[248:251]
    v_pk_max_i16 v98, v98, 0
    v_pk_max_i16 v99, v99, 0
    v_mfma_f32_16x16x32_bf16 v[252:255], a[68:71], v[180:183], v[252:255]
    s_waitcnt lgkmcnt(1)
    v_mfma_f32_16x16x32_bf16 v[208:211], a[188:191], v[184:187], v[208:211]
    buffer_store_dwordx4 v[96:99], v28, s[16:19], s42 offen sc1
    v_mfma_f32_16x16x32_bf16 v[212:215], a[192:195], v[184:187], v[212:215]
    v_cvt_pk_bf16_f32 v100, v232, v233
    v_cvt_pk_bf16_f32 v101, v234, v235
    v_mfma_f32_16x16x32_bf16 v[240:243], a[72:75], v[184:187], v[240:243]
    v_cvt_pk_bf16_f32 v102, v236, v237
    v_mfma_f32_16x16x32_bf16 v[244:247], a[76:79], v[184:187], v[244:247]
    v_cvt_pk_bf16_f32 v103, v238, v239
    s_waitcnt lgkmcnt(0)
    v_mfma_f32_16x16x32_bf16 v[216:219], a[188:191], v[188:191], v[216:219]
    v_pk_max_i16 v100, v100, 0
    v_pk_max_i16 v101, v101, 0
    v_mfma_f32_16x16x32_bf16 v[220:223], a[192:195], v[188:191], v[220:223]
    v_pk_max_i16 v102, v102, 0
    v_pk_max_i16 v103, v103, 0
    v_mfma_f32_16x16x32_bf16 v[248:251], a[72:75], v[188:191], v[248:251]
    buffer_store_dwordx4 v[100:103], v29, s[16:19], s42 offen sc1
    v_mfma_f32_16x16x32_bf16 v[252:255], a[76:79], v[188:191], v[252:255]
    v_cvt_pk_bf16_f32 v88, v208, v209
    v_cvt_pk_bf16_f32 v89, v210, v211
    v_cvt_pk_bf16_f32 v90, v212, v213
    v_cvt_pk_bf16_f32 v91, v214, v215
    v_pk_max_i16 v88, v88, 0
    v_pk_max_i16 v89, v89, 0
    v_pk_max_i16 v90, v90, 0
    v_pk_max_i16 v91, v91, 0
    buffer_store_dwordx4 v[88:91], v30, s[16:19], s41 offen sc1
    v_cvt_pk_bf16_f32 v92, v216, v217
    v_cvt_pk_bf16_f32 v93, v218, v219
    v_cvt_pk_bf16_f32 v94, v220, v221
    v_cvt_pk_bf16_f32 v95, v222, v223
    v_pk_max_i16 v92, v92, 0
    v_pk_max_i16 v93, v93, 0
    v_pk_max_i16 v94, v94, 0
    v_pk_max_i16 v95, v95, 0
    buffer_store_dwordx4 v[92:95], v31, s[16:19], s41 offen sc1
    v_cvt_pk_bf16_f32 v104, v240, v241
    v_cvt_pk_bf16_f32 v105, v242, v243
    v_cvt_pk_bf16_f32 v106, v244, v245
    v_cvt_pk_bf16_f32 v107, v246, v247
    v_pk_max_i16 v104, v104, 0
    v_pk_max_i16 v105, v105, 0
    v_pk_max_i16 v106, v106, 0
    v_pk_max_i16 v107, v107, 0
    buffer_store_dwordx4 v[104:107], v30, s[16:19], s42 offen sc1
    v_cvt_pk_bf16_f32 v108, v248, v249
    v_cvt_pk_bf16_f32 v109, v250, v251
    v_cvt_pk_bf16_f32 v110, v252, v253
    v_cvt_pk_bf16_f32 v111, v254, v255
    v_pk_max_i16 v108, v108, 0
    v_pk_max_i16 v109, v109, 0
    v_pk_max_i16 v110, v110, 0
    v_pk_max_i16 v111, v111, 0
    buffer_store_dwordx4 v[108:111], v31, s[16:19], s42 offen sc1
    s_lshl_b32 s52, s3, 10
    v_add_u32 v5, s52, v1
    v_add_u32 v13, 40960, v5
    ds_read_b128 v[224:227], v5 offset:0
    ds_read_b128 v[228:231], v5 offset:4096
    ds_read_b128 v[232:235], v5 offset:8192
    buffer_load_dwordx4 a[120:123], v1, s[16:19], s60 offen offset:2048 sc1
    ds_read_b128 v[236:239], v5 offset:12288
    ds_read_b128 v[240:243], v5 offset:16384
    ds_read_b128 v[244:247], v5 offset:20480
    v_mov_b32 v188, 0x3f803f80
    v_mov_b32 v189, 0x3f803f80
    buffer_load_dwordx4 a[132:135], v1, s[16:19], s60 offen offset:3072 sc1
    v_mov_b32 v190, 0x3f803f80
    v_mov_b32 v191, 0x3f803f80
    s_waitcnt lgkmcnt(5)
    v_mfma_f32_16x16x32_bf16 v[180:183], v[224:227], v[224:227], 0
    s_lshl_b32 s50, s56, 12
    s_add_u32 s60, s60, 4096
    v_add_u32 v76, s50, v5
    v_mfma_f32_16x16x32_bf16 v[184:187], v[188:191], v[224:227], 0
    ds_read_b128 v[224:227], v5 offset:24576
    s_waitcnt lgkmcnt(5)
    v_mfma_f32_16x16x32_bf16 v[180:183], v[228:231], v[228:231], v[180:183]
    v_lshrrev_b32 v252, 1, v3
    buffer_load_dwordx4 a[136:139], v1, s[16:19], s60 offen sc1
    v_lshlrev_b32 v252, 8, v252
    v_mfma_f32_16x16x32_bf16 v[184:187], v[188:191], v[228:231], v[184:187]
    ds_read_b128 v[228:231], v5 offset:28672
    s_waitcnt lgkmcnt(5)
    v_mfma_f32_16x16x32_bf16 v[180:183], v[232:235], v[232:235], v[180:183]
    s_cmp_le_i32 s9, 4
    s_cselect_b32 s61, s7, s3
    v_lshl_add_u32 v252, v2, 4, v252
    v_and_b32 v15, 1, v3
    v_mfma_f32_16x16x32_bf16 v[184:187], v[188:191], v[232:235], v[184:187]
    ds_read_b128 v[232:235], v5 offset:32768
    s_waitcnt lgkmcnt(5)
    s_add_u32 s61, s61, 4
    v_mfma_f32_16x16x32_bf16 v[180:183], v[236:239], v[236:239], v[180:183]
    v_lshl_add_u32 v77, v15, 3, v252
    v_mfma_f32_16x16x32_bf16 v[184:187], v[188:191], v[236:239], v[184:187]
    ds_read_b128 v[236:239], v5 offset:36864
    s_waitcnt lgkmcnt(5)
    v_mfma_f32_16x16x32_bf16 v[180:183], v[240:243], v[240:243], v[180:183]
    s_mul_i32 s60, s61, 5120
    s_lshl_b32 s50, s57, 12
    v_mfma_f32_16x16x32_bf16 v[184:187], v[188:191], v[240:243], v[184:187]
    ds_read_b128 v[240:243], v13 offset:0
    s_waitcnt lgkmcnt(5)
    v_mfma_f32_16x16x32_bf16 v[180:183], v[244:247], v[244:247], v[180:183]
    s_add_u32 s60, s60, s8
    s_add_u32 s50, s50, s52
    v_mfma_f32_16x16x32_bf16 v[184:187], v[188:191], v[244:247], v[184:187]
    ds_read_b128 v[244:247], v13 offset:4096
    s_waitcnt lgkmcnt(5)
    v_mfma_f32_16x16x32_bf16 v[180:183], v[224:227], v[224:227], v[180:183]
    buffer_load_dwordx4 a[140:143], v1, s[16:19], s60 offen sc1
    s_lshl_b32 s51, s58, 9
    v_mfma_f32_16x16x32_bf16 v[184:187], v[188:191], v[224:227], v[184:187]
    ds_read_b128 v[224:227], v13 offset:8192
    s_waitcnt lgkmcnt(5)
    v_mfma_f32_16x16x32_bf16 v[180:183], v[228:231], v[228:231], v[180:183]
    buffer_load_dwordx4 a[144:147], v1, s[16:19], s60 offen offset:1024 sc1
    v_mfma_f32_16x16x32_bf16 v[184:187], v[188:191], v[228:231], v[184:187]
    ds_read_b128 v[228:231], v13 offset:12288
    s_waitcnt lgkmcnt(5)
    v_mfma_f32_16x16x32_bf16 v[180:183], v[232:235], v[232:235], v[180:183]
    s_add_u32 s50, s50, s51
    v_mfma_f32_16x16x32_bf16 v[184:187], v[188:191], v[232:235], v[184:187]
    buffer_load_dwordx4 a[148:151], v1, s[16:19], s60 offen offset:2048 sc1
    ds_read_b128 v[232:235], v13 offset:16384
    s_waitcnt lgkmcnt(5)
    v_mfma_f32_16x16x32_bf16 v[180:183], v[236:239], v[236:239], v[180:183]
    v_add_u32 v77, s50, v77
    v_mfma_f32_16x16x32_bf16 v[184:187], v[188:191], v[236:239], v[184:187]
    buffer_load_dwordx4 a[168:171], v1, s[16:19], s60 offen offset:3072 sc1
    ds_read_b128 v[236:239], v13 offset:20480
    s_waitcnt lgkmcnt(5)
    v_mfma_f32_16x16x32_bf16 v[180:183], v[240:243], v[240:243], v[180:183]
    v_lshl_add_u32 v252, v15, 30, v252
    v_mfma_f32_16x16x32_bf16 v[184:187], v[188:191], v[240:243], v[184:187]
    s_add_u32 s60, s60, 4096
    ds_read_b128 v[240:243], v13 offset:24576
    s_waitcnt lgkmcnt(5)
    v_mfma_f32_16x16x32_bf16 v[180:183], v[244:247], v[244:247], v[180:183]
    v_and_b32 v78, 3, v2
    v_mfma_f32_16x16x32_bf16 v[184:187], v[188:191], v[244:247], v[184:187]
    ds_read_b128 v[244:247], v13 offset:28672
    buffer_load_dwordx4 a[124:127], v1, s[16:19], s60 offen sc1
    s_waitcnt lgkmcnt(5)
    v_mfma_f32_16x16x32_bf16 v[180:183], v[224:227], v[224:227], v[180:183]
    v_lshrrev_b32 v79, 2, v2
    v_mfma_f32_16x16x32_bf16 v[184:187], v[188:191], v[224:227], v[184:187]
    ds_read_b128 v[224:227], v13 offset:32768
    s_cmp_le_i32 s9, 8
    s_cselect_b32 s61, s7, s3
    s_waitcnt lgkmcnt(5)
    v_mfma_f32_16x16x32_bf16 v[180:183], v[228:231], v[228:231], v[180:183]
    v_lshl_add_u32 v79, v79, 4, v2
    v_mfma_f32_16x16x32_bf16 v[184:187], v[188:191], v[228:231], v[184:187]
    ds_read_b128 v[228:231], v13 offset:36864
    s_add_u32 s61, s61, 8
    s_waitcnt lgkmcnt(5)
    v_mfma_f32_16x16x32_bf16 v[180:183], v[232:235], v[232:235], v[180:183]
    v_lshlrev_b32 v79, 2, v79
    v_mfma_f32_16x16x32_bf16 v[184:187], v[188:191], v[232:235], v[184:187]
    s_mov_b32 s50, 0x3acccccd
    s_waitcnt lgkmcnt(4)
    s_mul_i32 s60, s61, 5120
    v_mfma_f32_16x16x32_bf16 v[180:183], v[236:239], v[236:239], v[180:183]
    v_mfma_f32_16x16x32_bf16 v[184:187], v[188:191], v[236:239], v[184:187]
    v_mov_b32 v254, 0x3727c5ac
    s_waitcnt lgkmcnt(3)
    v_mfma_f32_16x16x32_bf16 v[180:183], v[240:243], v[240:243], v[180:183]
    s_add_u32 s60, s60, s8
    v_mfma_f32_16x16x32_bf16 v[184:187], v[188:191], v[240:243], v[184:187]
    s_waitcnt lgkmcnt(2)
    v_mfma_f32_16x16x32_bf16 v[180:183], v[244:247], v[244:247], v[180:183]
    v_mfma_f32_16x16x32_bf16 v[184:187], v[188:191], v[244:247], v[184:187]
    s_waitcnt lgkmcnt(1)
    buffer_load_dwordx4 a[128:131], v1, s[16:19], s60 offen sc1
    v_mfma_f32_16x16x32_bf16 v[180:183], v[224:227], v[224:227], v[180:183]
    v_mfma_f32_16x16x32_bf16 v[184:187], v[188:191], v[224:227], v[184:187]
    s_waitcnt lgkmcnt(0)
    v_mfma_f32_16x16x32_bf16 v[180:183], v[228:231], v[228:231], v[180:183]
    v_mfma_f32_16x16x32_bf16 v[184:187], v[188:191], v[228:231], v[184:187]
    buffer_load_dwordx4 a[172:175], v1, s[16:19], s60 offen offset:1024 sc1
    s_bitcmp1_b32 s3, 0
    s_cbranch_scc0 nsw_m_66
    v_swap_b32 v80, v84
    v_swap_b32 v81, v85
    v_swap_b32 v82, v86
    v_swap_b32 v83, v87
    v_swap_b32 v88, v92
    v_swap_b32 v89, v93
    v_swap_b32 v90, v94
    v_swap_b32 v91, v95
    v_swap_b32 v96, v100
    v_swap_b32 v97, v101
    v_swap_b32 v98, v102
    v_swap_b32 v99, v103
    v_swap_b32 v104, v108
    v_swap_b32 v105, v109
    v_swap_b32 v106, v110
    v_swap_b32 v107, v111
nsw_m_66:
    s_bitcmp1_b32 s3, 1
    s_cbranch_scc0 nsw_m_67
    v_swap_b32 v80, v88
    v_swap_b32 v81, v89
    v_swap_b32 v82, v90
    v_swap_b32 v83, v91
    v_swap_b32 v84, v92
    v_swap_b32 v85, v93
    v_swap_b32 v86, v94
    v_swap_b32 v87, v95
    v_swap_b32 v96, v104
    v_swap_b32 v97, v105
    v_swap_b32 v98, v106
    v_swap_b32 v99, v107
    v_swap_b32 v100, v108
    v_swap_b32 v101, v109
    v_swap_b32 v102, v110
    v_swap_b32 v103, v111
nsw_m_67:
    s_add_u32 s55, s47, 6
    v_mov_b32 v248, s55
    v_mov_b32 v249, s46
    v_lshlrev_b32 v250, 25, v0
    s_waitcnt vmcnt(10)
    s_barrier
    buffer_store_dwordx2 v[248:249], v250, s[16:19], s43 offen sc0 sc1
    s_waitcnt vmcnt(26)
    v_mfma_f32_16x16x32_bf16 v[36:39], a[80:83], v[84:87], 0
    ds_read_b128 v[232:235], v76
    ds_read_b128 v[236:239], v76 offset:4096
    v_mfma_f32_16x16x32_bf16 v[40:43], a[84:87], v[84:87], 0
    buffer_load_dwordx4 a[176:179], v1, s[16:19], s60 offen offset:2048 sc1
    v_mfma_f32_16x16x32_bf16 v[44:47], a[104:107], v[84:87], 0
    buffer_load_dwordx4 a[180:183], v1, s[16:19], s60 offen offset:3072 sc1
    v_mfma_f32_16x16x32_bf16 v[48:51], a[60:63], v[84:87], 0
    s_add_u32 s60, s60, 4096
    ds_read_b64 v[240:241], v77
    v_mfma_f32_16x16x32_bf16 v[52:55], a[64:67], v[84:87], 0
    buffer_load_dwordx4 a[152:155], v1, s[16:19], s60 offen sc1
    v_mfma_f32_16x16x32_bf16 v[56:59], a[80:83], v[88:91], 0
    s_cmp_le_i32 s9, 12
    s_cselect_b32 s61, s7, s3
    v_mfma_f32_16x16x32_bf16 v[60:63], a[84:87], v[88:91], 0
    s_add_u32 s61, s61, 12
    v_mfma_f32_16x16x32_bf16 v[64:67], a[104:107], v[88:91], 0
    v_cmp_eq_u32 vcc, 1, v78
    s_nop 1
    v_cndmask_b32 v180, v180, v181, vcc
    v_mfma_f32_16x16x32_bf16 v[68:71], a[60:63], v[88:91], 0
    s_mul_i32 s60, s61, 5120
    s_add_u32 s60, s60, s8
    v_mfma_f32_16x16x32_bf16 v[72:75], a[64:67], v[88:91], 0
    buffer_load_dwordx4 a[156:159], v1, s[16:19], s60 offen sc1
    v_mfma_f32_16x16x32_bf16 v[160:163], a[80:83], v[92:95], 0
    buffer_load_dwordx4 a[160:163], v1, s[16:19], s60 offen offset:1024 sc1
    v_mfma_f32_16x16x32_bf16 v[164:167], a[84:87], v[92:95], 0
    buffer_load_dwordx4 a[164:167], v1, s[16:19], s60 offen offset:2048 sc1
    v_mfma_f32_16x16x32_bf16 v[168:171], a[104:107], v[92:95], 0
    v_cmp_eq_u32 vcc, 2, v78
    s_nop 1
    v_cndmask_b32 v180, v180, v182, vcc
    v_mfma_f32_16x16x32_bf16 v[172:175], a[60:63], v[92:95], 0
    buffer_load_dwordx4 a[184:187], v1, s[16:19], s60 offen offset:3072 sc1
    v_mfma_f32_16x16x32_bf16 v[176:179], a[64:67], v[92:95], 0
    s_add_u32 s60, s60, 4096
    v_mfma_f32_16x16x32_bf16 v[16:19], a[80:83], v[80:83], 0
    buffer_load_dwordx4 a[188:191], v1, s[16:19], s60 offen sc1
    v_mfma_f32_16x16x32_bf16 v[20:23], a[84:87], v[80:83], 0
    v_cmp_eq_u32 vcc, 3, v78
    s_nop 1
    v_cndmask_b32 v180, v180, v183, vcc
    v_mfma_f32_16x16x32_bf16 v[24:27], a[104:107], v[80:83], 0
    s_cmp_le_i32 s9, 16
    s_cselect_b32 s61, s7, s3
    v_mfma_f32_16x16x32_bf16 v[28:31], a[60:63], v[80:83], 0
    s_add_u32 s61, s61, 16
    s_mul_i32 s60, s61, 5120
    v_mfma_f32_16x16x32_bf16 v[32:35], a[64:67], v[80:83], 0
    s_add_u32 s60, s60, s8
    s_waitcnt vmcnt(29)
    v_mfma_f32_16x16x32_bf16 v[36:39], a[108:111], v[100:103], v[36:39]
    buffer_load_dwordx4 a[192:195], v1, s[16:19], s60 offen sc1
    v_mfma_f32_16x16x32_bf16 v[40:43], a[112:115], v[100:103], v[40:43]
    ds_bpermute_b32 v180, v79, v180
    v_mul_f32 v253, s50, v184
    v_mfma_f32_16x16x32_bf16 v[44:47], a[116:119], v[100:103], v[44:47]
    buffer_load_dwordx4 a[196:199], v1, s[16:19], s60 offen offset:1024 sc1
    v_mfma_f32_16x16x32_bf16 v[48:51], a[88:91], v[100:103], v[48:51]
    buffer_load_dwordx4 a[200:203], v1, s[16:19], s60 offen offset:2048 sc1
    v_mfma_f32_16x16x32_bf16 v[52:55], a[92:95], v[100:103], v[52:55]
    buffer_load_dwordx4 a[24:27], v1, s[16:19], s60 offen offset:3072 sc1
    v_mfma_f32_16x16x32_bf16 v[56:59], a[108:111], v[104:107], v[56:59]
    v_fma_f32 v253, -v253, v253, v254
    s_waitcnt lgkmcnt(0)
    v_mfma_f32_16x16x32_bf16 v[60:63], a[112:115], v[104:107], v[60:63]
    s_add_u32 s60, s60, 4096
    v_fma_f32 v180, v180, s50, v253
    v_mfma_f32_16x16x32_bf16 v[64:67], a[116:119], v[104:107], v[64:67]
    buffer_load_dwordx4 a[28:31], v1, s[16:19], s60 offen sc1
    v_mfma_f32_16x16x32_bf16 v[68:71], a[88:91], v[104:107], v[68:71]
    s_cmp_le_i32 s9, 40
    s_cselect_b32 s61, s7, s3
    v_mfma_f32_16x16x32_bf16 v[72:75], a[92:95], v[104:107], v[72:75]
    s_add_u32 s61, s61, 40
    v_max_f32 v180, v254, v180
    v_mfma_f32_16x16x32_bf16 v[160:163], a[108:111], v[108:111], v[160:163]
    s_mul_i32 s60, s61, 5120
    v_mfma_f32_16x16x32_bf16 v[164:167], a[112:115], v[108:111], v[164:167]
    s_add_u32 s60, s60, s8
    v_mfma_f32_16x16x32_bf16 v[168:171], a[116:119], v[108:111], v[168:171]
    buffer_load_dwordx4 a[56:59], v1, s[16:19], s60 offen sc1
    v_mfma_f32_16x16x32_bf16 v[172:175], a[88:91], v[108:111], v[172:175]
    buffer_load_dwordx4 a[68:71], v1, s[16:19], s60 offen offset:1024 sc1
    v_mfma_f32_16x16x32_bf16 v[176:179], a[92:95], v[108:111], v[176:179]
    buffer_load_dwordx4 a[72:75], v1, s[16:19], s60 offen offset:2048 sc1
    v_mfma_f32_16x16x32_bf16 v[16:19], a[108:111], v[96:99], v[16:19]
    v_rsq_f32 v242, v180
    v_mfma_f32_16x16x32_bf16 v[20:23], a[112:115], v[96:99], v[20:23]
    buffer_load_dwordx4 a[76:79], v1, s[16:19], s60 offen offset:3072 sc1
    v_mfma_f32_16x16x32_bf16 v[24:27], a[116:119], v[96:99], v[24:27]
    s_add_u32 s60, s60, 4096
    v_mfma_f32_16x16x32_bf16 v[28:31], a[88:91], v[96:99], v[28:31]
    buffer_load_dwordx4 v[192:195], v1, s[16:19], s60 offen sc1
    v_mfma_f32_16x16x32_bf16 v[32:35], a[92:95], v[96:99], v[32:35]
    buffer_load_dwordx2 v[250:251], v4, s[16:19], 0 offen sc1
    s_mov_b32 s55, 0
    s_add_u32 s54, s47, 6
    s_waitcnt vmcnt(0)
ploop_m_69:
    v_subrev_u32 v250, s54, v250
    v_xor_b32 v251, s46, v251
    v_lshl_or_b32 v250, v251, 3, v250
    v_and_b32 v251, -8, v251
    v_or_b32 v250, v250, v251
    v_cmp_le_u32 vcc, 2, v250
    s_add_u32 s55, s55, 1
    s_cmp_ge_u32 s55, 200000
    s_cbranch_scc1 pok_m_68
    s_nop 2
    s_cbranch_vccz pok_m_68
    s_sleep 1
    buffer_load_dwordx2 v[250:251], v4, s[16:19], 0 offen sc1
    s_waitcnt vmcnt(0)
    s_branch ploop_m_69
pok_m_68:
    s_cmp_le_i32 s9, 20
    s_cselect_b32 s49, s7, s3
    s_add_u32 s49, s49, 20
    s_lshl_b32 s48, s49, 10
    buffer_load_dwordx4 v[116:119], v7, s[16:19], s48 offen sc1
    buffer_load_dwordx4 v[120:123], v8, s[16:19], s48 offen sc1
    buffer_load_dwordx4 v[124:127], v9, s[16:19], s48 offen sc1
    buffer_load_dwordx4 v[112:115], v6, s[16:19], s48 offen sc1
    s_cmp_le_i32 s9, 24
    s_cselect_b32 s49, s7, s3
    s_add_u32 s49, s49, 24
    s_lshl_b32 s48, s49, 10
    buffer_load_dwordx4 v[132:135], v7, s[16:19], s48 offen sc1
    buffer_load_dwordx4 v[136:139], v8, s[16:19], s48 offen sc1
    buffer_load_dwordx4 v[140:143], v9, s[16:19], s48 offen sc1
    buffer_load_dwordx4 v[128:131], v6, s[16:19], s48 offen sc1
    s_cmp_le_i32 s9, 28
    s_cselect_b32 s49, s7, s3
    s_add_u32 s49, s49, 28
    s_lshl_b32 s48, s49, 10
    buffer_load_dwordx4 v[148:151], v7, s[16:19], s48 offen sc1
    buffer_load_dwordx4 v[152:155], v8, s[16:19], s48 offen sc1
    buffer_load_dwordx4 v[156:159], v9, s[16:19], s48 offen sc1
    buffer_load_dwordx4 v[144:147], v6, s[16:19], s48 offen sc1
    s_cmp_le_i32 s9, 32
    s_cselect_b32 s49, s7, s3
    s_add_u32 s49, s49, 32
    s_lshl_b32 s48, s49, 10
    buffer_load_dwordx4 v[84:87], v7, s[16:19], s48 offen sc1
    buffer_load_dwordx4 v[88:91], v8, s[16:19], s48 offen sc1
    buffer_load_dwordx4 v[92:95], v9, s[16:19], s48 offen sc1
    buffer_load_dwordx4 v[80:83], v6, s[16:19], s48 offen sc1
    s_waitcnt vmcnt(15)
    v_mfma_f32_16x16x32_bf16 v[36:39], a[204:207], v[116:119], v[36:39]
    s_cmp_le_i32 s9, 36
    s_cselect_b32 s49, s7, s3
    v_mfma_f32_16x16x32_bf16 v[40:43], a[208:211], v[116:119], v[40:43]
    s_cmp_le_i32 s9, 44
    s_cselect_b32 s61, s7, s3
    v_mfma_f32_16x16x32_bf16 v[44:47], a[212:215], v[116:119], v[44:47]
    s_add_u32 s61, s61, 44
    v_mfma_f32_16x16x32_bf16 v[48:51], a[224:227], v[116:119], v[48:51]
    s_add_u32 s49, s49, 36
    s_mul_i32 s60, s61, 5120
    v_mfma_f32_16x16x32_bf16 v[52:55], a[228:231], v[116:119], v[52:55]
    s_add_u32 s60, s60, s8
    s_waitcnt vmcnt(14)
    v_mfma_f32_16x16x32_bf16 v[56:59], a[204:207], v[120:123], v[56:59]
    s_lshl_b32 s48, s49, 10
    v_mfma_f32_16x16x32_bf16 v[60:63], a[208:211], v[120:123], v[60:63]
    s_cmp_ge_u32 s61, 54
    s_cselect_b32 s60, 1073741824, s60
    v_mfma_f32_16x16x32_bf16 v[64:67], a[212:215], v[120:123], v[64:67]
    buffer_load_dwordx4 v[100:103], v7, s[16:19], s48 offen sc1
    v_mfma_f32_16x16x32_bf16 v[68:71], a[224:227], v[120:123], v[68:71]
    buffer_load_dwordx4 v[196:199], v1, s[16:19], s60 offen sc1
    v_mfma_f32_16x16x32_bf16 v[72:75], a[228:231], v[120:123], v[72:75]
    s_waitcnt vmcnt(15)
    v_mfma_f32_16x16x32_bf16 v[160:163], a[204:207], v[124:127], v[160:163]
    buffer_load_dwordx4 v[104:107], v8, s[16:19], s48 offen sc1
    v_mfma_f32_16x16x32_bf16 v[164:167], a[208:211], v[124:127], v[164:167]
    buffer_load_dwordx4 v[200:203], v1, s[16:19], s60 offen offset:1024 sc1
    v_mfma_f32_16x16x32_bf16 v[168:171], a[212:215], v[124:127], v[168:171]
    buffer_load_dwordx4 v[204:207], v1, s[16:19], s60 offen offset:2048 sc1
    v_mfma_f32_16x16x32_bf16 v[172:175], a[224:227], v[124:127], v[172:175]
    buffer_load_dwordx4 v[108:111], v9, s[16:19], s48 offen sc1
    v_mfma_f32_16x16x32_bf16 v[176:179], a[228:231], v[124:127], v[176:179]
    s_waitcnt vmcnt(18)
    v_mfma_f32_16x16x32_bf16 v[16:19], a[204:207], v[112:115], v[16:19]
    buffer_load_dwordx4 v[208:211], v1, s[16:19], s60 offen offset:3072 sc1
    v_mfma_f32_16x16x32_bf16 v[20:23], a[208:211], v[112:115], v[20:23]
    buffer_load_dwordx4 v[96:99], v6, s[16:19], s48 offen sc1
    v_mfma_f32_16x16x32_bf16 v[24:27], a[212:215], v[112:115], v[24:27]
    s_add_u32 s60, s60, 4096
    v_mfma_f32_16x16x32_bf16 v[28:31], a[224:227], v[112:115], v[28:31]
    buffer_load_dwordx4 v[212:215], v1, s[16:19], s60 offen sc1
    v_mfma_f32_16x16x32_bf16 v[32:35], a[228:231], v[112:115], v[32:35]
    s_waitcnt vmcnt(20)
    v_mfma_f32_16x16x32_bf16 v[36:39], a[232:235], v[132:135], v[36:39]
    s_cmp_le_i32 s9, 0
    s_cselect_b32 s49, s7, s3
    v_mfma_f32_16x16x32_bf16 v[40:43], a[236:239], v[132:135], v[40:43]
    s_barrier
    v_mfma_f32_16x16x32_bf16 v[44:47], a[240:243], v[132:135], v[44:47]
    v_mfma_f32_16x16x32_bf16 v[48:51], a[244:247], v[132:135], v[48:51]
    s_lshl_b32 s48, s49, 10
    v_mfma_f32_16x16x32_bf16 v[52:55], a[216:219], v[132:135], v[52:55]
    s_waitcnt vmcnt(19)
    v_mfma_f32_16x16x32_bf16 v[56:59], a[232:235], v[136:139], v[56:59]
    buffer_load_dwordx4 v[116:119], v7, s[16:19], s48 offen sc1
    v_mfma_f32_16x16x32_bf16 v[60:63], a[236:239], v[136:139], v[60:63]
    v_mfma_f32_16x16x32_bf16 v[64:67], a[240:243], v[136:139], v[64:67]
    v_mfma_f32_16x16x32_bf16 v[68:71], a[244:247], v[136:139], v[68:71]
    v_mfma_f32_16x16x32_bf16 v[72:75], a[216:219], v[136:139], v[72:75]
    s_waitcnt vmcnt(19)
    v_mfma_f32_16x16x32_bf16 v[160:163], a[232:235], v[140:143], v[160:163]
    buffer_load_dwordx4 v[120:123], v8, s[16:19], s48 offen sc1
    v_mfma_f32_16x16x32_bf16 v[164:167], a[236:239], v[140:143], v[164:167]
    v_mfma_f32_16x16x32_bf16 v[168:171], a[240:243], v[140:143], v[168:171]
    buffer_load_dwordx4 v[124:127], v9, s[16:19], s48 offen sc1
    v_mfma_f32_16x16x32_bf16 v[172:175], a[244:247], v[140:143], v[172:175]
    v_mfma_f32_16x16x32_bf16 v[176:179], a[216:219], v[140:143], v[176:179]
    s_waitcnt vmcnt(20)
    v_mfma_f32_16x16x32_bf16 v[16:19], a[232:235], v[128:131], v[16:19]
    v_mfma_f32_16x16x32_bf16 v[20:23], a[236:239], v[128:131], v[20:23]
    buffer_load_dwordx4 v[112:115], v6, s[16:19], s48 offen sc1
    v_mfma_f32_16x16x32_bf16 v[24:27], a[240:243], v[128:131], v[24:27]
    v_mfma_f32_16x16x32_bf16 v[28:31], a[244:247], v[128:131], v[28:31]
    v_mfma_f32_16x16x32_bf16 v[32:35], a[216:219], v[128:131], v[32:35]
    s_waitcnt vmcnt(20)
    v_mfma_f32_16x16x32_bf16 v[36:39], a[220:223], v[148:151], v[36:39]
    s_cmp_le_i32 s9, 4
    s_cselect_b32 s49, s7, s3
    v_mfma_f32_16x16x32_bf16 v[40:43], a[248:251], v[148:151], v[40:43]
    v_mfma_f32_16x16x32_bf16 v[44:47], a[252:255], v[148:151], v[44:47]
    v_mfma_f32_16x16x32_bf16 v[48:51], a[0:3], v[148:151], v[48:51]
    s_add_u32 s49, s49, 4
    v_mfma_f32_16x16x32_bf16 v[52:55], a[4:7], v[148:151], v[52:55]
    s_waitcnt vmcnt(19)
    v_mfma_f32_16x16x32_bf16 v[56:59], a[220:223], v[152:155], v[56:59]
    s_lshl_b32 s48, s49, 10
    v_mfma_f32_16x16x32_bf16 v[60:63], a[248:251], v[152:155], v[60:63]
    buffer_load_dwordx4 v[132:135], v7, s[16:19], s48 offen sc1
    v_mfma_f32_16x16x32_bf16 v[64:67], a[252:255], v[152:155], v[64:67]
    v_mfma_f32_16x16x32_bf16 v[68:71], a[0:3], v[152:155], v[68:71]
    v_mfma_f32_16x16x32_bf16 v[72:75], a[4:7], v[152:155], v[72:75]
    s_waitcnt vmcnt(19)
    v_mfma_f32_16x16x32_bf16 v[160:163], a[220:223], v[156:159], v[160:163]
    buffer_load_dwordx4 v[136:139], v8, s[16:19], s48 offen sc1
    v_mfma_f32_16x16x32_bf16 v[164:167], a[248:251], v[156:159], v[164:167]
    v_mfma_f32_16x16x32_bf16 v[168:171], a[252:255], v[156:159], v[168:171]
    v_mfma_f32_16x16x32_bf16 v[172:175], a[0:3], v[156:159], v[172:175]
    buffer_load_dwordx4 v[140:143], v9, s[16:19], s48 offen sc1
    v_mfma_f32_16x16x32_bf16 v[176:179], a[4:7], v[156:159], v[176:179]
    s_waitcnt vmcnt(20)
    v_mfma_f32_16x16x32_bf16 v[16:19], a[220:223], v[144:147], v[16:19]
    v_mfma_f32_16x16x32_bf16 v[20:23], a[248:251], v[144:147], v[20:23]
    buffer_load_dwordx4 v[128:131], v6, s[16:19], s48 offen sc1
    v_mfma_f32_16x16x32_bf16 v[24:27], a[252:255], v[144:147], v[24:27]
    v_mfma_f32_16x16x32_bf16 v[28:31], a[0:3], v[144:147], v[28:31]
    v_mfma_f32_16x16x32_bf16 v[32:35], a[4:7], v[144:147], v[32:35]
    s_waitcnt vmcnt(20)
    v_mfma_f32_16x16x32_bf16 v[36:39], a[8:11], v[84:87], v[36:39]
    s_cmp_le_i32 s9, 8
    s_cselect_b32 s49, s7, s3
    v_mfma_f32_16x16x32_bf16 v[40:43], a[12:15], v[84:87], v[40:43]
    v_mfma_f32_16x16x32_bf16 v[44:47], a[16:19], v[84:87], v[44:47]
    v_mfma_f32_16x16x32_bf16 v[48:51], a[20:23], v[84:87], v[48:51]
    s_add_u32 s49, s49, 8
    v_mfma_f32_16x16x32_bf16 v[52:55], a[32:35], v[84:87], v[52:55]
    s_waitcnt vmcnt(19)
    v_mfma_f32_16x16x32_bf16 v[56:59], a[8:11], v[88:91], v[56:59]
    s_lshl_b32 s48, s49, 10
    v_mfma_f32_16x16x32_bf16 v[60:63], a[12:15], v[88:91], v[60:63]
    buffer_load_dwordx4 v[148:151], v7, s[16:19], s48 offen sc1
    v_mfma_f32_16x16x32_bf16 v[64:67], a[16:19], v[88:91], v[64:67]
    v_mfma_f32_16x16x32_bf16 v[68:71], a[20:23], v[88:91], v[68:71]
    v_mfma_f32_16x16x32_bf16 v[72:75], a[32:35], v[88:91], v[72:75]
    s_waitcnt vmcnt(19)
    v_mfma_f32_16x16x32_bf16 v[160:163], a[8:11], v[92:95], v[160:163]
    buffer_load_dwordx4 v[152:155], v8, s[16:19], s48 offen sc1
    v_mfma_f32_16x16x32_bf16 v[164:167], a[12:15], v[92:95], v[164:167]
    v_mfma_f32_16x16x32_bf16 v[168:171], a[16:19], v[92:95], v[168:171]
    v_mfma_f32_16x16x32_bf16 v[172:175], a[20:23], v[92:95], v[172:175]
    buffer_load_dwordx4 v[156:159], v9, s[16:19], s48 offen sc1
    v_mfma_f32_16x16x32_bf16 v[176:179], a[32:35], v[92:95], v[176:179]
    s_waitcnt vmcnt(20)
    v_mfma_f32_16x16x32_bf16 v[16:19], a[8:11], v[80:83], v[16:19]
    v_mfma_f32_16x16x32_bf16 v[20:23], a[12:15], v[80:83], v[20:23]
    buffer_load_dwordx4 v[144:147], v6, s[16:19], s48 offen sc1
    v_mfma_f32_16x16x32_bf16 v[24:27], a[16:19], v[80:83], v[24:27]
    v_mfma_f32_16x16x32_bf16 v[28:31], a[20:23], v[80:83], v[28:31]
    v_mfma_f32_16x16x32_bf16 v[32:35], a[32:35], v[80:83], v[32:35]
    s_waitcnt vmcnt(20)
    v_mfma_f32_16x16x32_bf16 v[36:39], a[36:39], v[100:103], v[36:39]
    s_cmp_le_i32 s9, 12
    s_cselect_b32 s49, s7, s3
    v_mfma_f32_16x16x32_bf16 v[40:43], a[40:43], v[100:103], v[40:43]
    v_mfma_f32_16x16x32_bf16 v[44:47], a[44:47], v[100:103], v[44:47]
    v_mfma_f32_16x16x32_bf16 v[48:51], a[48:51], v[100:103], v[48:51]
    s_add_u32 s49, s49, 12
    v_mfma_f32_16x16x32_bf16 v[52:55], a[52:55], v[100:103], v[52:55]
    s_waitcnt vmcnt(18)
    v_mfma_f32_16x16x32_bf16 v[56:59], a[36:39], v[104:107], v[56:59]
    s_lshl_b32 s48, s49, 10
    v_mfma_f32_16x16x32_bf16 v[60:63], a[40:43], v[104:107], v[60:63]
    buffer_load_dwordx4 v[84:87], v7, s[16:19], s48 offen sc1
    v_mfma_f32_16x16x32_bf16 v[64:67], a[44:47], v[104:107], v[64:67]
    v_mfma_f32_16x16x32_bf16 v[68:71], a[48:51], v[104:107], v[68:71]
    v_mfma_f32_16x16x32_bf16 v[72:75], a[52:55], v[104:107], v[72:75]
    s_waitcnt vmcnt(16)
    v_mfma_f32_16x16x32_bf16 v[160:163], a[36:39], v[108:111], v[160:163]
    buffer_load_dwordx4 v[88:91], v8, s[16:19], s48 offen sc1
    v_mfma_f32_16x16x32_bf16 v[164:167], a[40:43], v[108:111], v[164:167]
    v_mfma_f32_16x16x32_bf16 v[168:171], a[44:47], v[108:111], v[168:171]
    v_mfma_f32_16x16x32_bf16 v[172:175], a[48:51], v[108:111], v[172:175]
    buffer_load_dwordx4 v[92:95], v9, s[16:19], s48 offen sc1
    v_mfma_f32_16x16x32_bf16 v[176:179], a[52:55], v[108:111], v[176:179]
    s_waitcnt vmcnt(16)
    v_mfma_f32_16x16x32_bf16 v[16:19], a[36:39], v[96:99], v[16:19]
    v_mfma_f32_16x16x32_bf16 v[20:23], a[40:43], v[96:99], v[20:23]
    buffer_load_dwordx4 v[80:83], v6, s[16:19], s48 offen sc1
    v_mfma_f32_16x16x32_bf16 v[24:27], a[44:47], v[96:99], v[24:27]
    v_mfma_f32_16x16x32_bf16 v[28:31], a[48:51], v[96:99], v[28:31]
    v_mfma_f32_16x16x32_bf16 v[32:35], a[52:55], v[96:99], v[32:35]
    s_waitcnt vmcnt(15)
    v_mfma_f32_16x16x32_bf16 v[36:39], a[96:99], v[116:119], v[36:39]
    s_cmp_le_i32 s9, 16
    s_cselect_b32 s49, s7, s3
    v_mfma_f32_16x16x32_bf16 v[40:43], a[100:103], v[116:119], v[40:43]
    v_mfma_f32_16x16x32_bf16 v[44:47], a[120:123], v[116:119], v[44:47]
    v_mfma_f32_16x16x32_bf16 v[48:51], a[132:135], v[116:119], v[48:51]
    s_add_u32 s49, s49, 16
    v_mfma_f32_16x16x32_bf16 v[52:55], a[136:139], v[116:119], v[52:55]
    s_waitcnt vmcnt(14)
    v_mfma_f32_16x16x32_bf16 v[56:59], a[96:99], v[120:123], v[56:59]
    s_lshl_b32 s48, s49, 10
    v_mfma_f32_16x16x32_bf16 v[60:63], a[100:103], v[120:123], v[60:63]
    buffer_load_dwordx4 v[100:103], v7, s[16:19], s48 offen sc1
    v_mfma_f32_16x16x32_bf16 v[64:67], a[120:123], v[120:123], v[64:67]
    v_mfma_f32_16x16x32_bf16 v[68:71], a[132:135], v[120:123], v[68:71]
    v_mfma_f32_16x16x32_bf16 v[72:75], a[136:139], v[120:123], v[72:75]
    s_waitcnt vmcnt(14)
    v_mfma_f32_16x16x32_bf16 v[160:163], a[96:99], v[124:127], v[160:163]
    buffer_load_dwordx4 v[104:107], v8, s[16:19], s48 offen sc1
    v_mfma_f32_16x16x32_bf16 v[164:167], a[100:103], v[124:127], v[164:167]
    v_mfma_f32_16x16x32_bf16 v[168:171], a[120:123], v[124:127], v[168:171]
    v_mfma_f32_16x16x32_bf16 v[172:175], a[132:135], v[124:127], v[172:175]
    buffer_load_dwordx4 v[108:111], v9, s[16:19], s48 offen sc1
    v_mfma_f32_16x16x32_bf16 v[176:179], a[136:139], v[124:127], v[176:179]
    s_waitcnt vmcnt(15)
    v_mfma_f32_16x16x32_bf16 v[16:19], a[96:99], v[112:115], v[16:19]
    v_mfma_f32_16x16x32_bf16 v[20:23], a[100:103], v[112:115], v[20:23]
    buffer_load_dwordx4 v[96:99], v6, s[16:19], s48 offen sc1
    v_mfma_f32_16x16x32_bf16 v[24:27], a[120:123], v[112:115], v[24:27]
    v_mfma_f32_16x16x32_bf16 v[28:31], a[132:135], v[112:115], v[28:31]
    v_mfma_f32_16x16x32_bf16 v[32:35], a[136:139], v[112:115], v[32:35]
    s_waitcnt vmcnt(15)
    v_mfma_f32_16x16x32_bf16 v[36:39], a[140:143], v[132:135], v[36:39]
    s_cmp_le_i32 s9, 40
    s_cselect_b32 s49, s7, s3
    v_mfma_f32_16x16x32_bf16 v[40:43], a[144:147], v[132:135], v[40:43]
    v_mfma_f32_16x16x32_bf16 v[44:47], a[148:151], v[132:135], v[44:47]
    v_mfma_f32_16x16x32_bf16 v[48:51], a[168:171], v[132:135], v[48:51]
    s_add_u32 s49, s49, 40
    v_mfma_f32_16x16x32_bf16 v[52:55], a[124:127], v[132:135], v[52:55]
    s_waitcnt vmcnt(14)
    v_mfma_f32_16x16x32_bf16 v[56:59], a[140:143], v[136:139], v[56:59]
    s_lshl_b32 s48, s49, 10
    v_mfma_f32_16x16x32_bf16 v[60:63], a[144:147], v[136:139], v[60:63]
    buffer_load_dwordx4 v[116:119], v7, s[16:19], s48 offen sc1
    v_mfma_f32_16x16x32_bf16 v[64:67], a[148:151], v[136:139], v[64:67]
    v_mfma_f32_16x16x32_bf16 v[68:71], a[168:171], v[136:139], v[68:71]
    v_mfma_f32_16x16x32_bf16 v[72:75], a[124:127], v[136:139], v[72:75]
    s_waitcnt vmcnt(14)
    v_mfma_f32_16x16x32_bf16 v[160:163], a[140:143], v[140:143], v[160:163]
    buffer_load_dwordx4 v[120:123], v8, s[16:19], s48 offen sc1
    v_mfma_f32_16x16x32_bf16 v[164:167], a[144:147], v[140:143], v[164:167]
    v_mfma_f32_16x16x32_bf16 v[168:171], a[148:151], v[140:143], v[168:171]
    v_mfma_f32_16x16x32_bf16 v[172:175], a[168:171], v[140:143], v[172:175]
    buffer_load_dwordx4 v[124:127], v9, s[16:19], s48 offen sc1
    v_mfma_f32_16x16x32_bf16 v[176:179], a[124:127], v[140:143], v[176:179]
    s_waitcnt vmcnt(15)
    v_mfma_f32_16x16x32_bf16 v[16:19], a[140:143], v[128:131], v[16:19]
    v_mfma_f32_16x16x32_bf16 v[20:23], a[144:147], v[128:131], v[20:23]
    buffer_load_dwordx4 v[112:115], v6, s[16:19], s48 offen sc1
    v_mfma_f32_16x16x32_bf16 v[24:27], a[148:151], v[128:131], v[24:27]
    v_mfma_f32_16x16x32_bf16 v[28:31], a[168:171], v[128:131], v[28:31]
    v_mfma_f32_16x16x32_bf16 v[32:35], a[124:127], v[128:131], v[32:35]
    s_waitcnt vmcnt(15)
    v_mfma_f32_16x16x32_bf16 v[36:39], a[128:131], v[148:151], v[36:39]
    s_cmp_le_i32 s9, 44
    s_cselect_b32 s49, s7, s3
    v_mfma_f32_16x16x32_bf16 v[40:43], a[172:175], v[148:151], v[40:43]
    v_mfma_f32_16x16x32_bf16 v[44:47], a[176:179], v[148:151], v[44:47]
    s_add_u32 s49, s49, 44
    v_mfma_f32_16x16x32_bf16 v[48:51], a[180:183], v[148:151], v[48:51]
    v_mfma_f32_16x16x32_bf16 v[52:55], a[152:155], v[148:151], v[52:55]
    s_lshl_b32 s48, s49, 10
    s_waitcnt vmcnt(14)
    v_mfma_f32_16x16x32_bf16 v[56:59], a[128:131], v[152:155], v[56:59]
    s_cmp_ge_u32 s49, 54
    s_cselect_b32 s48, 1073741824, s48
    v_mfma_f32_16x16x32_bf16 v[60:63], a[172:175], v[152:155], v[60:63]
    v_mfma_f32_16x16x32_bf16 v[64:67], a[176:179], v[152:155], v[64:67]
    v_mfma_f32_16x16x32_bf16 v[68:71], a[180:183], v[152:155], v[68:71]
    buffer_load_dwordx4 v[132:135], v7, s[16:19], s48 offen sc1
    v_mfma_f32_16x16x32_bf16 v[72:75], a[152:155], v[152:155], v[72:75]
    s_waitcnt vmcnt(14)
    v_mfma_f32_16x16x32_bf16 v[160:163], a[128:131], v[156:159], v[160:163]
    v_mfma_f32_16x16x32_bf16 v[164:167], a[172:175], v[156:159], v[164:167]
    buffer_load_dwordx4 v[136:139], v8, s[16:19], s48 offen sc1
    v_mfma_f32_16x16x32_bf16 v[168:171], a[176:179], v[156:159], v[168:171]
    v_mfma_f32_16x16x32_bf16 v[172:175], a[180:183], v[156:159], v[172:175]
    v_mfma_f32_16x16x32_bf16 v[176:179], a[152:155], v[156:159], v[176:179]
    s_waitcnt vmcnt(14)
    v_mfma_f32_16x16x32_bf16 v[16:19], a[128:131], v[144:147], v[16:19]
    buffer_load_dwordx4 v[140:143], v9, s[16:19], s48 offen sc1
    v_mfma_f32_16x16x32_bf16 v[20:23], a[172:175], v[144:147], v[20:23]
    v_mfma_f32_16x16x32_bf16 v[24:27], a[176:179], v[144:147], v[24:27]
    buffer_load_dwordx4 v[128:131], v6, s[16:19], s48 offen sc1
    v_mfma_f32_16x16x32_bf16 v[28:31], a[180:183], v[144:147], v[28:31]
    v_mfma_f32_16x16x32_bf16 v[32:35], a[152:155], v[144:147], v[32:35]
    s_waitcnt vmcnt(15)
    v_mfma_f32_16x16x32_bf16 v[36:39], a[156:159], v[84:87], v[36:39]
    v_mfma_f32_16x16x32_bf16 v[40:43], a[160:163], v[84:87], v[40:43]
    v_mfma_f32_16x16x32_bf16 v[44:47], a[164:167], v[84:87], v[44:47]
    v_mfma_f32_16x16x32_bf16 v[48:51], a[184:187], v[84:87], v[48:51]
    v_mfma_f32_16x16x32_bf16 v[52:55], a[188:191], v[84:87], v[52:55]
    s_waitcnt vmcnt(14)
    v_mfma_f32_16x16x32_bf16 v[56:59], a[156:159], v[88:91], v[56:59]
    v_mfma_f32_16x16x32_bf16 v[60:63], a[160:163], v[88:91], v[60:63]
    v_mfma_f32_16x16x32_bf16 v[64:67], a[164:167], v[88:91], v[64:67]
    v_mfma_f32_16x16x32_bf16 v[68:71], a[184:187], v[88:91], v[68:71]
    v_mfma_f32_16x16x32_bf16 v[72:75], a[188:191], v[88:91], v[72:75]
    s_waitcnt vmcnt(13)
    v_mfma_f32_16x16x32_bf16 v[160:163], a[156:159], v[92:95], v[160:163]
    v_mfma_f32_16x16x32_bf16 v[164:167], a[160:163], v[92:95], v[164:167]
    v_mfma_f32_16x16x32_bf16 v[168:171], a[164:167], v[92:95], v[168:171]
    v_mfma_f32_16x16x32_bf16 v[172:175], a[184:187], v[92:95], v[172:175]
    v_mfma_f32_16x16x32_bf16 v[176:179], a[188:191], v[92:95], v[176:179]
    s_waitcnt vmcnt(12)
    v_mfma_f32_16x16x32_bf16 v[16:19], a[156:159], v[80:83], v[16:19]
    v_mfma_f32_16x16x32_bf16 v[20:23], a[160:163], v[80:83], v[20:23]
    v_mfma_f32_16x16x32_bf16 v[24:27], a[164:167], v[80:83], v[24:27]
    v_mfma_f32_16x16x32_bf16 v[28:31], a[184:187], v[80:83], v[28:31]
    v_mfma_f32_16x16x32_bf16 v[32:35], a[188:191], v[80:83], v[32:35]
    s_waitcnt vmcnt(11)
    v_mfma_f32_16x16x32_bf16 v[36:39], a[192:195], v[100:103], v[36:39]
    v_lshlrev_b32 v77, 7, v2
    v_add_u32 v77, s59, v77
    v_mfma_f32_16x16x32_bf16 v[40:43], a[196:199], v[100:103], v[40:43]
    v_mul_u32_u24 v77, 1280, v77
    s_add_u32 s52, s56, 0
    v_mfma_f32_16x16x32_bf16 v[44:47], a[200:203], v[100:103], v[44:47]
    s_lshr_b32 s48, s52, 1
    s_lshl_b32 s48, s48, 7
    v_mfma_f32_16x16x32_bf16 v[48:51], a[24:27], v[100:103], v[48:51]
    s_and_b32 s52, s52, 1
    s_lshl_b32 s52, s52, 4
    v_mfma_f32_16x16x32_bf16 v[52:55], a[28:31], v[100:103], v[52:55]
    s_add_u32 s48, s48, s52
    s_waitcnt vmcnt(7)
    v_mfma_f32_16x16x32_bf16 v[36:39], a[56:59], v[116:119], v[36:39]
    s_add_u32 s52, s56, 1
    s_lshr_b32 s49, s52, 1
    v_mfma_f32_16x16x32_bf16 v[40:43], a[68:71], v[116:119], v[40:43]
    s_lshl_b32 s49, s49, 7
    s_and_b32 s52, s52, 1
    v_mfma_f32_16x16x32_bf16 v[44:47], a[72:75], v[116:119], v[44:47]
    s_lshl_b32 s52, s52, 4
    s_add_u32 s49, s49, s52
    v_mfma_f32_16x16x32_bf16 v[48:51], a[76:79], v[116:119], v[48:51]
    s_add_u32 s52, s57, 0
    s_lshr_b32 s50, s52, 1
    v_mfma_f32_16x16x32_bf16 v[52:55], v[192:195], v[116:119], v[52:55]
    s_lshl_b32 s50, s50, 7
    s_waitcnt vmcnt(3)
    v_mfma_f32_16x16x32_bf16 v[36:39], v[196:199], v[132:135], v[36:39]
    s_and_b32 s52, s52, 1
    s_lshl_b32 s52, s52, 4
    v_mfma_f32_16x16x32_bf16 v[40:43], v[200:203], v[132:135], v[40:43]
    s_add_u32 s50, s50, s52
    s_lshl_b32 s52, s58, 6
    v_mfma_f32_16x16x32_bf16 v[44:47], v[204:207], v[132:135], v[44:47]
    s_add_u32 s50, s50, s52
    v_lshl_add_u32 v76, v3, 5, v77
    v_mfma_f32_16x16x32_bf16 v[48:51], v[208:211], v[132:135], v[48:51]
    v_lshrrev_b32 v252, 1, v3
    v_lshl_add_u32 v252, v252, 5, v77
    v_mfma_f32_16x16x32_bf16 v[52:55], v[212:215], v[132:135], v[52:55]
    v_lshl_add_u32 v252, v15, 30, v252
    s_waitcnt vmcnt(10)
    v_mfma_f32_16x16x32_bf16 v[56:59], a[192:195], v[104:107], v[56:59]
    v_mfma_f32_16x16x32_bf16 v[60:63], a[196:199], v[104:107], v[60:63]
    v_mfma_f32_16x16x32_bf16 v[64:67], a[200:203], v[104:107], v[64:67]
    v_mfma_f32_16x16x32_bf16 v[68:71], a[24:27], v[104:107], v[68:71]
    v_mfma_f32_16x16x32_bf16 v[72:75], a[28:31], v[104:107], v[72:75]
    s_waitcnt vmcnt(6)
    v_mfma_f32_16x16x32_bf16 v[56:59], a[56:59], v[120:123], v[56:59]
    v_mfma_f32_16x16x32_bf16 v[60:63], a[68:71], v[120:123], v[60:63]
    ds_write_b128 v11, v[36:39] offset:0
    v_mfma_f32_16x16x32_bf16 v[64:67], a[72:75], v[120:123], v[64:67]
    v_mfma_f32_16x16x32_bf16 v[68:71], a[76:79], v[120:123], v[68:71]
    ds_write_b128 v11, v[40:43] offset:1024
    v_mfma_f32_16x16x32_bf16 v[72:75], v[192:195], v[120:123], v[72:75]
    s_waitcnt vmcnt(2)
    v_mfma_f32_16x16x32_bf16 v[56:59], v[196:199], v[136:139], v[56:59]
    ds_write_b128 v11, v[44:47] offset:2048
    v_mfma_f32_16x16x32_bf16 v[60:63], v[200:203], v[136:139], v[60:63]
    v_mfma_f32_16x16x32_bf16 v[64:67], v[204:207], v[136:139], v[64:67]
    ds_write_b128 v11, v[48:51] offset:3072
    v_mfma_f32_16x16x32_bf16 v[68:71], v[208:211], v[136:139], v[68:71]
    v_mfma_f32_16x16x32_bf16 v[72:75], v[212:215], v[136:139], v[72:75]
    ds_write_b128 v11, v[52:55] offset:4096
    s_waitcnt vmcnt(9)
    v_mfma_f32_16x16x32_bf16 v[160:163], a[192:195], v[108:111], v[160:163]
    v_mfma_f32_16x16x32_bf16 v[164:167], a[196:199], v[108:111], v[164:167]
    v_mfma_f32_16x16x32_bf16 v[168:171], a[200:203], v[108:111], v[168:171]
    v_mfma_f32_16x16x32_bf16 v[172:175], a[24:27], v[108:111], v[172:175]
    v_mfma_f32_16x16x32_bf16 v[176:179], a[28:31], v[108:111], v[176:179]
    s_waitcnt vmcnt(5)
    v_mfma_f32_16x16x32_bf16 v[160:163], a[56:59], v[124:127], v[160:163]
    v_mfma_f32_16x16x32_bf16 v[164:167], a[68:71], v[124:127], v[164:167]
    ds_write_b128 v12, v[56:59] offset:0
    v_mfma_f32_16x16x32_bf16 v[168:171], a[72:75], v[124:127], v[168:171]
    v_mfma_f32_16x16x32_bf16 v[172:175], a[76:79], v[124:127], v[172:175]
    ds_write_b128 v12, v[60:63] offset:1024
    v_mfma_f32_16x16x32_bf16 v[176:179], v[192:195], v[124:127], v[176:179]
    s_waitcnt vmcnt(1)
    v_mfma_f32_16x16x32_bf16 v[160:163], v[196:199], v[140:143], v[160:163]
    ds_write_b128 v12, v[64:67] offset:2048
    v_mfma_f32_16x16x32_bf16 v[164:167], v[200:203], v[140:143], v[164:167]
    v_mfma_f32_16x16x32_bf16 v[168:171], v[204:207], v[140:143], v[168:171]
    ds_write_b128 v12, v[68:71] offset:3072
    v_mfma_f32_16x16x32_bf16 v[172:175], v[208:211], v[140:143], v[172:175]
    v_mfma_f32_16x16x32_bf16 v[176:179], v[212:215], v[140:143], v[176:179]
    ds_write_b128 v12, v[72:75] offset:4096
    s_waitcnt vmcnt(8)
    v_mfma_f32_16x16x32_bf16 v[16:19], a[192:195], v[96:99], v[16:19]
    v_mfma_f32_16x16x32_bf16 v[20:23], a[196:199], v[96:99], v[20:23]
    v_mfma_f32_16x16x32_bf16 v[24:27], a[200:203], v[96:99], v[24:27]
    v_mfma_f32_16x16x32_bf16 v[28:31], a[24:27], v[96:99], v[28:31]
    v_mfma_f32_16x16x32_bf16 v[32:35], a[28:31], v[96:99], v[32:35]
    s_waitcnt vmcnt(4)
    v_mfma_f32_16x16x32_bf16 v[16:19], a[56:59], v[112:115], v[16:19]
    v_mfma_f32_16x16x32_bf16 v[20:23], a[68:71], v[112:115], v[20:23]
    ds_write_b128 v14, v[160:163] offset:0
    v_mfma_f32_16x16x32_bf16 v[24:27], a[72:75], v[112:115], v[24:27]
    v_mfma_f32_16x16x32_bf16 v[28:31], a[76:79], v[112:115], v[28:31]
    ds_write_b128 v14, v[164:167] offset:1024
    v_mfma_f32_16x16x32_bf16 v[32:35], v[192:195], v[112:115], v[32:35]
    s_waitcnt vmcnt(0)
    v_mfma_f32_16x16x32_bf16 v[16:19], v[196:199], v[128:131], v[16:19]
    ds_write_b128 v14, v[168:171] offset:2048
    v_mfma_f32_16x16x32_bf16 v[20:23], v[200:203], v[128:131], v[20:23]
    v_mfma_f32_16x16x32_bf16 v[24:27], v[204:207], v[128:131], v[24:27]
    ds_write_b128 v14, v[172:175] offset:3072
    v_mfma_f32_16x16x32_bf16 v[28:31], v[208:211], v[128:131], v[28:31]
    v_mfma_f32_16x16x32_bf16 v[32:35], v[212:215], v[128:131], v[32:35]
    ds_write_b128 v14, v[176:179] offset:4096
    v_lshlrev_b32 v192, 16, v232
    v_and_b32 v193, s10, v232
    v_lshlrev_b32 v194, 16, v233
    v_and_b32 v195, s10, v233
    v_lshlrev_b32 v196, 16, v234
    v_and_b32 v197, s10, v234
    v_lshlrev_b32 v198, 16, v235
    v_and_b32 v199, s10, v235
    v_lshlrev_b32 v200, 16, v236
    v_and_b32 v201, s10, v236
    v_lshlrev_b32 v202, 16, v237
    v_and_b32 v203, s10, v237
    v_lshlrev_b32 v204, 16, v238
    v_and_b32 v205, s10, v238
    v_lshlrev_b32 v206, 16, v239
    v_and_b32 v207, s10, v239
    v_lshlrev_b32 v208, 16, v240
    v_and_b32 v209, s10, v240
    v_lshlrev_b32 v210, 16, v241
    v_and_b32 v211, s10, v241
    s_waitcnt lgkmcnt(0)
    s_barrier
    ds_read_b128 v[80:83], v10 offset:0
    ds_read_b128 v[84:87], v10 offset:5120
    ds_read_b128 v[88:91], v10 offset:10240
    ds_read_b128 v[92:95], v10 offset:1024
    ds_read_b128 v[96:99], v10 offset:6144
    ds_read_b128 v[100:103], v10 offset:11264
    ds_read_b128 v[104:107], v10 offset:2048
    ds_read_b128 v[108:111], v10 offset:7168
    ds_read_b128 v[112:115], v10 offset:12288
    ds_read_b128 v[116:119], v10 offset:3072
    ds_read_b128 v[120:123], v10 offset:8192
    ds_read_b128 v[124:127], v10 offset:13312
    ds_read_b128 v[128:131], v10 offset:4096
    ds_read_b128 v[132:135], v10 offset:9216
    ds_read_b128 v[136:139], v10 offset:14336
    s_waitcnt lgkmcnt(12)
    v_pk_add_f32 v[80:81], v[80:81], v[84:85]
    v_pk_add_f32 v[16:17], v[16:17], v[88:89]
    v_pk_add_f32 v[82:83], v[82:83], v[86:87]
    v_pk_add_f32 v[18:19], v[18:19], v[90:91]
    v_pk_add_f32 v[16:17], v[16:17], v[80:81]
    v_pk_add_f32 v[18:19], v[18:19], v[82:83]
    v_fmac_f32 v192, v242, v16
    v_fmac_f32 v193, v242, v17
    v_fmac_f32 v194, v242, v18
    v_fmac_f32 v195, v242, v19
    v_cvt_pk_bf16_f32 v36, v192, v193
    v_cvt_pk_bf16_f32 v37, v194, v195
    s_waitcnt lgkmcnt(9)
    v_pk_add_f32 v[92:93], v[92:93], v[96:97]
    v_pk_add_f32 v[20:21], v[20:21], v[100:101]
    v_pk_add_f32 v[94:95], v[94:95], v[98:99]
    v_pk_add_f32 v[22:23], v[22:23], v[102:103]
    v_pk_add_f32 v[20:21], v[20:21], v[92:93]
    v_pk_add_f32 v[22:23], v[22:23], v[94:95]
    v_fmac_f32 v196, v242, v20
    v_fmac_f32 v197, v242, v21
    v_fmac_f32 v198, v242, v22
    v_fmac_f32 v199, v242, v23
    v_cvt_pk_bf16_f32 v38, v196, v197
    v_cvt_pk_bf16_f32 v39, v198, v199
    buffer_store_dwordx4 v[36:39], v76, s[24:27], s48 offen
    s_waitcnt lgkmcnt(6)
    v_pk_add_f32 v[104:105], v[104:105], v[108:109]
    v_pk_add_f32 v[24:25], v[24:25], v[112:113]
    v_pk_add_f32 v[106:107], v[106:107], v[110:111]
    v_pk_add_f32 v[26:27], v[26:27], v[114:115]
    v_pk_add_f32 v[24:25], v[24:25], v[104:105]
    v_pk_add_f32 v[26:27], v[26:27], v[106:107]
    v_fmac_f32 v200, v242, v24
    v_fmac_f32 v201, v242, v25
    v_fmac_f32 v202, v242, v26
    v_fmac_f32 v203, v242, v27
    v_cvt_pk_bf16_f32 v40, v200, v201
    v_cvt_pk_bf16_f32 v41, v202, v203
    s_waitcnt lgkmcnt(3)
    v_pk_add_f32 v[116:117], v[116:117], v[120:121]
    v_pk_add_f32 v[28:29], v[28:29], v[124:125]
    v_pk_add_f32 v[118:119], v[118:119], v[122:123]
    v_pk_add_f32 v[30:31], v[30:31], v[126:127]
    v_pk_add_f32 v[28:29], v[28:29], v[116:117]
    v_pk_add_f32 v[30:31], v[30:31], v[118:119]
    v_fmac_f32 v204, v242, v28
    v_fmac_f32 v205, v242, v29
    v_fmac_f32 v206, v242, v30
    v_fmac_f32 v207, v242, v31
    v_cvt_pk_bf16_f32 v42, v204, v205
    v_cvt_pk_bf16_f32 v43, v206, v207
    buffer_store_dwordx4 v[40:43], v76, s[24:27], s49 offen
    s_waitcnt lgkmcnt(0)
    v_pk_add_f32 v[128:129], v[128:129], v[132:133]
    v_pk_add_f32 v[32:33], v[32:33], v[136:137]
    v_pk_add_f32 v[130:131], v[130:131], v[134:135]
    v_pk_add_f32 v[34:35], v[34:35], v[138:139]
    v_pk_add_f32 v[32:33], v[32:33], v[128:129]
    v_pk_add_f32 v[34:35], v[34:35], v[130:131]
    v_fmac_f32 v208, v242, v32
    v_fmac_f32 v209, v242, v33
    v_fmac_f32 v210, v242, v34
    v_fmac_f32 v211, v242, v35
    v_cvt_pk_bf16_f32 v44, v208, v209
    v_cvt_pk_bf16_f32 v45, v210, v211
    v_mov_b32 v46, v44
    v_mov_b32 v47, v45
    v_mov_b32 v48, v44
    v_mov_b32 v49, v45
    s_nop 0
    v_permlane16_swap_b32 v48, v46
    v_permlane16_swap_b32 v49, v47
    buffer_store_dwordx4 v[44:47], v252, s[24:27], s50 offen
    s_endpgm
vrt_m_25:
    s_mov_b32 s55, 0
    s_add_u32 s54, s59, 0
vlp_m_27:
    s_sleep 1
    buffer_load_dwordx4 v[32:35], v4, s[16:19], s54 offen sc1
    buffer_load_dwordx4 v[36:39], v4, s[16:19], s54 offen offset:1280 sc1
    buffer_load_dwordx4 v[40:43], v4, s[16:19], s54 offen offset:2560 sc1
    buffer_load_dwordx4 v[44:47], v4, s[16:19], s54 offen offset:3840 sc1
    buffer_load_dword v8, v6, s[16:19], s59 offen sc1
    s_add_u32 s55, s55, 1
    s_waitcnt vmcnt(0)
    v_max3_u32 v28, v32, v36, v40
    v_max3_u32 v28, v28, v44, v8
    v_cmp_eq_u32 vcc, -1, v28
    s_cmp_ge_u32 s55, 20000
    s_cbranch_scc1 vbk_m_26
    s_nop 1
    s_cbranch_vccnz vlp_m_27
    s_branch vbk_m_26
vrt_m_28:
    s_mov_b32 s55, 0
    s_add_u32 s54, s59, 256
vlp_m_30:
    s_sleep 1
    buffer_load_dwordx4 v[48:51], v4, s[16:19], s54 offen sc1
    buffer_load_dwordx4 v[52:55], v4, s[16:19], s54 offen offset:1280 sc1
    buffer_load_dwordx4 v[56:59], v4, s[16:19], s54 offen offset:2560 sc1
    buffer_load_dwordx4 v[60:63], v4, s[16:19], s54 offen offset:3840 sc1
    buffer_load_dword v8, v6, s[16:19], s59 offen sc1
    s_add_u32 s55, s55, 1
    s_waitcnt vmcnt(0)
    v_max3_u32 v28, v48, v52, v56
    v_max3_u32 v28, v28, v60, v8
    v_cmp_eq_u32 vcc, -1, v28
    s_cmp_ge_u32 s55, 20000
    s_cbranch_scc1 vbk_m_29
    s_nop 1
    s_cbranch_vccnz vlp_m_30
    s_branch vbk_m_29
vrt_m_31:
    s_mov_b32 s55, 0
    s_add_u32 s54, s59, 512
vlp_m_33:
    s_sleep 1
    buffer_load_dwordx4 v[64:67], v4, s[16:19], s54 offen sc1
    buffer_load_dwordx4 v[68:71], v4, s[16:19], s54 offen offset:1280 sc1
    buffer_load_dwordx4 v[72:75], v4, s[16:19], s54 offen offset:2560 sc1
    buffer_load_dwordx4 v[76:79], v4, s[16:19], s54 offen offset:3840 sc1
    buffer_load_dword v8, v6, s[16:19], s59 offen sc1
    s_add_u32 s55, s55, 1
    s_waitcnt vmcnt(0)
    v_max3_u32 v28, v64, v68, v72
    v_max3_u32 v28, v28, v76, v8
    v_cmp_eq_u32 vcc, -1, v28
    s_cmp_ge_u32 s55, 20000
    s_cbranch_scc1 vbk_m_32
    s_nop 1
    s_cbranch_vccnz vlp_m_33
    s_branch vbk_m_32
vrt_m_34:
    s_mov_b32 s55, 0
    s_add_u32 s54, s59, 768
vlp_m_36:
    s_sleep 1
    buffer_load_dwordx4 v[80:83], v4, s[16:19], s54 offen sc1
    buffer_load_dwordx4 v[84:87], v4, s[16:19], s54 offen offset:1280 sc1
    buffer_load_dwordx4 v[88:91], v4, s[16:19], s54 offen offset:2560 sc1
    buffer_load_dwordx4 v[92:95], v4, s[16:19], s54 offen offset:3840 sc1
    buffer_load_dword v8, v6, s[16:19], s59 offen sc1
    s_add_u32 s55, s55, 1
    s_waitcnt vmcnt(0)
    v_max3_u32 v28, v80, v84, v88
    v_max3_u32 v28, v28, v92, v8
    v_cmp_eq_u32 vcc, -1, v28
    s_cmp_ge_u32 s55, 20000
    s_cbranch_scc1 vbk_m_35
    s_nop 1
    s_cbranch_vccnz vlp_m_36
    s_branch vbk_m_35
vrt_m_39:
    s_mov_b32 s55, 0
    s_add_u32 s54, s59, 1024
vlp_m_41:
    s_sleep 1
    buffer_load_dwordx4 v[96:99], v4, s[16:19], s54 offen sc1
    buffer_load_dwordx4 v[100:103], v4, s[16:19], s54 offen offset:1280 sc1
    buffer_load_dwordx4 v[104:107], v4, s[16:19], s54 offen offset:2560 sc1
    buffer_load_dwordx4 v[108:111], v4, s[16:19], s54 offen offset:3840 sc1
    buffer_load_dword v9, v7, s[16:19], s59 offen sc1
    s_add_u32 s55, s55, 1
    s_waitcnt vmcnt(0)
    v_max3_u32 v28, v96, v100, v104
    v_max3_u32 v28, v28, v108, v9
    v_cmp_eq_u32 vcc, -1, v28
    s_cmp_ge_u32 s55, 20000
    s_cbranch_scc1 vbk_m_40
    s_nop 1
    s_cbranch_vccnz vlp_m_41
    s_branch vbk_m_40
vrt_m_51:
    s_mov_b32 s55, 0
    s_add_u32 s54, s59, 0
vlp_m_53:
    s_sleep 1
    buffer_load_dwordx4 v[32:35], v4, s[16:19], s54 offen sc1
    buffer_load_dwordx4 v[36:39], v4, s[16:19], s54 offen offset:1280 sc1
    buffer_load_dwordx4 v[40:43], v4, s[16:19], s54 offen offset:2560 sc1
    buffer_load_dwordx4 v[44:47], v4, s[16:19], s54 offen offset:3840 sc1
    buffer_load_dword v8, v6, s[16:19], s59 offen sc1
    s_add_u32 s55, s55, 1
    s_waitcnt vmcnt(0)
    v_max3_u32 v28, v32, v36, v40
    v_max3_u32 v28, v28, v44, v8
    v_cmp_eq_u32 vcc, -1, v28
    s_cmp_ge_u32 s55, 20000
    s_cbranch_scc1 vbk_m_52
    s_nop 1
    s_cbranch_vccnz vlp_m_53
    s_branch vbk_m_52
vrt_m_54:
    s_mov_b32 s55, 0
    s_add_u32 s54, s59, 256
vlp_m_56:
    s_sleep 1
    buffer_load_dwordx4 v[48:51], v4, s[16:19], s54 offen sc1
    buffer_load_dwordx4 v[52:55], v4, s[16:19], s54 offen offset:1280 sc1
    buffer_load_dwordx4 v[56:59], v4, s[16:19], s54 offen offset:2560 sc1
    buffer_load_dwordx4 v[60:63], v4, s[16:19], s54 offen offset:3840 sc1
    buffer_load_dword v8, v6, s[16:19], s59 offen sc1
    s_add_u32 s55, s55, 1
    s_waitcnt vmcnt(0)
    v_max3_u32 v28, v48, v52, v56
    v_max3_u32 v28, v28, v60, v8
    v_cmp_eq_u32 vcc, -1, v28
    s_cmp_ge_u32 s55, 20000
    s_cbranch_scc1 vbk_m_55
    s_nop 1
    s_cbranch_vccnz vlp_m_56
    s_branch vbk_m_55
vrt_m_57:
    s_mov_b32 s55, 0
    s_add_u32 s54, s59, 512
vlp_m_59:
    s_sleep 1
    buffer_load_dwordx4 v[64:67], v4, s[16:19], s54 offen sc1
    buffer_load_dwordx4 v[68:71], v4, s[16:19], s54 offen offset:1280 sc1
    buffer_load_dwordx4 v[72:75], v4, s[16:19], s54 offen offset:2560 sc1
    buffer_load_dwordx4 v[76:79], v4, s[16:19], s54 offen offset:3840 sc1
    buffer_load_dword v8, v6, s[16:19], s59 offen sc1
    s_add_u32 s55, s55, 1
    s_waitcnt vmcnt(0)
    v_max3_u32 v28, v64, v68, v72
    v_max3_u32 v28, v28, v76, v8
    v_cmp_eq_u32 vcc, -1, v28
    s_cmp_ge_u32 s55, 20000
    s_cbranch_scc1 vbk_m_58
    s_nop 1
    s_cbranch_vccnz vlp_m_59
    s_branch vbk_m_58
vrt_m_60:
    s_mov_b32 s55, 0
    s_add_u32 s54, s59, 768
vlp_m_62:
    s_sleep 1
    buffer_load_dwordx4 v[80:83], v4, s[16:19], s54 offen sc1
    buffer_load_dwordx4 v[84:87], v4, s[16:19], s54 offen offset:1280 sc1
    buffer_load_dwordx4 v[88:91], v4, s[16:19], s54 offen offset:2560 sc1
    buffer_load_dwordx4 v[92:95], v4, s[16:19], s54 offen offset:3840 sc1
    buffer_load_dword v8, v6, s[16:19], s59 offen sc1
    s_add_u32 s55, s55, 1
    s_waitcnt vmcnt(0)
    v_max3_u32 v28, v80, v84, v88
    v_max3_u32 v28, v28, v92, v8
    v_cmp_eq_u32 vcc, -1, v28
    s_cmp_ge_u32 s55, 20000
    s_cbranch_scc1 vbk_m_61
    s_nop 1
    s_cbranch_vccnz vlp_m_62
    s_branch vbk_m_61
vrt_m_63:
    s_mov_b32 s55, 0
    s_add_u32 s54, s59, 1024
vlp_m_65:
    s_sleep 1
    buffer_load_dwordx4 v[96:99], v4, s[16:19], s54 offen sc1
    buffer_load_dwordx4 v[100:103], v4, s[16:19], s54 offen offset:1280 sc1
    buffer_load_dwordx4 v[104:107], v4, s[16:19], s54 offen offset:2560 sc1
    buffer_load_dwordx4 v[108:111], v4, s[16:19], s54 offen offset:3840 sc1
    buffer_load_dword v9, v7, s[16:19], s59 offen sc1
    s_add_u32 s55, s55, 1
    s_waitcnt vmcnt(0)
    v_max3_u32 v28, v96, v100, v104
    v_max3_u32 v28, v28, v108, v9
    v_cmp_eq_u32 vcc, -1, v28
    s_cmp_ge_u32 s55, 20000
    s_cbranch_scc1 vbk_m_64
    s_nop 1
    s_cbranch_vccnz vlp_m_65
    s_branch vbk_m_64
w1b_m_9:
    s_and_b32 s30, s29, 3
    s_lshr_b32 s31, s29, 2
    s_cmp_eq_u32 s28, 0
    s_cselect_b32 s61, 8, 16
    s_lshl_b32 s60, s30, 1
    s_mul_i32 s60, s60, s61
    s_add_u32 s36, s60, s28
    s_add_u32 s38, s36, s61
    s_sub_u32 s39, 128, s38
    s_sub_u32 s37, 128, s36
    s_cmp_eq_u32 s36, 0
    s_cselect_b32 s37, 64, s37
    s_lshl_b32 s40, s2, 7
    s_add_u32 s40, s40, 29196288
    s_cmp_lg_u32 s3, 0
    s_cselect_b32 s40, 1073741824, s40
    s_add_u32 s43, s40, 32768
    s_mul_i32 s34, s31, 7
    s_min_u32 s34, s34, 48
    s_lshl_b32 s61, s3, 1
    s_add_u32 s60, s34, s61
    s_lshl_b32 s41, s60, 10
    s_add_u32 s42, s41, 1024
    s_mul_i32 s44, s60, 40960
    s_add_u32 s44, s44, 24641536
    s_add_u32 s45, s44, 40960
    s_cmp_eq_u32 s3, 3
    s_cselect_b32 s45, 1073741824, s45
    s_cselect_b32 s61, s31, 0
    s_cmp_ge_u32 s61, 6
    s_cselect_b32 s44, 1073741824, s44
    s_cmp_eq_u32 s44, 1073741824
    s_cselect_b32 s41, 1073741824, s41
    s_cmp_eq_u32 s45, 1073741824
    s_cselect_b32 s42, 1073741824, s42
    s_cmp_ge_u32 s31, 6
    s_cselect_b32 s60, 6, 7
    s_add_u32 s7, s3, s60
    s_sub_u32 s9, s34, s3
    s_mul_i32 s8, s31, 276480
    s_add_u32 s8, s8, 26853376
    s_mov_b32 s10, 0xffff0000
    s_mov_b32 s18, 29261824
    s_mov_b32 s19, 0x20000
    s_mov_b32 s26, 2621440
    s_mov_b32 s27, 0x20000
    s_mov_b32 s22, 256
    s_mov_b32 s23, 0x20000
    s_lshl_b32 s48, s56, 7
    s_add_u32 s48, s48, 29216768
    s_cmp_lg_u32 s3, 0
    s_cselect_b32 s40, 1073741824, s48
    v_lshl_add_u32 v9, v3, 4, v7
    v_lshlrev_b32 v9, 6, v9
    v_lshl_add_u32 v9, v6, 4, v9
    s_lshr_b32 s48, s3, 1
    s_and_b32 s49, s3, 1
    s_mul_i32 s50, s48, 20480
    s_lshl_b32 s51, s49, 3
    s_add_u32 s51, s50, s51
    v_add_u32 v9, s51, v9
    s_mul_i32 s52, s56, 40960
    s_lshl_b32 s51, s49, 10
    s_add_u32 s52, s52, s51
    s_add_u32 s52, s52, s50
    s_add_u32 s52, s52, 24641536
    v_mov_b32 v20, 0x3f803f80
    v_mov_b32 v21, 0x3f803f80
    v_mov_b32 v22, 0x3f803f80
    v_mov_b32 v23, 0x3f803f80
    v_lshlrev_b32 v11, 3, v2
    s_lshl_b32 s51, s49, 7
    s_add_u32 s51, s51, 122880
    v_add_u32 v11, s51, v11
    s_lshl_b32 s51, s48, 2
    v_add_u32 v12, s51, v11
    s_waitcnt vmcnt(0)
    s_barrier
    ds_read_b64_tr_b16 v[32:33], v9 offset:0
    ds_read_b64_tr_b16 v[34:35], v9 offset:256
    ds_read_b64_tr_b16 v[36:37], v9 offset:512
    ds_read_b64_tr_b16 v[38:39], v9 offset:768
    ds_read_b64_tr_b16 v[40:41], v9 offset:4096
    ds_read_b64_tr_b16 v[42:43], v9 offset:4352
    ds_read_b64_tr_b16 v[44:45], v9 offset:4608
    ds_read_b64_tr_b16 v[46:47], v9 offset:4864
    ds_read_b64_tr_b16 v[48:49], v9 offset:8192
    ds_read_b64_tr_b16 v[50:51], v9 offset:8448
    ds_read_b64_tr_b16 v[52:53], v9 offset:8704
    ds_read_b64_tr_b16 v[54:55], v9 offset:8960
    ds_read_b64_tr_b16 v[56:57], v9 offset:12288
    ds_read_b64_tr_b16 v[58:59], v9 offset:12544
    ds_read_b64_tr_b16 v[60:61], v9 offset:12800
    ds_read_b64_tr_b16 v[62:63], v9 offset:13056
    ds_read_b64_tr_b16 v[64:65], v9 offset:16384
    ds_read_b64_tr_b16 v[66:67], v9 offset:16640
    ds_read_b64_tr_b16 v[68:69], v9 offset:16896
    ds_read_b64_tr_b16 v[70:71], v9 offset:17152
    s_waitcnt lgkmcnt(15)
    v_mfma_f32_16x16x32_bf16 v[80:83], v[20:23], v[32:35], 0
    v_lshlrev_b32 v96, 16, v32
    v_and_b32 v97, s10, v32
    v_lshlrev_b32 v98, 16, v33
    v_and_b32 v99, s10, v33
    v_lshlrev_b32 v100, 16, v34
    v_and_b32 v101, s10, v34
    v_lshlrev_b32 v102, 16, v35
    v_and_b32 v103, s10, v35
    s_waitcnt lgkmcnt(15)
    v_mfma_f32_16x16x32_bf16 v[80:83], v[20:23], v[36:39], v[80:83]
    v_lshlrev_b32 v104, 16, v36
    v_and_b32 v105, s10, v36
    v_lshlrev_b32 v106, 16, v37
    v_and_b32 v107, s10, v37
    v_lshlrev_b32 v108, 16, v38
    v_and_b32 v109, s10, v38
    v_lshlrev_b32 v110, 16, v39
    v_and_b32 v111, s10, v39
    s_waitcnt lgkmcnt(14)
    v_mfma_f32_16x16x32_bf16 v[80:83], v[20:23], v[40:43], v[80:83]
    v_lshlrev_b32 v112, 16, v40
    v_and_b32 v113, s10, v40
    v_lshlrev_b32 v114, 16, v41
    v_and_b32 v115, s10, v41
    v_lshlrev_b32 v116, 16, v42
    v_and_b32 v117, s10, v42
    v_lshlrev_b32 v118, 16, v43
    v_and_b32 v119, s10, v43
    s_waitcnt lgkmcnt(12)
    v_mfma_f32_16x16x32_bf16 v[80:83], v[20:23], v[44:47], v[80:83]
    v_lshlrev_b32 v120, 16, v44
    v_and_b32 v121, s10, v44
    v_lshlrev_b32 v122, 16, v45
    v_and_b32 v123, s10, v45
    v_lshlrev_b32 v124, 16, v46
    v_and_b32 v125, s10, v46
    v_lshlrev_b32 v126, 16, v47
    v_and_b32 v127, s10, v47
    s_waitcnt lgkmcnt(10)
    v_mfma_f32_16x16x32_bf16 v[80:83], v[20:23], v[48:51], v[80:83]
    v_lshlrev_b32 v128, 16, v48
    v_and_b32 v129, s10, v48
    v_lshlrev_b32 v130, 16, v49
    v_and_b32 v131, s10, v49
    v_lshlrev_b32 v132, 16, v50
    v_and_b32 v133, s10, v50
    v_lshlrev_b32 v134, 16, v51
    v_and_b32 v135, s10, v51
    s_waitcnt lgkmcnt(8)
    v_mfma_f32_16x16x32_bf16 v[80:83], v[20:23], v[52:55], v[80:83]
    v_lshlrev_b32 v136, 16, v52
    v_and_b32 v137, s10, v52
    v_lshlrev_b32 v138, 16, v53
    v_and_b32 v139, s10, v53
    v_lshlrev_b32 v140, 16, v54
    v_and_b32 v141, s10, v54
    v_lshlrev_b32 v142, 16, v55
    v_and_b32 v143, s10, v55
    s_waitcnt lgkmcnt(6)
    v_mfma_f32_16x16x32_bf16 v[80:83], v[20:23], v[56:59], v[80:83]
    v_lshlrev_b32 v144, 16, v56
    v_and_b32 v145, s10, v56
    v_lshlrev_b32 v146, 16, v57
    v_and_b32 v147, s10, v57
    v_lshlrev_b32 v148, 16, v58
    v_and_b32 v149, s10, v58
    v_lshlrev_b32 v150, 16, v59
    v_and_b32 v151, s10, v59
    s_waitcnt lgkmcnt(4)
    v_mfma_f32_16x16x32_bf16 v[80:83], v[20:23], v[60:63], v[80:83]
    v_lshlrev_b32 v152, 16, v60
    v_and_b32 v153, s10, v60
    v_lshlrev_b32 v154, 16, v61
    v_and_b32 v155, s10, v61
    v_lshlrev_b32 v156, 16, v62
    v_and_b32 v157, s10, v62
    v_lshlrev_b32 v158, 16, v63
    v_and_b32 v159, s10, v63
    s_waitcnt lgkmcnt(2)
    v_mfma_f32_16x16x32_bf16 v[80:83], v[20:23], v[64:67], v[80:83]
    s_waitcnt lgkmcnt(0)
    v_mfma_f32_16x16x32_bf16 v[80:83], v[20:23], v[68:71], v[80:83]
    v_lshlrev_b32 v160, 16, v64
    v_and_b32 v161, s10, v64
    v_lshlrev_b32 v162, 16, v65
    v_and_b32 v163, s10, v65
    v_lshlrev_b32 v164, 16, v66
    v_and_b32 v165, s10, v66
    v_lshlrev_b32 v166, 16, v67
    v_and_b32 v167, s10, v67
    ds_write_b32 v12, v80
    v_lshlrev_b32 v168, 16, v68
    v_and_b32 v169, s10, v68
    v_lshlrev_b32 v170, 16, v69
    v_and_b32 v171, s10, v69
    v_lshlrev_b32 v172, 16, v70
    v_and_b32 v173, s10, v70
    v_lshlrev_b32 v174, 16, v71
    v_and_b32 v175, s10, v71
    s_waitcnt lgkmcnt(0)
    s_barrier
    ds_read_b64 v[24:25], v11
    s_waitcnt lgkmcnt(0)
    v_add_f32 v24, v24, v25
    v_mul_f32 v24, 0xbacccccd, v24
    v_mov_b32 v25, v24
    v_pk_add_f32 v[96:97], v[96:97], v[24:25]
    v_pk_add_f32 v[98:99], v[98:99], v[24:25]
    v_pk_add_f32 v[100:101], v[100:101], v[24:25]
    v_pk_add_f32 v[102:103], v[102:103], v[24:25]
    v_cvt_pk_bf16_f32 v32, v96, v97
    v_cvt_pk_bf16_f32 v33, v98, v99
    v_cvt_pk_bf16_f32 v34, v100, v101
    v_cvt_pk_bf16_f32 v35, v102, v103
    buffer_store_dwordx4 v[32:35], v1, s[16:19], s52 offen sc1
    v_pk_add_f32 v[104:105], v[104:105], v[24:25]
    v_pk_add_f32 v[106:107], v[106:107], v[24:25]
    v_pk_add_f32 v[108:109], v[108:109], v[24:25]
    v_pk_add_f32 v[110:111], v[110:111], v[24:25]
    v_cvt_pk_bf16_f32 v36, v104, v105
    v_cvt_pk_bf16_f32 v37, v106, v107
    v_cvt_pk_bf16_f32 v38, v108, v109
    v_cvt_pk_bf16_f32 v39, v110, v111
    buffer_store_dwordx4 v[36:39], v1, s[16:19], s52 offen offset:2048 sc1
    s_add_u32 s52, s52, 4096
    v_pk_add_f32 v[112:113], v[112:113], v[24:25]
    v_pk_add_f32 v[114:115], v[114:115], v[24:25]
    v_pk_add_f32 v[116:117], v[116:117], v[24:25]
    v_pk_add_f32 v[118:119], v[118:119], v[24:25]
    v_cvt_pk_bf16_f32 v40, v112, v113
    v_cvt_pk_bf16_f32 v41, v114, v115
    v_cvt_pk_bf16_f32 v42, v116, v117
    v_cvt_pk_bf16_f32 v43, v118, v119
    buffer_store_dwordx4 v[40:43], v1, s[16:19], s52 offen sc1
    v_pk_add_f32 v[120:121], v[120:121], v[24:25]
    v_pk_add_f32 v[122:123], v[122:123], v[24:25]
    v_pk_add_f32 v[124:125], v[124:125], v[24:25]
    v_pk_add_f32 v[126:127], v[126:127], v[24:25]
    v_cvt_pk_bf16_f32 v44, v120, v121
    v_cvt_pk_bf16_f32 v45, v122, v123
    v_cvt_pk_bf16_f32 v46, v124, v125
    v_cvt_pk_bf16_f32 v47, v126, v127
    buffer_store_dwordx4 v[44:47], v1, s[16:19], s52 offen offset:2048 sc1
    s_add_u32 s52, s52, 4096
    v_pk_add_f32 v[128:129], v[128:129], v[24:25]
    v_pk_add_f32 v[130:131], v[130:131], v[24:25]
    v_pk_add_f32 v[132:133], v[132:133], v[24:25]
    v_pk_add_f32 v[134:135], v[134:135], v[24:25]
    v_cvt_pk_bf16_f32 v48, v128, v129
    v_cvt_pk_bf16_f32 v49, v130, v131
    v_cvt_pk_bf16_f32 v50, v132, v133
    v_cvt_pk_bf16_f32 v51, v134, v135
    buffer_store_dwordx4 v[48:51], v1, s[16:19], s52 offen sc1
    v_pk_add_f32 v[136:137], v[136:137], v[24:25]
    v_pk_add_f32 v[138:139], v[138:139], v[24:25]
    v_pk_add_f32 v[140:141], v[140:141], v[24:25]
    v_pk_add_f32 v[142:143], v[142:143], v[24:25]
    v_cvt_pk_bf16_f32 v52, v136, v137
    v_cvt_pk_bf16_f32 v53, v138, v139
    v_cvt_pk_bf16_f32 v54, v140, v141
    v_cvt_pk_bf16_f32 v55, v142, v143
    buffer_store_dwordx4 v[52:55], v1, s[16:19], s52 offen offset:2048 sc1
    s_add_u32 s52, s52, 4096
    v_pk_add_f32 v[144:145], v[144:145], v[24:25]
    v_pk_add_f32 v[146:147], v[146:147], v[24:25]
    v_pk_add_f32 v[148:149], v[148:149], v[24:25]
    v_pk_add_f32 v[150:151], v[150:151], v[24:25]
    v_cvt_pk_bf16_f32 v56, v144, v145
    v_cvt_pk_bf16_f32 v57, v146, v147
    v_cvt_pk_bf16_f32 v58, v148, v149
    v_cvt_pk_bf16_f32 v59, v150, v151
    buffer_store_dwordx4 v[56:59], v1, s[16:19], s52 offen sc1
    v_pk_add_f32 v[152:153], v[152:153], v[24:25]
    v_pk_add_f32 v[154:155], v[154:155], v[24:25]
    v_pk_add_f32 v[156:157], v[156:157], v[24:25]
    v_pk_add_f32 v[158:159], v[158:159], v[24:25]
    v_cvt_pk_bf16_f32 v60, v152, v153
    v_cvt_pk_bf16_f32 v61, v154, v155
    v_cvt_pk_bf16_f32 v62, v156, v157
    v_cvt_pk_bf16_f32 v63, v158, v159
    buffer_store_dwordx4 v[60:63], v1, s[16:19], s52 offen offset:2048 sc1
    s_add_u32 s52, s52, 4096
    v_pk_add_f32 v[160:161], v[160:161], v[24:25]
    v_pk_add_f32 v[162:163], v[162:163], v[24:25]
    v_pk_add_f32 v[164:165], v[164:165], v[24:25]
    v_pk_add_f32 v[166:167], v[166:167], v[24:25]
    v_cvt_pk_bf16_f32 v64, v160, v161
    v_cvt_pk_bf16_f32 v65, v162, v163
    v_cvt_pk_bf16_f32 v66, v164, v165
    v_cvt_pk_bf16_f32 v67, v166, v167
    buffer_store_dwordx4 v[64:67], v1, s[16:19], s52 offen sc1
    v_pk_add_f32 v[168:169], v[168:169], v[24:25]
    v_pk_add_f32 v[170:171], v[170:171], v[24:25]
    v_pk_add_f32 v[172:173], v[172:173], v[24:25]
    v_pk_add_f32 v[174:175], v[174:175], v[24:25]
    v_cvt_pk_bf16_f32 v68, v168, v169
    v_cvt_pk_bf16_f32 v69, v170, v171
    v_cvt_pk_bf16_f32 v70, v172, v173
    v_cvt_pk_bf16_f32 v71, v174, v175
    buffer_store_dwordx4 v[68:71], v1, s[16:19], s52 offen offset:2048 sc1
    s_add_u32 s52, s52, 4096
    s_branch prepidle_m_70
w2b_m_10:
    buffer_load_dwordx4 v1, s[12:15], s48 offen lds
    buffer_load_dwordx4 v1, s[12:15], s48 offen offset:1024 lds
    buffer_load_dwordx4 v1, s[12:15], s48 offen offset:2048 lds
    buffer_load_dwordx4 v1, s[12:15], s48 offen offset:3072 lds
    s_add_u32 m0, m0, 4096
    s_add_u32 s48, s48, 4096
    buffer_load_dwordx4 v1, s[12:15], s48 offen lds
    buffer_load_dwordx4 v1, s[12:15], s48 offen offset:1024 lds
    buffer_load_dwordx4 v1, s[12:15], s48 offen offset:2048 lds
    buffer_load_dwordx4 v1, s[12:15], s48 offen offset:3072 lds
    s_add_u32 m0, m0, 4096
    s_add_u32 s48, s48, 4096
    buffer_load_dwordx4 v1, s[12:15], s48 offen lds
    buffer_load_dwordx4 v1, s[12:15], s48 offen offset:1024 lds
    buffer_load_dwordx4 v1, s[12:15], s48 offen offset:2048 lds
    buffer_load_dwordx4 v1, s[12:15], s48 offen offset:3072 lds
    s_add_u32 m0, m0, 4096
    s_add_u32 s48, s48, 4096
    buffer_load_dwordx4 v1, s[12:15], s48 offen lds
    buffer_load_dwordx4 v1, s[12:15], s48 offen offset:1024 lds
    buffer_load_dwordx4 v1, s[12:15], s48 offen offset:2048 lds
    buffer_load_dwordx4 v1, s[12:15], s48 offen offset:3072 lds
    s_add_u32 m0, m0, 4096
    s_add_u32 s48, s48, 4096
    buffer_load_dwordx4 v1, s[12:15], s48 offen lds
    buffer_load_dwordx4 v1, s[12:15], s48 offen offset:1024 lds
    buffer_load_dwordx4 v1, s[12:15], s48 offen offset:2048 lds
    buffer_load_dwordx4 v1, s[12:15], s48 offen offset:3072 lds
    s_and_b32 s30, s29, 3
    s_lshr_b32 s31, s29, 2
    s_cmp_eq_u32 s28, 0
    s_cselect_b32 s61, 8, 16
    s_lshl_b32 s60, s30, 1
    s_mul_i32 s60, s60, s61
    s_add_u32 s36, s60, s28
    s_add_u32 s38, s36, s61
    s_sub_u32 s39, 128, s38
    s_sub_u32 s37, 128, s36
    s_cmp_eq_u32 s36, 0
    s_cselect_b32 s37, 64, s37
    s_lshl_b32 s40, s2, 7
    s_add_u32 s40, s40, 29196288
    s_cmp_lg_u32 s3, 0
    s_cselect_b32 s40, 1073741824, s40
    s_add_u32 s43, s40, 32768
    s_mul_i32 s34, s31, 7
    s_min_u32 s34, s34, 48
    s_lshl_b32 s61, s3, 1
    s_add_u32 s60, s34, s61
    s_lshl_b32 s41, s60, 10
    s_add_u32 s42, s41, 1024
    s_mul_i32 s44, s60, 40960
    s_add_u32 s44, s44, 24641536
    s_add_u32 s45, s44, 40960
    s_cmp_eq_u32 s3, 3
    s_cselect_b32 s45, 1073741824, s45
    s_cselect_b32 s61, s31, 0
    s_cmp_ge_u32 s61, 6
    s_cselect_b32 s44, 1073741824, s44
    s_cmp_eq_u32 s44, 1073741824
    s_cselect_b32 s41, 1073741824, s41
    s_cmp_eq_u32 s45, 1073741824
    s_cselect_b32 s42, 1073741824, s42
    s_cmp_ge_u32 s31, 6
    s_cselect_b32 s60, 6, 7
    s_add_u32 s7, s3, s60
    s_sub_u32 s9, s34, s3
    s_mul_i32 s8, s31, 276480
    s_add_u32 s8, s8, 26853376
    s_mov_b32 s10, 0xffff0000
    s_mov_b32 s18, 29261824
    s_mov_b32 s19, 0x20000
    s_mov_b32 s26, 2621440
    s_mov_b32 s27, 0x20000
    s_mov_b32 s22, 256
    s_mov_b32 s23, 0x20000
    s_and_b32 s48, s3, 1
    s_lshr_b32 s49, s3, 1
    v_lshl_add_u32 v9, v3, 3, v7
    v_mul_u32_u24 v9, 1280, v9
    s_mul_i32 s50, s48, 40960
    s_mul_i32 s51, s49, 640
    s_add_u32 s50, s50, s51
    v_add_u32 v9, s50, v9
    v_lshrrev_b32 v11, 1, v6
    v_lshl_add_u32 v10, v11, 5, v9
    v_and_b32 v11, 1, v6
    v_lshl_add_u32 v10, v11, 3, v10
    v_lshl_add_u32 v9, v6, 5, v9
    s_lshl_b32 s50, s56, 1
    s_add_u32 s50, s50, s48
    s_mul_i32 s52, s50, 5120
    s_mul_i32 s51, s49, 1105920
    s_add_u32 s52, s52, s51
    s_add_u32 s52, s52, 26853376
    v_add_u32 v12, 4096, v1
    s_waitcnt vmcnt(0)
    s_barrier
    ds_read_b64_tr_b16 v[32:33], v9 offset:0
    ds_read_b64_tr_b16 v[34:35], v9 offset:5120
    ds_read_b64_tr_b16 v[36:37], v9 offset:8
    ds_read_b64_tr_b16 v[38:39], v9 offset:5128
    ds_read_b64_tr_b16 v[40:41], v9 offset:16
    ds_read_b64_tr_b16 v[42:43], v9 offset:5136
    ds_read_b64_tr_b16 v[44:45], v9 offset:24
    ds_read_b64_tr_b16 v[46:47], v9 offset:5144
    ds_read_b64_tr_b16 v[48:49], v10 offset:128
    ds_read_b64_tr_b16 v[50:51], v10 offset:5248
    ds_read_b64_tr_b16 v[52:53], v9 offset:144
    ds_read_b64_tr_b16 v[54:55], v9 offset:5264
    s_waitcnt lgkmcnt(10)
    ds_read_b64_tr_b16 v[56:57], v9 offset:152
    ds_read_b64_tr_b16 v[58:59], v9 offset:5272
    buffer_store_dwordx4 v[32:35], v1, s[16:19], s52 offen sc1
    s_waitcnt lgkmcnt(10)
    ds_read_b64_tr_b16 v[60:61], v9 offset:256
    ds_read_b64_tr_b16 v[62:63], v9 offset:5376
    buffer_store_dwordx4 v[36:39], v1, s[16:19], s52 offen offset:1024 sc1
    s_waitcnt lgkmcnt(10)
    ds_read_b64_tr_b16 v[64:65], v9 offset:264
    ds_read_b64_tr_b16 v[66:67], v9 offset:5384
    buffer_store_dwordx4 v[40:43], v1, s[16:19], s52 offen offset:2048 sc1
    s_waitcnt lgkmcnt(10)
    ds_read_b64_tr_b16 v[68:69], v10 offset:192
    ds_read_b64_tr_b16 v[70:71], v10 offset:5312
    buffer_store_dwordx4 v[44:47], v1, s[16:19], s52 offen offset:3072 sc1
    s_waitcnt lgkmcnt(10)
    ds_read_b64_tr_b16 v[72:73], v9 offset:272
    ds_read_b64_tr_b16 v[74:75], v9 offset:5392
    buffer_store_dwordx4 v[48:51], v12, s[16:19], s52 offen sc1
    s_add_u32 s52, s52, 276480
    s_waitcnt lgkmcnt(10)
    ds_read_b64_tr_b16 v[76:77], v9 offset:280
    ds_read_b64_tr_b16 v[78:79], v9 offset:5400
    buffer_store_dwordx4 v[52:55], v1, s[16:19], s52 offen sc1
    s_waitcnt lgkmcnt(10)
    ds_read_b64_tr_b16 v[80:81], v9 offset:384
    ds_read_b64_tr_b16 v[82:83], v9 offset:5504
    buffer_store_dwordx4 v[56:59], v1, s[16:19], s52 offen offset:1024 sc1
    s_waitcnt lgkmcnt(10)
    ds_read_b64_tr_b16 v[84:85], v9 offset:392
    ds_read_b64_tr_b16 v[86:87], v9 offset:5512
    buffer_store_dwordx4 v[60:63], v1, s[16:19], s52 offen offset:2048 sc1
    s_waitcnt lgkmcnt(10)
    ds_read_b64_tr_b16 v[88:89], v10 offset:400
    ds_read_b64_tr_b16 v[90:91], v10 offset:5520
    buffer_store_dwordx4 v[64:67], v1, s[16:19], s52 offen offset:3072 sc1
    s_waitcnt lgkmcnt(10)
    ds_read_b64_tr_b16 v[92:93], v9 offset:512
    ds_read_b64_tr_b16 v[94:95], v9 offset:5632
    buffer_store_dwordx4 v[68:71], v12, s[16:19], s52 offen sc1
    s_add_u32 s52, s52, 276480
    s_waitcnt lgkmcnt(10)
    ds_read_b64_tr_b16 v[96:97], v9 offset:520
    ds_read_b64_tr_b16 v[98:99], v9 offset:5640
    buffer_store_dwordx4 v[72:75], v1, s[16:19], s52 offen sc1
    s_waitcnt lgkmcnt(10)
    ds_read_b64_tr_b16 v[100:101], v9 offset:528
    ds_read_b64_tr_b16 v[102:103], v9 offset:5648
    buffer_store_dwordx4 v[76:79], v1, s[16:19], s52 offen offset:1024 sc1
    s_waitcnt lgkmcnt(10)
    ds_read_b64_tr_b16 v[104:105], v9 offset:536
    ds_read_b64_tr_b16 v[106:107], v9 offset:5656
    buffer_store_dwordx4 v[80:83], v1, s[16:19], s52 offen offset:2048 sc1
    s_waitcnt lgkmcnt(10)
    ds_read_b64_tr_b16 v[108:109], v10 offset:464
    ds_read_b64_tr_b16 v[110:111], v10 offset:5584
    buffer_store_dwordx4 v[84:87], v1, s[16:19], s52 offen offset:3072 sc1
    s_waitcnt lgkmcnt(10)
    buffer_store_dwordx4 v[88:91], v12, s[16:19], s52 offen sc1
    s_add_u32 s52, s52, 276480
    s_waitcnt lgkmcnt(8)
    buffer_store_dwordx4 v[92:95], v1, s[16:19], s52 offen sc1
    s_waitcnt lgkmcnt(6)
    buffer_store_dwordx4 v[96:99], v1, s[16:19], s52 offen offset:1024 sc1
    s_waitcnt lgkmcnt(4)
    buffer_store_dwordx4 v[100:103], v1, s[16:19], s52 offen offset:2048 sc1
    s_waitcnt lgkmcnt(2)
    buffer_store_dwordx4 v[104:107], v1, s[16:19], s52 offen offset:3072 sc1
    s_waitcnt lgkmcnt(0)
    buffer_store_dwordx4 v[108:111], v12, s[16:19], s52 offen sc1
    s_add_u32 s52, s52, 276480
    s_branch prepidle_m_70
cpf_m_11:
    s_and_b32 s30, s29, 3
    s_lshr_b32 s31, s29, 2
    s_cmp_eq_u32 s28, 0
    s_cselect_b32 s61, 8, 16
    s_lshl_b32 s60, s30, 1
    s_mul_i32 s60, s60, s61
    s_add_u32 s36, s60, s28
    s_add_u32 s38, s36, s61
    s_sub_u32 s39, 128, s38
    s_sub_u32 s37, 128, s36
    s_cmp_eq_u32 s36, 0
    s_cselect_b32 s37, 64, s37
    s_lshl_b32 s40, s2, 7
    s_add_u32 s40, s40, 29196288
    s_cmp_lg_u32 s3, 0
    s_cselect_b32 s40, 1073741824, s40
    s_add_u32 s43, s40, 32768
    s_mul_i32 s34, s31, 7
    s_min_u32 s34, s34, 48
    s_lshl_b32 s61, s3, 1
    s_add_u32 s60, s34, s61
    s_lshl_b32 s41, s60, 10
    s_add_u32 s42, s41, 1024
    s_mul_i32 s44, s60, 40960
    s_add_u32 s44, s44, 24641536
    s_add_u32 s45, s44, 40960
    s_cmp_eq_u32 s3, 3
    s_cselect_b32 s45, 1073741824, s45
    s_cselect_b32 s61, s31, 0
    s_cmp_ge_u32 s61, 6
    s_cselect_b32 s44, 1073741824, s44
    s_cmp_eq_u32 s44, 1073741824
    s_cselect_b32 s41, 1073741824, s41
    s_cmp_eq_u32 s45, 1073741824
    s_cselect_b32 s42, 1073741824, s42
    s_cmp_ge_u32 s31, 6
    s_cselect_b32 s60, 6, 7
    s_add_u32 s7, s3, s60
    s_sub_u32 s9, s34, s3
    s_mul_i32 s8, s31, 276480
    s_add_u32 s8, s8, 26853376
    s_mov_b32 s10, 0xffff0000
    s_mov_b32 s18, 29261824
    s_mov_b32 s19, 0x20000
    s_mov_b32 s26, 2621440
    s_mov_b32 s27, 0x20000
    s_mov_b32 s22, 256
    s_mov_b32 s23, 0x20000
    s_lshl_b32 s48, s3, 8
    s_add_u32 s48, s48, s2
    s_cmp_lg_u32 s48, 255
    s_cbranch_scc1 mskip_m_71
    s_memrealtime s[50:51]
    s_waitcnt lgkmcnt(0)
    s_lshr_b64 s[52:53], s[50:51], 28
    s_lshl_b32 s50, s50, 3
    s_or_b32 s50, s50, 0x80000000
    v_mov_b32 v250, s50
    v_mov_b32 v251, s52
    v_lshlrev_b32 v252, 25, v0
    buffer_store_dwordx2 v[250:251], v252, s[20:23], 0 offen sc0 sc1
mskip_m_71:
    v_lshlrev_b32 v100, 16, v0
    s_lshl_b32 s48, s3, 22
    buffer_load_dword v104, v100, s[16:19], s48 offen sc1
    s_add_u32 s48, s48, 16777216
    buffer_load_dword v105, v100, s[16:19], s48 offen sc1
    s_add_u32 s48, s48, 16777216
    buffer_load_dword v102, v100, s[24:27], 0 offen
prepidle_m_70:
    s_mov_b32 s32, 0
    s_mov_b32 s6, 0
    v_mov_b32 v251, 0
    buffer_load_dwordx2 v[248:249], v251, s[20:23], 0 offen sc1
    s_branch join_m_3
end_m_1:
    s_endpgm
Lcodeend_m:
.section .rodata,"a"
.p2align 6
.amdhsa_kernel interleave_layers__spectral_fnet__dense_activation_relu__prompt_kernel
  .amdhsa_next_free_vgpr 512
  .amdhsa_next_free_sgpr 102
  .amdhsa_accum_offset 256
  .amdhsa_group_segment_fixed_size 0
  .amdhsa_kernarg_size 88
  .amdhsa_user_sgpr_count 2
  .amdhsa_user_sgpr_kernarg_segment_ptr 1
  .amdhsa_system_sgpr_workgroup_id_x 1
.end_amdhsa_kernel
```
